```python
import torch

def _softmax(x, axis=-1):
    return torch.softmax(x, dim=axis)
def _gelu(x):
    return torch.nn.functional.gelu(x, approximate="tanh")
def _silu(x):
    return torch.nn.functional.silu(x)
def _sigmoid(x):
    return torch.sigmoid(x)
def _layernorm(x, axis=-1, eps=1e-5):
    m = x.mean(dim=axis, keepdim=True)
    v = x.var(dim=axis, keepdim=True, unbiased=False)
    return (x - m) / torch.sqrt(v + eps)
def _scatter_add(tgt, idx, src, axis=0):
    return tgt.clone().index_add_(axis, idx, src)
def _segment_sum(src, seg, n):
    out = torch.zeros((n,) + src.shape[1:], dtype=src.dtype)
    return out.index_add_(0, seg, src)
def _pad(x, pw):
    flat = tuple(v for pair in reversed(pw) for v in pair)
    return torch.nn.functional.pad(x, flat)

kernel_name = 'interleave_layers__sliding_block__sliding_local_dilated__prompt'

def setup_inputs():

    _w = (lambda a: (lambda t: t.to(torch.bfloat16) if t.is_floating_point() else t)(torch.as_tensor(a)))
    def _A_setup():
        B, S, D = 1, 2048, 512
        return {
            "x": _w((lambda *s: torch.randn(*s, dtype=torch.bfloat16) * 0.05)(B, S, D)),
            "wqkv": _w((lambda *s: torch.randn(*s, dtype=torch.bfloat16) * 0.05)(D, 3 * D)),
            "wo": _w((lambda *s: torch.randn(*s, dtype=torch.bfloat16) * 0.05)(D, D)),
        }
    _A_in = _A_setup()

    def _B_setup():
        B, S, D = 1, 2048, 512
        return {
            "x": _w((lambda *s: torch.randn(*s, dtype=torch.bfloat16) * 0.05)(B, S, D)),
            "wqkv": _w((lambda *s: torch.randn(*s, dtype=torch.bfloat16) * 0.05)(D, 3 * D)),
            "wo": _w((lambda *s: torch.randn(*s, dtype=torch.bfloat16) * 0.05)(D, D)),
        }
    _B_in = _B_setup()

    return {
        "A_x": _A_in["x"],
        "A_wqkv": _A_in["wqkv"],
        "A_wo": _A_in["wo"],
        "B_x": _B_in["x"],
        "B_wqkv": _B_in["wqkv"],
        "B_wo": _B_in["wo"],
    }

def reference(A_x, A_wqkv, A_wo, B_x, B_wqkv, B_wo):
    def _A_ref(x, wqkv, wo):
        B, S, D = x.shape
        H = 32; Dh = D // H; W = 256
        qkv = (lambda x, *d: x.permute(*d))((x @ wqkv).reshape(B, S, 3, H, Dh), 2, 0, 3, 1, 4)
        q, k, v = qkv[0], qkv[1], qkv[2]
        scores = torch.einsum("bhqd,bhkd->bhqk", q, k) * (Dh ** -0.5)
        idx = torch.arange(S)
        mask = (idx[:, None] - idx[None, :] >= 0) & (idx[:, None] - idx[None, :] < W)
        scores = torch.where(mask[None, None], scores, -1e9)
        p = _softmax(scores, axis=-1)
        o = torch.einsum("bhqk,bhkd->bhqd", p, v)
        return (lambda x, *d: x.permute(*d))(o, 0, 2, 1, 3).reshape(B, S, D) @ wo

    def _B_ref(x, wqkv, wo):
        B, S, D = x.shape
        H = 32; Dh = D // H
        W, dil = 8, 2
        qkv = (lambda x, *d: x.permute(*d))((x @ wqkv).reshape(B, S, 3, H, Dh), 2, 0, 3, 1, 4)
        q, k, v = qkv[0], qkv[1], qkv[2]
        scale = Dh ** -0.5
        pos = torch.arange(S)
        off = torch.arange(W) * dil
        idx = pos[:, None] - off[None, :]
        mask = idx >= 0
        idx_c = torch.where(mask, idx, 0).reshape(-1)
        kg = k[:, :, idx_c, :].reshape(B, H, S, W, Dh)
        vg = v[:, :, idx_c, :].reshape(B, H, S, W, Dh)
        logits = torch.einsum("bhsd,bhswd->bhsw", q, kg) * scale
        logits = torch.where(mask[None, None, :, :], logits, -1e9)
        attn = _softmax(logits, axis=-1)
        o = torch.einsum("bhsw,bhswd->bhsd", attn, vg)
        return (lambda x, *d: x.permute(*d))(o, 0, 2, 1, 3).reshape(B, S, D) @ wo

    x = A_x
    x = x + _A_ref(_layernorm(x, axis=-1), A_wqkv, A_wo)
    x = x + _B_ref(_layernorm(x, axis=-1), B_wqkv, B_wo)
    x = x + _A_ref(_layernorm(x, axis=-1), A_wqkv, A_wo)
    x = x + _B_ref(_layernorm(x, axis=-1), B_wqkv, B_wo)
    return x
```

```asm
; @launch grid=(256,1,1) block=(256,1,1) lds=163840
.amdgcn_target "amdgcn-amd-amdhsa--gfx950"
.text
.globl interleave_layers__sliding_block__sliding_local_dilated__prompt_kernel
.p2align 8
.type interleave_layers__sliding_block__sliding_local_dilated__prompt_kernel,@function
interleave_layers__sliding_block__sliding_local_dilated__prompt_kernel:
    s_cmp_ge_u32 s2, 256
    s_cbranch_scc1 L_exit
    s_load_dwordx2 s[16:17], s[0:1], 8
    s_load_dwordx2 s[8:9], s[0:1], 0
    s_lshr_b32 s37, s2, 3
    s_getpc_b64 s[50:51]
    s_lshl_b32 s48, s37, 9
    v_lshl_add_u32 v6, v0, 1, s48
    global_load_ubyte v123, v6, s[50:51]
    v_lshrrev_b32 v6, 6, v0
    v_and_b32_e64 v1, 63, v0
    v_readfirstlane_b32 s3, v6
    s_mov_b32 s18, 1572864
    s_mov_b32 s19, 0x20000
    s_and_b32 s36, s2, 7
    s_lshr_b32 s38, s2, 6
    s_and_b32 s39, s37, 7
    s_lshl_b32 s49, s36, 18
    s_lshl_b32 s48, s37, 13
    s_add_u32 s48, s48, s49
    v_lshl_add_u32 v8, v0, 5, s48
    v_bfe_u32 v6, v1, 4, 1
    s_and_b32 s48, s3, 1
    s_lshl_b32 s48, s48, 1
    v_or_b32 v6, s48, v6
    v_lshlrev_b32 v6, 1, v6
    v_and_b32 v5, 7, v1
    v_xor_b32 v5, v5, v6
    v_lshlrev_b32 v5, 4, v5
    v_lshrrev_b32 v6, 3, v1
    v_mul_u32_u24 v6, 3072, v6
    v_add_u32 v5, v5, v6
    s_mul_i32 s62, s3, 24576
    s_lshl_b32 s56, s39, 7
    s_add_u32 s62, s62, s56
    s_lshl_b32 s57, s3, 11
    s_add_u32 s56, s57, 64512
    s_andn2_b32 s48, 6, s39
    s_lshl_b32 s49, s39, 2
    s_lshl_b32 s49, s48, s49
    s_lshl_b32 s48, s48, 28
    s_xor_b32 s48, s48, s49
    s_bitcmp1_b32 s39, 0
    s_cselect_b32 s49, 0, 0x11000000
    s_xor_b32 s48, s48, s49
    s_mul_i32 s80, s38, 0x22222222
    s_xor_b32 s48, s48, 0x76543210
    s_add_u32 s80, s80, s48
    s_bfe_u32 s55, s80, 0x30000
    s_mul_i32 s55, s55, 196608
    s_add_u32 s55, s55, s62
    s_add_u32 m0, s56, 0
    s_waitcnt lgkmcnt(0)
    global_load_dword v123, v8, s[8:9]
    buffer_load_dwordx4 v5, s[16:19], s55 offen offset:1024 lds
    buffer_load_dwordx4 v5, s[16:19], s55 offen offset:2048 lds
    s_add_u32 s55, s55, 98304
    s_add_u32 m0, s56, 8192
    s_nop 0
    buffer_load_dwordx4 v5, s[16:19], s55 offen offset:1024 lds
    buffer_load_dwordx4 v5, s[16:19], s55 offen offset:2048 lds
    s_load_dwordx2 s[4:5], s[0:1], 64
    s_load_dwordx2 s[20:21], s[0:1], 16
    s_load_dwordx4 s[32:35], s[0:1], 32
    s_load_dwordx2 s[12:13], s[0:1], 48
    s_load_dwordx2 s[24:25], s[0:1], 56
    v_lshlrev_b32 v0, 4, v1
    v_and_b32 v2, 15, v1
    v_lshrrev_b32_e64 v3, 4, v1
    s_lshl_b32 s40, s36, 2
    s_add_u32 s40, s40, s38
    s_lshl_b32 s45, s40, 2
    s_add_u32 s45, s45, s3
    s_mov_b32 s10, 2097152
    s_mov_b32 s11, 0x20000
    v_lshrrev_b32 v6, 3, v1
    v_xor_b32 v7, v6, v1
    v_and_b32 v7, 7, v7
    v_lshlrev_b32 v7, 4, v7
    v_lshl_add_u32 v122, v6, 11, v7
    s_lshr_b32 s63, s45, 1
    s_lshl_b32 s63, s63, 15
    s_and_b32 s48, s45, 1
    s_lshl_b32 s48, s48, 10
    s_add_u32 s63, s63, s48
    v_add_u32 v239, 15360, v122
    s_bfe_u32 s58, s80, 0x30000
    s_add_u32 m0, s57, 0
    s_lshl_b32 s58, s58, 7
    s_add_u32 s58, s58, s63
    buffer_load_dwordx4 v122, s[8:11], s58 offen offset:0 lds
    buffer_load_dwordx4 v239, s[8:11], s58 offen offset:1024 lds
    s_sub_u32 s48, 384, s16
    s_and_b32 s48, s48, 0x380
    s_lshl_b32 s49, s37, 2
    s_add_u32 s49, s49, s3
    s_mul_i32 s49, s49, 12288
    s_add_u32 s49, s49, s48
    v_lshlrev_b32 v7, 10, v1
    s_mov_b64 exec, 0xfff
    buffer_load_dword v123, v7, s[16:19], s49 offen offset:0
    s_mov_b64 exec, -1
    v_and_b32 v6, 7, v2
    v_xor_b32 v7, v6, v3
    v_lshlrev_b32 v7, 4, v7
    v_lshl_add_u32 v120, v2, 7, v7
    v_xor_b32 v241, 64, v120
    v_add_u32 v121, s57, v120
    v_add_u32_e64 v242, s57, v241
    v_bfe_u32 v6, v1, 3, 1
    v_bfe_u32 v7, v1, 4, 1
    v_lshl_or_b32 v6, v7, 1, v6
    v_xor_b32 v6, s3, v6
    v_lshlrev_b32 v6, 5, v6
    v_and_b32_e64 v7, 3, v1
    v_lshl_add_u32 v6, v7, 3, v6
    v_bfe_u32 v7, v1, 2, 2
    v_lshl_add_u32 v6, v7, 7, v6
    v_mul_u32_u24 v7, 2048, v3
    v_add_u32_e64 v4, v6, v7
    v_add_u32 v4, 65536, v4
    v_add_u32 v240, 0x10000, v4
    v_mov_b32 v96, 0x3f803f80
    v_mov_b32 v97, 0x3f803f80
    v_mov_b32 v98, 0x3f803f80
    v_mov_b32 v99, 0x3f803f80
    s_mov_b32 s14, 2097152
    s_mov_b32 s15, 0x20000
    s_mov_b32 s22, 524288
    s_mov_b32 s23, 0x20000
    s_lshl_b32 s46, s39, 2
    s_add_u32 s46, s46, s3
    s_mov_b32 s41, 0
    s_mov_b32 s44, 0
    s_mul_i32 s78, s3, 6144
    s_add_u32 s78, s78, 131072
    s_lshl_b32 s73, s46, 17
    s_lshl_b32 s48, s40, 12
    s_add_u32 s73, s73, s48
    s_add_u32 s73, s73, 10485760
    s_lshl_b32 s74, s40, 16
    s_lshl_b32 s48, s46, 10
    s_add_u32 s74, s74, s48
    s_add_u32 s74, s74, 2097152
    s_add_u32 s75, s74, 32768
    s_lshl_b32 s72, s39, 1
    s_lshl_b32 s77, s45, 10
    s_add_u32 s77, s77, 18874368
    s_min_u32 s48, s40, 4
    s_lshl_b32 s82, 0xf, s48
    s_mov_b32 s81, s82
    s_lshr_b32 s49, s45, 1
    s_and_b32 s50, s45, 1
    s_lshl_b32 s83, s49, 15
    s_lshl_b32 s48, s50, 9
    s_add_u32 s83, s83, s48
    s_add_u32 s83, s83, 2097152
    s_lshl_b32 s84, s49, 15
    s_lshl_b32 s48, s50, 10
    s_add_u32 s84, s84, s48
    s_lshl_b32 s48, s39, 7
    s_add_u32 s84, s84, s48
    s_lshl_b32 s85, s45, 14
    s_lshl_b32 s48, s39, 11
    s_add_u32 s85, s85, s48
    s_bfe_u32 s49, s80, 0x3001c
    s_lshl_b32 s76, s45, 14
    s_lshl_b32 s48, s49, 11
    s_add_u32 s76, s76, s48
    s_lshl_b32 s86, s45, 10
    s_lshl_b32 s48, s39, 3
    s_add_u32 s86, s86, s48
    s_add_u32 s86, s86, 18874368
    s_lshl_b32 s87, s40, 14
    s_lshl_b32 s48, s39, 11
    s_add_u32 s87, s87, s48
    s_lshl_b32 s48, s3, 7
    s_add_u32 s87, s87, s48
    s_add_u32 s87, s87, 19922560
    s_lshl_b32 s88, s40, 10
    s_lshl_b32 s48, s39, 3
    s_add_u32 s88, s88, s48
    s_lshl_b32 s48, s3, 9
    s_add_u32 s88, s88, s48
    s_add_u32 s88, s88, 20969984
    s_xor_b32 s49, s3, s39
    s_lshl_b32 s89, s40, 14
    s_lshl_b32 s48, s49, 11
    s_add_u32 s89, s89, s48
    s_add_u32 s89, s89, 19906560
    s_lshl_b32 s90, s40, 10
    s_add_u32 s90, s90, 20970496
    s_mov_b32 s92, 0x3eb8aa3b
    s_mov_b32 s94, 0xffff
    s_mov_b32 s95, 0xffff
    v_and_b32 v125, 3, v1
    s_sub_u32 s48, s40, 1
    v_sub_u32 v7, s48, v125
    v_and_b32 v7, 31, v7
    v_lshlrev_b32 v7, 11, v7
    s_lshl_b32 s49, s39, 8
    s_lshl_b32 s48, s3, 2
    s_add_u32 s49, s49, s48
    v_add_u32 v7, s49, v7
    v_add_u32 v6, 128, v7
    v_cmp_gt_u32 s[50:51], s38, v125
    s_nop 1
    v_cndmask_b32 v125, v6, v7, s[50:51]
    v_mov_b32 v126, 0
    v_mov_b32 v127, 0
    v_lshlrev_b32 v6, 1, v2
    v_bfe_u32 v7, v1, 4, 1
    v_add_u32 v6, v6, v7
    v_lshrrev_b32 v7, 5, v1
    v_lshlrev_b32 v7, 3, v7
    v_sub_u32 v6, v7, v6
    s_mov_b32 s48, 0x1ffff
    v_pk_add_i16 v6, v6, s48 op_sel_hi:[0,1]
    v_pk_add_i16 v216, v6, 0 op_sel_hi:[1,0]
    v_pk_ashrrev_i16 v216, 15, v216 op_sel_hi:[0,1]
    v_pk_add_i16 v217, v6, 4 op_sel_hi:[1,0]
    v_pk_ashrrev_i16 v217, 15, v217 op_sel_hi:[0,1]
    v_pk_add_i16 v218, v6, 16 op_sel_hi:[1,0]
    v_pk_ashrrev_i16 v218, 15, v218 op_sel_hi:[0,1]
    v_pk_add_i16 v219, v6, 20 op_sel_hi:[1,0]
    v_pk_ashrrev_i16 v219, 15, v219 op_sel_hi:[0,1]
    v_pk_add_i16 v220, v6, 1 op_sel_hi:[1,0]
    v_pk_ashrrev_i16 v220, 15, v220 op_sel_hi:[0,1]
    v_pk_add_i16 v221, v6, 5 op_sel_hi:[1,0]
    v_pk_ashrrev_i16 v221, 15, v221 op_sel_hi:[0,1]
    v_pk_add_i16 v222, v6, 17 op_sel_hi:[1,0]
    v_pk_ashrrev_i16 v222, 15, v222 op_sel_hi:[0,1]
    v_pk_add_i16 v223, v6, 21 op_sel_hi:[1,0]
    v_pk_ashrrev_i16 v223, 15, v223 op_sel_hi:[0,1]
    v_add_u32 v6, 159744, v0
    ds_write_b128 v6, v[216:219]
    ds_write_b128 v6, v[220:223] offset:1024
    v_and_b32 v6, 16, v0
    v_lshlrev_b32 v6, 4, v6
    v_add_u32 v6, 158208, v6
    v_mov_b32 v224, 0
    v_mov_b32 v225, 0
    v_mov_b32 v226, 0
    v_mov_b32 v227, 0
    ds_write_b128 v6, v[96:99]
    ds_write_b128 v6, v[224:227] offset:16
    s_mov_b32 s6, 268435456
    s_mov_b32 s7, 0x20000
    s_mov_b32 s26, 256
    s_mov_b32 s27, 0x20000
    s_lshl_b32 s47, s40, 11
    s_lshl_b32 s48, s39, 8
    s_add_u32 s47, s47, s48
    s_lshl_b32 s48, s3, 2
    s_add_u32 s47, s47, s48
    s_getreg_b32 s52, hwreg(HW_REG_XCC_ID)
    s_and_b32 s52, s52, 7
    s_mul_i32 s53, s52, s52
    s_lshl_b32 s53, s53, 14
    s_lshl_b32 s52, s52, 6
    s_add_u32 s52, s52, s53
    s_add_u32 s52, s52, 1
    s_lshl_b32 s53, s36, 5
    v_mov_b32 v8, s52
    v_lshlrev_b32 v6, 7, v1
    s_lshl_b32 s93, s37, 2
    s_lshl_b32 s48, s3, 0
    s_add_u32 s93, s93, s48
    s_lshl_b32 s48, s36, 13
    s_waitcnt lgkmcnt(0)
    s_bfe_u32 s58, s80, 0x30004
    s_add_u32 m0, s57, 8192
    s_lshl_b32 s58, s58, 7
    s_add_u32 s58, s58, s63
    buffer_load_dwordx4 v122, s[8:11], s58 offen offset:0 lds
    buffer_load_dwordx4 v239, s[8:11], s58 offen offset:1024 lds
    s_bfe_u32 s55, s80, 0x30004
    s_mul_i32 s55, s55, 196608
    s_add_u32 s55, s55, s62
    s_add_u32 m0, s56, 16384
    s_nop 0
    buffer_load_dwordx4 v5, s[16:19], s55 offen offset:1024 lds
    buffer_load_dwordx4 v5, s[16:19], s55 offen offset:2048 lds
    s_cmp_lg_u32 s3, 0
    s_cbranch_scc1 L_nochk
    s_mov_b64 exec, 1
    buffer_atomic_add v8, off, s[24:27], s53 sc1
    buffer_load_dword v123, off, s[4:7], s47
    s_mov_b64 exec, -1
L_nochk:
    s_cmp_lg_u32 s93, 1
    s_cbranch_scc1 L_nolead
    buffer_load_dwordx4 v[116:119], v6, s[4:7], s48 offen sc1
L_nolead:
    s_lshl_b32 s93, s93, 12
    s_cmp_lg_u32 s3, 2
    s_cbranch_scc1 L_nocode
    s_getpc_b64 s[50:51]
L_pc2:
    s_mul_i32 s48, s37, 2560
    v_lshl_add_u32 v6, v1, 7, s48
    v_min_u32 v6, L_pfend-L_pc2, v6
    s_mov_b64 exec, 0xfffff
    global_load_dword v123, v6, s[50:51]
    s_mov_b64 exec, -1
L_nocode:
    s_add_u32 s55, s55, 98304
    s_add_u32 m0, s56, 24576
    s_nop 0
    buffer_load_dwordx4 v5, s[16:19], s55 offen offset:1024 lds
    buffer_load_dwordx4 v5, s[16:19], s55 offen offset:2048 lds
    s_bfe_u32 s58, s80, 0x30008
    s_add_u32 m0, s57, 16384
    s_lshl_b32 s58, s58, 7
    s_add_u32 s58, s58, s63
    buffer_load_dwordx4 v122, s[8:11], s58 offen offset:0 lds
    buffer_load_dwordx4 v239, s[8:11], s58 offen offset:1024 lds
    s_bfe_u32 s55, s80, 0x30008
    s_mul_i32 s55, s55, 196608
    s_add_u32 s55, s55, s62
    s_add_u32 m0, s56, 32768
    s_nop 0
    buffer_load_dwordx4 v5, s[16:19], s55 offen offset:1024 lds
    buffer_load_dwordx4 v5, s[16:19], s55 offen offset:2048 lds
    s_waitcnt vmcnt(11) lgkmcnt(0)
    s_barrier
    ds_read_b64_tr_b16 a[64:65], v4 offset:0
    ds_read_b64_tr_b16 a[66:67], v4 offset:512
    ds_read_b64_tr_b16 a[128:129], v4 offset:1024
    ds_read_b64_tr_b16 a[130:131], v4 offset:1536
    ds_read_b128 v[40:43], v121 offset:0
    ds_read_b128 v[64:67], v120 offset:0
    ds_read_b128 v[68:71], v120 offset:2048
    ds_read_b128 v[72:75], v120 offset:4096
    ds_read_b128 v[76:79], v120 offset:6144
    s_waitcnt vmcnt(11) lgkmcnt(0)
    s_barrier
    v_mfma_f32_16x16x32_bf16 v[60:63], v[40:43], v[40:43], 0
    ds_read_b64_tr_b16 a[68:69], v4 offset:8192
    ds_read_b64_tr_b16 a[70:71], v4 offset:8704
    v_mfma_f32_16x16x32_bf16 v[112:115], v[40:43], v[96:99], 0
    ds_read_b64_tr_b16 a[132:133], v4 offset:9216
    ds_read_b64_tr_b16 a[134:135], v4 offset:9728
    v_mfma_f32_16x16x32_bf16 v[104:107], a[64:67], v[96:99], 0
    ds_read_b128 v[40:43], v242 offset:0
    ds_read_b128 v[80:83], v241 offset:0
    v_mfma_f32_16x16x32_bf16 v[108:111], v[96:99], a[128:131], 0
    ds_read_b128 v[84:87], v241 offset:2048
    ds_read_b128 v[88:91], v241 offset:4096
    s_add_u32 s55, s55, 98304
    v_mfma_f32_16x16x32_bf16 v[24:27], a[64:67], v[64:67], 0
    ds_read_b128 v[92:95], v241 offset:6144
    s_add_u32 m0, s56, 40960
    v_mfma_f32_16x16x32_bf16 v[28:31], a[64:67], v[68:71], 0
    buffer_load_dwordx4 v5, s[16:19], s55 offen offset:1024 lds
    v_mfma_f32_16x16x32_bf16 v[32:35], a[64:67], v[72:75], 0
    buffer_load_dwordx4 v5, s[16:19], s55 offen offset:2048 lds
    v_mfma_f32_16x16x32_bf16 v[36:39], a[64:67], v[76:79], 0
    s_bfe_u32 s58, s80, 0x3000c
    s_add_u32 m0, s57, 24576
    s_lshl_b32 s58, s58, 7
    s_add_u32 s58, s58, s63
    v_mfma_f32_16x16x32_bf16 v[44:47], v[64:67], a[128:131], 0
    buffer_load_dwordx4 v122, s[8:11], s58 offen offset:0 lds
    v_mfma_f32_16x16x32_bf16 v[48:51], v[68:71], a[128:131], 0
    v_mfma_f32_16x16x32_bf16 v[52:55], v[72:75], a[128:131], 0
    buffer_load_dwordx4 v239, s[8:11], s58 offen offset:1024 lds
    v_mfma_f32_16x16x32_bf16 v[56:59], v[76:79], a[128:131], 0
    s_waitcnt vmcnt(10) lgkmcnt(0)
    s_barrier
    v_mfma_f32_16x16x32_bf16 v[60:63], v[40:43], v[40:43], v[60:63]
    ds_read_b64_tr_b16 a[72:73], v4 offset:16384
    ds_read_b64_tr_b16 a[74:75], v4 offset:16896
    v_lshlrev_b32 v7, 7, v1
    v_add_u32 v255, s93, v7
    v_mfma_f32_16x16x32_bf16 v[112:115], v[40:43], v[96:99], v[112:115]
    ds_read_b64_tr_b16 a[136:137], v4 offset:17408
    ds_read_b64_tr_b16 a[138:139], v4 offset:17920
    s_bfe_u32 s55, s80, 0x3000c
    s_lshr_b32 s50, s3, 1
    v_mfma_f32_16x16x32_bf16 v[104:107], a[68:71], v[96:99], v[104:107]
    ds_read_b128 v[40:43], v121 offset:8192
    ds_read_b128 v[64:67], v120 offset:8192
    s_mul_i32 s55, s55, 196608
    s_and_b32 s51, s3, 1
    v_mfma_f32_16x16x32_bf16 v[108:111], v[96:99], a[132:135], v[108:111]
    ds_read_b128 v[68:71], v120 offset:10240
    ds_read_b128 v[72:75], v120 offset:12288
    s_add_u32 s55, s55, s62
    s_lshl_b32 s49, s40, 14
    v_mfma_f32_16x16x32_bf16 v[24:27], a[68:71], v[80:83], v[24:27]
    ds_read_b128 v[76:79], v120 offset:14336
    s_add_u32 m0, s56, 49152
    s_lshl_b32 s48, s39, 11
    s_add_u32 s49, s49, s48
    v_mfma_f32_16x16x32_bf16 v[28:31], a[68:71], v[84:87], v[28:31]
    buffer_load_dwordx4 v5, s[16:19], s55 offen offset:1024 lds
    s_lshl_b32 s48, s50, 19
    s_add_u32 s49, s49, s48
    v_mfma_f32_16x16x32_bf16 v[32:35], a[68:71], v[88:91], v[32:35]
    buffer_load_dwordx4 v5, s[16:19], s55 offen offset:2048 lds
    s_lshl_b32 s48, s51, 10
    s_add_u32 s49, s49, s48
    v_mfma_f32_16x16x32_bf16 v[36:39], a[68:71], v[92:95], v[36:39]
    s_add_u32 s55, s55, 98304
    s_add_u32 m0, s56, 57344
    s_add_u32 s49, s49, 19920896
    v_add_u32_e64 v254, s85, v7
    v_mfma_f32_16x16x32_bf16 v[44:47], v[80:83], a[132:135], v[44:47]
    buffer_load_dwordx4 v5, s[16:19], s55 offen offset:1024 lds
    v_mfma_f32_16x16x32_bf16 v[48:51], v[84:87], a[132:135], v[48:51]
    v_mfma_f32_16x16x32_bf16 v[52:55], v[88:91], a[132:135], v[52:55]
    buffer_load_dwordx4 v5, s[16:19], s55 offen offset:2048 lds
    v_mfma_f32_16x16x32_bf16 v[56:59], v[92:95], a[132:135], v[56:59]
    s_waitcnt vmcnt(12) lgkmcnt(0)
    s_barrier
    v_mfma_f32_16x16x32_bf16 v[60:63], v[40:43], v[40:43], v[60:63]
    ds_read_b64_tr_b16 a[76:77], v4 offset:24576
    ds_read_b64_tr_b16 a[78:79], v4 offset:25088
    v_add_u32 v6, s49, v7
    s_lshl_b32 s50, s40, 10
    v_mfma_f32_16x16x32_bf16 v[112:115], v[40:43], v[96:99], v[112:115]
    ds_read_b64_tr_b16 a[140:141], v4 offset:25600
    ds_read_b64_tr_b16 a[142:143], v4 offset:26112
    s_bfe_u32 s58, s80, 0x30010
    s_lshl_b32 s48, s51, 16
    v_mfma_f32_16x16x32_bf16 v[104:107], a[72:75], v[96:99], v[104:107]
    ds_read_b128 v[40:43], v242 offset:8192
    ds_read_b128 v[80:83], v241 offset:8192
    s_add_u32 m0, s57, 32768
    s_add_u32 s50, s50, s48
    v_mfma_f32_16x16x32_bf16 v[108:111], v[96:99], a[136:139], v[108:111]
    ds_read_b128 v[84:87], v241 offset:10240
    ds_read_b128 v[88:91], v241 offset:12288
    s_lshl_b32 s58, s58, 7
    s_lshl_b32 s48, s39, 7
    v_mfma_f32_16x16x32_bf16 v[24:27], a[72:75], v[64:67], v[24:27]
    ds_read_b128 v[92:95], v241 offset:14336
    s_add_u32 s58, s58, s63
    s_add_u32 s50, s50, s48
    s_add_u32 s50, s50, 20971520
    v_mfma_f32_16x16x32_bf16 v[28:31], a[72:75], v[68:71], v[28:31]
    buffer_load_dwordx4 v122, s[8:11], s58 offen offset:0 lds
    v_cmp_gt_u32 s[48:49], 16, v1
    s_nop 1
    v_cndmask_b32 v254, v6, v254, s[48:49]
    v_mfma_f32_16x16x32_bf16 v[32:35], a[72:75], v[72:75], v[32:35]
    buffer_load_dwordx4 v239, s[8:11], s58 offen offset:1024 lds
    v_writelane_b32 v254, s50, 24
    s_lshl_b32 s50, s45, 10
    v_mfma_f32_16x16x32_bf16 v[36:39], a[72:75], v[76:79], v[36:39]
    s_bfe_u32 s55, s80, 0x30010
    s_mul_i32 s55, s55, 196608
    s_add_u32 s55, s55, s62
    s_add_u32 m0, s56, 65536
    v_mfma_f32_16x16x32_bf16 v[44:47], v[64:67], a[136:139], v[44:47]
    buffer_load_dwordx4 v5, s[16:19], s55 offen offset:1024 lds
    s_lshl_b32 s48, s39, 7
    s_add_u32 s50, s50, s48
    v_mfma_f32_16x16x32_bf16 v[48:51], v[68:71], a[136:139], v[48:51]
    v_mfma_f32_16x16x32_bf16 v[52:55], v[72:75], a[136:139], v[52:55]
    buffer_load_dwordx4 v5, s[16:19], s55 offen offset:2048 lds
    v_mfma_f32_16x16x32_bf16 v[56:59], v[76:79], a[136:139], v[56:59]
    s_waitcnt vmcnt(12) lgkmcnt(0)
    s_barrier
    v_mfma_f32_16x16x32_bf16 v[60:63], v[40:43], v[40:43], v[60:63]
    ds_read_b64_tr_b16 a[80:81], v4 offset:32768
    ds_read_b64_tr_b16 a[82:83], v4 offset:33280
    s_add_u32 s50, s50, 18874368
    v_writelane_b32 v254, s50, 25
    v_mfma_f32_16x16x32_bf16 v[112:115], v[40:43], v[96:99], v[112:115]
    ds_read_b64_tr_b16 a[144:145], v4 offset:33792
    ds_read_b64_tr_b16 a[146:147], v4 offset:34304
    s_bfe_u32 s58, s80, 0x30014
    s_lshr_b32 s48, s93, 3
    v_mfma_f32_16x16x32_bf16 v[104:107], a[76:79], v[96:99], v[104:107]
    ds_read_b128 v[40:43], v121 offset:16384
    ds_read_b128 v[64:67], v120 offset:16384
    s_add_u32 m0, s57, 40960
    v_add_u32_e64 v253, s48, v7
    v_mfma_f32_16x16x32_bf16 v[108:111], v[96:99], a[140:143], v[108:111]
    ds_read_b128 v[68:71], v120 offset:18432
    ds_read_b128 v[72:75], v120 offset:20480
    s_lshl_b32 s58, s58, 7
    v_min_u32 v253, L_pfend-L_qa_e, v253
    v_mfma_f32_16x16x32_bf16 v[24:27], a[76:79], v[80:83], v[24:27]
    ds_read_b128 v[76:79], v120 offset:22528
    s_add_u32 s58, s58, s63
    v_and_b32 v6, 7, v1
    s_lshr_b32 s48, s93, 17
    v_mfma_f32_16x16x32_bf16 v[28:31], a[76:79], v[84:87], v[28:31]
    buffer_load_dwordx4 v122, s[8:11], s58 offen offset:0 lds
    v_lshlrev_b32 v6, 1, v6
    v_xor_b32 v250, s48, v6
    v_mfma_f32_16x16x32_bf16 v[32:35], a[76:79], v[88:91], v[32:35]
    buffer_load_dwordx4 v239, s[8:11], s58 offen offset:1024 lds
    s_bfe_u32 s48, s93, 0x5000c
    s_mul_i32 s48, s48, 3072
    v_mfma_f32_16x16x32_bf16 v[36:39], a[76:79], v[92:95], v[36:39]
    s_add_u32 s55, s55, 98304
    s_add_u32 m0, s56, 73728
    v_add_u32_e64 v249, s48, v7
    s_mov_b32 s79, 98304
    v_mfma_f32_16x16x32_bf16 v[44:47], v[80:83], a[140:143], v[44:47]
    buffer_load_dwordx4 v5, s[16:19], s55 offen offset:1024 lds
    v_mfma_f32_16x16x32_bf16 v[48:51], v[84:87], a[140:143], v[48:51]
    v_mfma_f32_16x16x32_bf16 v[52:55], v[88:91], a[140:143], v[52:55]
    buffer_load_dwordx4 v5, s[16:19], s55 offen offset:2048 lds
    v_mfma_f32_16x16x32_bf16 v[56:59], v[92:95], a[140:143], v[56:59]
    s_waitcnt vmcnt(14) lgkmcnt(0)
    s_barrier
    v_mfma_f32_16x16x32_bf16 v[60:63], v[40:43], v[40:43], v[60:63]
    ds_read_b64_tr_b16 a[84:85], v4 offset:40960
    ds_read_b64_tr_b16 a[86:87], v4 offset:41472
    v_mfma_f32_16x16x32_bf16 v[112:115], v[40:43], v[96:99], v[112:115]
    ds_read_b64_tr_b16 a[148:149], v4 offset:41984
    ds_read_b64_tr_b16 a[150:151], v4 offset:42496
    s_bfe_u32 s58, s80, 0x30018
    v_mfma_f32_16x16x32_bf16 v[104:107], a[80:83], v[96:99], v[104:107]
    ds_read_b128 v[40:43], v242 offset:16384
    ds_read_b128 v[80:83], v241 offset:16384
    s_add_u32 m0, s57, 49152
    v_mfma_f32_16x16x32_bf16 v[108:111], v[96:99], a[144:147], v[108:111]
    ds_read_b128 v[84:87], v241 offset:18432
    ds_read_b128 v[88:91], v241 offset:20480
    s_lshl_b32 s58, s58, 7
    v_mfma_f32_16x16x32_bf16 v[24:27], a[80:83], v[64:67], v[24:27]
    ds_read_b128 v[92:95], v241 offset:22528
    s_add_u32 s58, s58, s63
    v_mfma_f32_16x16x32_bf16 v[28:31], a[80:83], v[68:71], v[28:31]
    buffer_load_dwordx4 v122, s[8:11], s58 offen offset:0 lds
    v_mfma_f32_16x16x32_bf16 v[32:35], a[80:83], v[72:75], v[32:35]
    buffer_load_dwordx4 v239, s[8:11], s58 offen offset:1024 lds
    v_mfma_f32_16x16x32_bf16 v[36:39], a[80:83], v[76:79], v[36:39]
    s_bfe_u32 s55, s80, 0x30014
    s_mul_i32 s55, s55, 196608
    s_add_u32 s55, s55, s62
    s_add_u32 m0, s56, 81920
    v_mfma_f32_16x16x32_bf16 v[44:47], v[64:67], a[144:147], v[44:47]
    buffer_load_dwordx4 v5, s[16:19], s55 offen offset:1024 lds
    v_mfma_f32_16x16x32_bf16 v[48:51], v[68:71], a[144:147], v[48:51]
    s_cmp_lg_u32 s93, 4096
    s_cbranch_scc1 ep_2_done
    s_waitcnt vmcnt(25)
    v_lshrrev_b32 v116, 8, v116
    v_lshrrev_b32 v117, 8, v117
    v_lshrrev_b32 v118, 8, v118
    v_lshrrev_b32 v119, 8, v119
    s_mov_b32 s48, 0
ep_2:
    s_add_u32 s48, s48, 1
    v_cmp_eq_u32 vcc, s48, v116
    v_cmp_eq_u32 s[50:51], s48, v117
    s_nop 0
    s_or_b64 vcc, vcc, s[50:51]
    v_cmp_eq_u32 s[50:51], s48, v118
    s_nop 0
    s_or_b64 vcc, vcc, s[50:51]
    v_cmp_eq_u32 s[50:51], s48, v119
    s_nop 0
    s_or_b64 vcc, vcc, s[50:51]
    s_nop 1
    s_cbranch_scc1 ep_2
    s_lshl_b32 s48, s48, 8
    v_mov_b32 v6, s48
    s_mov_b64 exec, 1
    buffer_store_dword v6, off, s[24:27], s53 offset:4 sc1
    s_mov_b64 exec, -1
ep_2_done:
    v_mfma_f32_16x16x32_bf16 v[52:55], v[72:75], a[144:147], v[52:55]
    buffer_load_dwordx4 v5, s[16:19], s55 offen offset:2048 lds
    v_bfe_u32 v6, v1, 4, 1
    v_mfma_f32_16x16x32_bf16 v[56:59], v[76:79], a[144:147], v[56:59]
    s_and_b32 s48, s3, 1
    s_waitcnt vmcnt(14) lgkmcnt(0)
    s_barrier
    v_mfma_f32_16x16x32_bf16 v[60:63], v[40:43], v[40:43], v[60:63]
    ds_read_b64_tr_b16 a[88:89], v4 offset:49152
    ds_read_b64_tr_b16 a[90:91], v4 offset:49664
    s_lshl_b32 s48, s48, 1
    v_mfma_f32_16x16x32_bf16 v[112:115], v[40:43], v[96:99], v[112:115]
    ds_read_b64_tr_b16 a[152:153], v4 offset:50176
    ds_read_b64_tr_b16 a[154:155], v4 offset:50688
    s_bfe_u32 s58, s80, 0x3001c
    v_mfma_f32_16x16x32_bf16 v[104:107], a[84:87], v[96:99], v[104:107]
    ds_read_b128 v[40:43], v121 offset:24576
    ds_read_b128 v[64:67], v120 offset:24576
    s_add_u32 m0, s57, 57344
    v_mfma_f32_16x16x32_bf16 v[108:111], v[96:99], a[148:151], v[108:111]
    ds_read_b128 v[68:71], v120 offset:26624
    ds_read_b128 v[72:75], v120 offset:28672
    s_lshl_b32 s58, s58, 7
    v_mfma_f32_16x16x32_bf16 v[24:27], a[84:87], v[80:83], v[24:27]
    ds_read_b128 v[76:79], v120 offset:30720
    s_add_u32 s58, s58, s63
    v_or_b32_e64 v6, s48, v6
    v_mfma_f32_16x16x32_bf16 v[28:31], a[84:87], v[84:87], v[28:31]
    buffer_load_dwordx4 v122, s[8:11], s58 offen offset:0 lds
    v_lshlrev_b32_e64 v6, 1, v6
    v_mfma_f32_16x16x32_bf16 v[32:35], a[84:87], v[88:91], v[32:35]
    buffer_load_dwordx4 v239, s[8:11], s58 offen offset:1024 lds
    v_mfma_f32_16x16x32_bf16 v[36:39], a[84:87], v[92:95], v[36:39]
    s_add_u32 s55, s55, 98304
    s_add_u32 m0, s56, 0
    v_mfma_f32_16x16x32_bf16 v[44:47], v[80:83], a[148:151], v[44:47]
    buffer_load_dwordx4 v5, s[16:19], s55 offen offset:1024 lds
    v_mfma_f32_16x16x32_bf16 v[48:51], v[84:87], a[148:151], v[48:51]
    v_mfma_f32_16x16x32_bf16 v[52:55], v[88:91], a[148:151], v[52:55]
    buffer_load_dwordx4 v5, s[16:19], s55 offen offset:2048 lds
    v_mfma_f32_16x16x32_bf16 v[56:59], v[92:95], a[148:151], v[56:59]
    s_waitcnt vmcnt(16) lgkmcnt(0)
    s_barrier
    v_mfma_f32_16x16x32_bf16 v[60:63], v[40:43], v[40:43], v[60:63]
    ds_read_b64_tr_b16 a[92:93], v4 offset:57344
    ds_read_b64_tr_b16 a[94:95], v4 offset:57856
    v_and_b32 v238, 7, v1
    v_mfma_f32_16x16x32_bf16 v[112:115], v[40:43], v[96:99], v[112:115]
    ds_read_b64_tr_b16 a[156:157], v4 offset:58368
    ds_read_b64_tr_b16 a[158:159], v4 offset:58880
    s_bfe_u32 s55, s80, 0x30018
    v_mfma_f32_16x16x32_bf16 v[104:107], a[88:91], v[96:99], v[104:107]
    ds_read_b128 v[40:43], v242 offset:24576
    ds_read_b128 v[80:83], v241 offset:24576
    s_mul_i32 s55, s55, 196608
    v_mfma_f32_16x16x32_bf16 v[108:111], v[96:99], a[152:155], v[108:111]
    ds_read_b128 v[84:87], v241 offset:26624
    ds_read_b128 v[88:91], v241 offset:28672
    s_add_u32 s55, s55, s62
    v_mfma_f32_16x16x32_bf16 v[24:27], a[88:91], v[64:67], v[24:27]
    ds_read_b128 v[92:95], v241 offset:30720
    s_add_u32 m0, s56, 8192
    v_xor_b32 v238, v238, v6
    v_mfma_f32_16x16x32_bf16 v[28:31], a[88:91], v[68:71], v[28:31]
    buffer_load_dwordx4 v5, s[16:19], s55 offen offset:1024 lds
    v_lshlrev_b32_e64 v238, 4, v238
    v_mfma_f32_16x16x32_bf16 v[32:35], a[88:91], v[72:75], v[32:35]
    buffer_load_dwordx4 v5, s[16:19], s55 offen offset:2048 lds
    v_mfma_f32_16x16x32_bf16 v[36:39], a[88:91], v[76:79], v[36:39]
    s_add_u32 s55, s55, 98304
    s_add_u32 m0, s56, 16384
    v_mfma_f32_16x16x32_bf16 v[44:47], v[64:67], a[152:155], v[44:47]
    buffer_load_dwordx4 v5, s[16:19], s55 offen offset:1024 lds
    v_mfma_f32_16x16x32_bf16 v[48:51], v[68:71], a[152:155], v[48:51]
    v_mfma_f32_16x16x32_bf16 v[52:55], v[72:75], a[152:155], v[52:55]
    buffer_load_dwordx4 v5, s[16:19], s55 offen offset:2048 lds
    v_mfma_f32_16x16x32_bf16 v[56:59], v[76:79], a[152:155], v[56:59]
    s_waitcnt vmcnt(16) lgkmcnt(0)
    s_barrier
    v_mfma_f32_16x16x32_bf16 v[60:63], v[40:43], v[40:43], v[60:63]
    ds_read_b64_tr_b16 a[96:97], v240 offset:0
    ds_read_b64_tr_b16 a[98:99], v240 offset:512
    v_lshrrev_b32_e64 v6, 3, v1
    v_mfma_f32_16x16x32_bf16 v[112:115], v[40:43], v[96:99], v[112:115]
    ds_read_b64_tr_b16 a[160:161], v240 offset:1024
    ds_read_b64_tr_b16 a[162:163], v240 offset:1536
    s_bfe_u32 s55, s80, 0x3001c
    v_mfma_f32_16x16x32_bf16 v[104:107], a[92:95], v[96:99], v[104:107]
    ds_read_b128 v[40:43], v121 offset:32768
    s_mul_i32 s55, s55, 196608
    v_mul_u32_u24 v6, 1024, v6
    v_mfma_f32_16x16x32_bf16 v[108:111], v[96:99], a[156:159], v[108:111]
    ds_read_b128 v[160:163], v242 offset:32768
    ds_read_b128 v[64:67], v120 offset:32768
    ds_read_b128 v[68:71], v120 offset:34816
    s_add_u32 s55, s55, s62
    v_mfma_f32_16x16x32_bf16 v[24:27], a[92:95], v[80:83], v[24:27]
    ds_read_b128 v[72:75], v120 offset:36864
    ds_read_b128 v[76:79], v120 offset:38912
    s_add_u32 m0, s56, 24576
    v_mfma_f32_16x16x32_bf16 v[28:31], a[92:95], v[84:87], v[28:31]
    buffer_load_dwordx4 v5, s[16:19], s55 offen offset:1024 lds
    v_add_u32 v238, v238, v6
    v_mfma_f32_16x16x32_bf16 v[32:35], a[92:95], v[88:91], v[32:35]
    buffer_load_dwordx4 v5, s[16:19], s55 offen offset:2048 lds
    s_lshl_b32 s0, s3, 13
    v_mfma_f32_16x16x32_bf16 v[36:39], a[92:95], v[92:95], v[36:39]
    s_add_u32 s55, s55, 98304
    s_add_u32 m0, s56, 32768
    s_lshl_b32 s1, s39, 7
    v_mfma_f32_16x16x32_bf16 v[44:47], v[80:83], a[156:159], v[44:47]
    buffer_load_dwordx4 v5, s[16:19], s55 offen offset:1024 lds
    v_mfma_f32_16x16x32_bf16 v[48:51], v[84:87], a[156:159], v[48:51]
    v_mfma_f32_16x16x32_bf16 v[52:55], v[88:91], a[156:159], v[52:55]
    buffer_load_dwordx4 v5, s[16:19], s55 offen offset:2048 lds
    v_mfma_f32_16x16x32_bf16 v[56:59], v[92:95], a[156:159], v[56:59]
    s_waitcnt vmcnt(16) lgkmcnt(0)
    s_barrier
    v_mfma_f32_16x16x32_bf16 v[60:63], v[40:43], v[40:43], v[60:63]
    ds_read_b64_tr_b16 a[100:101], v240 offset:8192
    ds_read_b64_tr_b16 a[102:103], v240 offset:8704
    v_mfma_f32_16x16x32_bf16 v[112:115], v[40:43], v[96:99], v[112:115]
    ds_read_b64_tr_b16 a[164:165], v240 offset:9216
    ds_read_b64_tr_b16 a[166:167], v240 offset:9728
    s_bfe_u32 s55, s80, 0x30000
    v_mfma_f32_16x16x32_bf16 v[60:63], v[160:163], v[160:163], v[60:63]
    ds_read_b128 v[40:43], v121 offset:40960
    s_mul_i32 s55, s55, 196608
    v_mfma_f32_16x16x32_bf16 v[112:115], v[160:163], v[96:99], v[112:115]
    ds_read_b128 v[160:163], v242 offset:40960
    ds_read_b128 v[80:83], v241 offset:32768
    ds_read_b128 v[84:87], v241 offset:34816
    s_add_u32 s55, s55, s62
    v_mfma_f32_16x16x32_bf16 v[104:107], a[96:99], v[96:99], v[104:107]
    ds_read_b128 v[88:91], v241 offset:36864
    ds_read_b128 v[92:95], v241 offset:38912
    s_add_u32 m0, s56, 41984
    v_mfma_f32_16x16x32_bf16 v[108:111], v[96:99], a[160:163], v[108:111]
    buffer_load_dwordx4 v5, s[16:19], s55 offen lds
    v_mfma_f32_16x16x32_bf16 v[24:27], a[96:99], v[64:67], v[24:27]
    s_add_u32 s55, s55, 98304
    s_add_u32 s0, s0, s1
    v_mfma_f32_16x16x32_bf16 v[28:31], a[96:99], v[68:71], v[28:31]
    s_add_u32 m0, s56, 43008
    s_lshl_b32 s1, s3, 10
    v_mfma_f32_16x16x32_bf16 v[32:35], a[96:99], v[72:75], v[32:35]
    buffer_load_dwordx4 v5, s[16:19], s55 offen lds
    v_mfma_f32_16x16x32_bf16 v[36:39], a[96:99], v[76:79], v[36:39]
    s_bfe_u32 s55, s80, 0x30004
    s_mul_i32 s55, s55, 196608
    s_add_u32 s55, s55, s62
    v_mfma_f32_16x16x32_bf16 v[44:47], v[64:67], a[160:163], v[44:47]
    s_add_u32 m0, s56, 50176
    v_and_b32_e64 v251, 7, v1
    v_mfma_f32_16x16x32_bf16 v[48:51], v[68:71], a[160:163], v[48:51]
    buffer_load_dwordx4 v5, s[16:19], s55 offen lds
    v_mfma_f32_16x16x32_bf16 v[52:55], v[72:75], a[160:163], v[52:55]
    v_lshlrev_b32_e64 v251, 7, v251
    v_bfe_u32 v6, v1, 3, 1
    v_mfma_f32_16x16x32_bf16 v[56:59], v[76:79], a[160:163], v[56:59]
    s_waitcnt vmcnt(15) lgkmcnt(0)
    s_barrier
    v_mfma_f32_16x16x32_bf16 v[60:63], v[40:43], v[40:43], v[60:63]
    ds_read_b64_tr_b16 a[104:105], v240 offset:16384
    ds_read_b64_tr_b16 a[106:107], v240 offset:16896
    v_mfma_f32_16x16x32_bf16 v[112:115], v[40:43], v[96:99], v[112:115]
    ds_read_b64_tr_b16 a[168:169], v240 offset:17408
    ds_read_b64_tr_b16 a[170:171], v240 offset:17920
    v_mfma_f32_16x16x32_bf16 v[60:63], v[160:163], v[160:163], v[60:63]
    ds_read_b128 v[40:43], v121 offset:49152
    v_lshl_add_u32 v251, v6, 15, v251
    v_mfma_f32_16x16x32_bf16 v[112:115], v[160:163], v[96:99], v[112:115]
    ds_read_b128 v[160:163], v242 offset:49152
    ds_read_b128 v[64:67], v120 offset:40960
    ds_read_b128 v[68:71], v120 offset:43008
    s_add_u32 s55, s55, 98304
    v_mfma_f32_16x16x32_bf16 v[104:107], a[100:103], v[96:99], v[104:107]
    ds_read_b128 v[72:75], v120 offset:45056
    ds_read_b128 v[76:79], v120 offset:47104
    s_add_u32 m0, s56, 51200
    v_mfma_f32_16x16x32_bf16 v[108:111], v[96:99], a[164:167], v[108:111]
    buffer_load_dwordx4 v5, s[16:19], s55 offen lds
    v_mfma_f32_16x16x32_bf16 v[24:27], a[100:103], v[80:83], v[24:27]
    s_bfe_u32 s55, s80, 0x30008
    s_mul_i32 s55, s55, 196608
    s_add_u32 s55, s55, s62
    v_mfma_f32_16x16x32_bf16 v[28:31], a[100:103], v[84:87], v[28:31]
    s_add_u32 m0, s56, 58368
    v_lshlrev_b32 v248, 5, v1
    v_mfma_f32_16x16x32_bf16 v[32:35], a[100:103], v[88:91], v[32:35]
    buffer_load_dwordx4 v5, s[16:19], s55 offen lds
    v_mfma_f32_16x16x32_bf16 v[36:39], a[100:103], v[92:95], v[36:39]
    s_add_u32 s55, s55, 98304
    v_sub_u32_e64 v248, s53, v248
    v_mfma_f32_16x16x32_bf16 v[44:47], v[80:83], a[164:167], v[44:47]
    s_add_u32 m0, s56, 59392
    v_and_b32 v248, 0xff, v248
    v_mfma_f32_16x16x32_bf16 v[48:51], v[84:87], a[164:167], v[48:51]
    buffer_load_dwordx4 v5, s[16:19], s55 offen lds
    v_mfma_f32_16x16x32_bf16 v[52:55], v[88:91], a[164:167], v[52:55]
    v_mfma_f32_16x16x32_bf16 v[56:59], v[92:95], a[164:167], v[56:59]
    s_waitcnt vmcnt(14) lgkmcnt(0)
    s_barrier
    v_mfma_f32_16x16x32_bf16 v[60:63], v[40:43], v[40:43], v[60:63]
    ds_read_b64_tr_b16 a[108:109], v4 offset:0
    ds_read_b64_tr_b16 a[110:111], v4 offset:512
    s_lshl_b32 s59, s3, 7
    v_mfma_f32_16x16x32_bf16 v[112:115], v[40:43], v[96:99], v[112:115]
    ds_read_b64_tr_b16 a[172:173], v4 offset:1024
    ds_read_b64_tr_b16 a[174:175], v4 offset:1536
    s_bfe_u32 s55, s80, 0x3000c
    v_mfma_f32_16x16x32_bf16 v[60:63], v[160:163], v[160:163], v[60:63]
    ds_read_b128 v[40:43], v121 offset:57344
    s_mul_i32 s55, s55, 196608
    v_lshl_add_u32 v245, v2, 3, s59
    v_mfma_f32_16x16x32_bf16 v[112:115], v[160:163], v[96:99], v[112:115]
    ds_read_b128 v[160:163], v242 offset:57344
    ds_read_b128 v[80:83], v241 offset:40960
    ds_read_b128 v[84:87], v241 offset:43008
    s_add_u32 s55, s55, s62
    v_mfma_f32_16x16x32_bf16 v[104:107], a[104:107], v[96:99], v[104:107]
    ds_read_b128 v[88:91], v241 offset:45056
    ds_read_b128 v[92:95], v241 offset:47104
    s_add_u32 m0, s56, 66560
    v_mfma_f32_16x16x32_bf16 v[108:111], v[96:99], a[168:171], v[108:111]
    buffer_load_dwordx4 v5, s[16:19], s55 offen lds
    v_add_u32 v244, 155648, v245
    v_mfma_f32_16x16x32_bf16 v[24:27], a[104:107], v[64:67], v[24:27]
    s_add_u32 s55, s55, 98304
    v_lshrrev_b32_e64 v245, 1, v245
    v_add_u32 v245, 156160, v245
    v_mfma_f32_16x16x32_bf16 v[28:31], a[104:107], v[68:71], v[28:31]
    s_add_u32 m0, s56, 67584
    v_lshlrev_b32_e64 v243, 3, v2
    v_add_u32 v243, 155648, v243
    v_mfma_f32_16x16x32_bf16 v[32:35], a[104:107], v[72:75], v[32:35]
    buffer_load_dwordx4 v5, s[16:19], s55 offen lds
    v_mfma_f32_16x16x32_bf16 v[36:39], a[104:107], v[76:79], v[36:39]
    s_bfe_u32 s55, s80, 0x30010
    s_mul_i32 s55, s55, 196608
    s_add_u32 s55, s55, s62
    v_mfma_f32_16x16x32_bf16 v[44:47], v[64:67], a[168:171], v[44:47]
    s_add_u32 m0, s56, 74752
    v_mfma_f32_16x16x32_bf16 v[48:51], v[68:71], a[168:171], v[48:51]
    buffer_load_dwordx4 v5, s[16:19], s55 offen lds
    v_mfma_f32_16x16x32_bf16 v[52:55], v[72:75], a[168:171], v[52:55]
    v_mfma_f32_16x16x32_bf16 v[56:59], v[76:79], a[168:171], v[56:59]
    s_waitcnt vmcnt(15) lgkmcnt(0)
    s_barrier
    v_mfma_f32_16x16x32_bf16 v[60:63], v[40:43], v[40:43], v[60:63]
    ds_read_b64_tr_b16 a[112:113], v4 offset:8192
    ds_read_b64_tr_b16 a[114:115], v4 offset:8704
    v_mfma_f32_16x16x32_bf16 v[112:115], v[40:43], v[96:99], v[112:115]
    ds_read_b64_tr_b16 a[176:177], v4 offset:9216
    ds_read_b64_tr_b16 a[178:179], v4 offset:9728
    v_mfma_f32_16x16x32_bf16 v[60:63], v[160:163], v[160:163], v[60:63]
    ds_read_b128 v[64:67], v120 offset:49152
    ds_read_b128 v[68:71], v120 offset:51200
    s_add_u32 s55, s55, 98304
    v_mfma_f32_16x16x32_bf16 v[112:115], v[160:163], v[96:99], v[112:115]
    ds_read_b128 v[72:75], v120 offset:53248
    ds_read_b128 v[76:79], v120 offset:55296
    s_add_u32 m0, s56, 75776
    v_mfma_f32_16x16x32_bf16 v[104:107], a[108:111], v[96:99], v[104:107]
    buffer_load_dwordx4 v5, s[16:19], s55 offen lds
    v_mfma_f32_16x16x32_bf16 v[108:111], v[96:99], a[172:175], v[108:111]
    s_bfe_u32 s55, s80, 0x30014
    s_mul_i32 s55, s55, 196608
    s_add_u32 s55, s55, s62
    v_mfma_f32_16x16x32_bf16 v[24:27], a[108:111], v[80:83], v[24:27]
    s_add_u32 m0, s56, 82944
    v_and_b32_e64 v6, 3, v2
    v_mfma_f32_16x16x32_bf16 v[28:31], a[108:111], v[84:87], v[28:31]
    buffer_load_dwordx4 v5, s[16:19], s55 offen lds
    v_mfma_f32_16x16x32_bf16 v[32:35], a[108:111], v[88:91], v[32:35]
    s_add_u32 s55, s55, 98304
    v_cmp_eq_u32 s[48:49], 1, v6
    v_mfma_f32_16x16x32_bf16 v[36:39], a[108:111], v[92:95], v[36:39]
    s_add_u32 m0, s56, 83968
    v_cmp_eq_u32 s[50:51], 2, v6
    v_mfma_f32_16x16x32_bf16 v[44:47], v[80:83], a[172:175], v[44:47]
    buffer_load_dwordx4 v5, s[16:19], s55 offen lds
    v_mfma_f32_16x16x32_bf16 v[48:51], v[84:87], a[172:175], v[48:51]
    v_cmp_eq_u32 s[28:29], 3, v6
    v_lshrrev_b32 v6, 2, v2
    v_mfma_f32_16x16x32_bf16 v[52:55], v[88:91], a[172:175], v[52:55]
    v_cmp_eq_u32 vcc, v6, v3
    v_mfma_f32_16x16x32_bf16 v[56:59], v[92:95], a[172:175], v[56:59]
    s_waitcnt vmcnt(16) lgkmcnt(0)
    s_barrier
    v_mfma_f32_16x16x32_bf16 v[104:107], a[112:115], v[96:99], v[104:107]
    ds_read_b64_tr_b16 a[116:117], v4 offset:16384
    ds_read_b64_tr_b16 a[118:119], v4 offset:16896
    s_bfe_u32 s55, s80, 0x30018
    v_lshlrev_b32_e64 v121, 4, v3
    v_mfma_f32_16x16x32_bf16 v[108:111], v[96:99], a[176:179], v[108:111]
    ds_read_b64_tr_b16 a[180:181], v4 offset:17408
    ds_read_b64_tr_b16 a[182:183], v4 offset:17920
    s_mul_i32 s55, s55, 196608
    v_add_u32 v121, 156160, v121
    v_mfma_f32_16x16x32_bf16 v[24:27], a[112:115], v[64:67], v[24:27]
    ds_read_b128 v[80:83], v241 offset:49152
    ds_read_b128 v[84:87], v241 offset:51200
    s_add_u32 s55, s55, s62
    v_cndmask_b32 v60, v60, v61, s[48:49]
    v_mfma_f32_16x16x32_bf16 v[28:31], a[112:115], v[68:71], v[28:31]
    ds_read_b128 v[88:91], v241 offset:53248
    ds_read_b128 v[92:95], v241 offset:55296
    s_add_u32 m0, s56, 1024
    v_cndmask_b32 v112, v112, v113, s[48:49]
    v_mfma_f32_16x16x32_bf16 v[32:35], a[112:115], v[72:75], v[32:35]
    buffer_load_dwordx4 v5, s[16:19], s55 offen lds
    v_cndmask_b32 v60, v60, v62, s[50:51]
    v_cndmask_b32 v112, v112, v114, s[50:51]
    v_mfma_f32_16x16x32_bf16 v[36:39], a[112:115], v[76:79], v[36:39]
    s_add_u32 s55, s55, 98304
    s_add_u32 m0, s56, 2048
    v_cndmask_b32 v60, v60, v63, s[28:29]
    v_cndmask_b32 v112, v112, v115, s[28:29]
    v_mfma_f32_16x16x32_bf16 v[44:47], v[64:67], a[176:179], v[44:47]
    buffer_load_dwordx4 v5, s[16:19], s55 offen lds
    v_mfma_f32_16x16x32_bf16 v[48:51], v[68:71], a[176:179], v[48:51]
    s_bfe_u32 s55, s80, 0x3001c
    s_mul_i32 s55, s55, 196608
    s_add_u32 s55, s55, s62
    s_add_u32 m0, s56, 9216
    v_mfma_f32_16x16x32_bf16 v[52:55], v[72:75], a[176:179], v[52:55]
    buffer_load_dwordx4 v5, s[16:19], s55 offen lds
    v_mfma_f32_16x16x32_bf16 v[56:59], v[76:79], a[176:179], v[56:59]
    s_waitcnt vmcnt(17) lgkmcnt(0)
    s_barrier
    v_mfma_f32_16x16x32_bf16 v[104:107], a[116:119], v[96:99], v[104:107]
    ds_read_b64_tr_b16 a[120:121], v4 offset:24576
    ds_read_b64_tr_b16 a[122:123], v4 offset:25088
    v_mov_b32_e64 v113, v60
    v_mfma_f32_16x16x32_bf16 v[108:111], v[96:99], a[180:183], v[108:111]
    ds_read_b64_tr_b16 a[184:185], v4 offset:25600
    ds_read_b64_tr_b16 a[186:187], v4 offset:26112
    v_mul_f32 v112, 0x3b000000, v112
    v_mfma_f32_16x16x32_bf16 v[24:27], a[116:119], v[80:83], v[24:27]
    ds_read_b128 v[64:67], v120 offset:57344
    ds_read_b128 v[68:71], v120 offset:59392
    s_add_u32 s55, s55, 98304
    v_mfma_f32_16x16x32_bf16 v[28:31], a[116:119], v[84:87], v[28:31]
    ds_read_b128 v[72:75], v120 offset:61440
    ds_read_b128 v[76:79], v120 offset:63488
    s_add_u32 m0, s56, 10240
    v_mfma_f32_16x16x32_bf16 v[32:35], a[116:119], v[88:91], v[32:35]
    buffer_load_dwordx4 v5, s[16:19], s55 offen lds
    v_mul_f32 v113, 0x3b000000, v113
    v_mfma_f32_16x16x32_bf16 v[36:39], a[116:119], v[92:95], v[36:39]
    v_fma_f32 v113, -v112, v112, v113
    v_max_f32_e64 v113, 0, v113
    v_cvt_pk_bf16_f32 v6, v112, v113
    v_mfma_f32_16x16x32_bf16 v[44:47], v[80:83], a[180:183], v[44:47]
    v_lshlrev_b32 v237, 6, v1
    v_lshlrev_b32 v112, 16, v6
    v_and_b32 v113, 0xffff0000, v6
    v_mfma_f32_16x16x32_bf16 v[48:51], v[84:87], a[180:183], v[48:51]
    buffer_load_dword v123, v237, s[20:23], s93 offen offset:0
    v_mfma_f32_16x16x32_bf16 v[52:55], v[88:91], a[180:183], v[52:55]
    v_mfma_f32_16x16x32_bf16 v[56:59], v[92:95], a[180:183], v[56:59]
    s_waitcnt vmcnt(17) lgkmcnt(0)
    s_barrier
    v_mfma_f32_16x16x32_bf16 v[104:107], a[120:123], v[96:99], v[104:107]
    ds_read_b64_tr_b16 a[124:125], v4 offset:32768
    ds_read_b64_tr_b16 a[126:127], v4 offset:33280
    v_add_f32 v113, 0x3727c5ac, v113
    v_mfma_f32_16x16x32_bf16 v[108:111], v[96:99], a[184:187], v[108:111]
    ds_read_b64_tr_b16 a[188:189], v4 offset:33792
    ds_read_b64_tr_b16 a[190:191], v4 offset:34304
    v_cvt_pk_bf16_f32 v6, v113, v113
    v_mfma_f32_16x16x32_bf16 v[24:27], a[120:123], v[64:67], v[24:27]
    ds_read_b128 v[80:83], v241 offset:57344
    ds_read_b128 v[84:87], v241 offset:59392
    v_and_b32 v113, 0xffff0000, v6
    v_mfma_f32_16x16x32_bf16 v[28:31], a[120:123], v[68:71], v[28:31]
    ds_read_b128 v[88:91], v241 offset:61440
    ds_read_b128 v[92:95], v241 offset:63488
    v_mfma_f32_16x16x32_bf16 v[32:35], a[120:123], v[72:75], v[32:35]
    s_mov_b64 exec, 0xffff
    buffer_load_dword v123, v251, s[4:7], s74 offen
    s_mov_b64 exec, -1
    v_mfma_f32_16x16x32_bf16 v[36:39], a[120:123], v[76:79], v[36:39]
    v_sqrt_f32_e64 v113, v113
    s_nop 0
    v_cvt_pk_bf16_f32 v6, v113, v113
    v_mfma_f32_16x16x32_bf16 v[44:47], v[64:67], a[184:187], v[44:47]
    v_and_b32 v113, 0xffff0000, v6
    v_rcp_f32 v113, v113
    v_mfma_f32_16x16x32_bf16 v[48:51], v[68:71], a[184:187], v[48:51]
    s_mov_b64 exec, vcc
    ds_write_b64 v244, v[112:113]
    ds_write2_b32 v245, v112, v113 offset0:0 offset1:64
    s_mov_b64 exec, -1
    v_mfma_f32_16x16x32_bf16 v[52:55], v[72:75], a[184:187], v[52:55]
    v_mfma_f32_16x16x32_bf16 v[56:59], v[76:79], a[184:187], v[56:59]
    s_waitcnt vmcnt(12) lgkmcnt(0)
    s_barrier
    v_mfma_f32_16x16x32_bf16 v[104:107], a[124:127], v[96:99], v[104:107]
    ds_read_b64_tr_b16 a[0:1], v4 offset:40960
    ds_read_b64_tr_b16 a[2:3], v4 offset:41472
    v_mfma_f32_16x16x32_bf16 v[108:111], v[96:99], a[188:191], v[108:111]
    ds_read_b128 v[184:187], v120 offset:0
    ds_read_b128 v[188:191], v120 offset:2048
    v_mfma_f32_16x16x32_bf16 v[24:27], a[124:127], v[80:83], v[24:27]
    ds_read_b128 v[192:195], v120 offset:4096
    ds_read_b128 v[196:199], v120 offset:6144
    v_mfma_f32_16x16x32_bf16 v[28:31], a[124:127], v[84:87], v[28:31]
    buffer_load_dwordx2 v[246:247], v248, s[24:27], 0 offen sc1
    v_mfma_f32_16x16x32_bf16 v[32:35], a[124:127], v[88:91], v[32:35]
    ds_read2_b64 v[112:115], v243 offset0:0 offset1:16
    ds_read2_b64 v[116:119], v243 offset0:32 offset1:48
    v_mfma_f32_16x16x32_bf16 v[36:39], a[124:127], v[92:95], v[36:39]
    ds_read_b128 v[128:131], v121 offset:0
    ds_read_b128 v[132:135], v121 offset:256
    v_mfma_f32_16x16x32_bf16 v[44:47], v[80:83], a[188:191], v[44:47]
    ds_read_b128 v[136:139], v121 offset:64
    ds_read_b128 v[140:143], v121 offset:320
    v_mfma_f32_16x16x32_bf16 v[48:51], v[84:87], a[188:191], v[48:51]
    ds_read_b128 v[144:147], v121 offset:128
    ds_read_b128 v[148:151], v121 offset:384
    v_mfma_f32_16x16x32_bf16 v[52:55], v[88:91], a[188:191], v[52:55]
    ds_read_b128 v[152:155], v121 offset:192
    ds_read_b128 v[156:159], v121 offset:448
    v_mfma_f32_16x16x32_bf16 v[56:59], v[92:95], a[188:191], v[56:59]
    s_waitcnt lgkmcnt(8)
    s_mov_b32 s63, 0
    v_pk_fma_f32 v[24:25], v[104:105], v[112:113], v[24:25] op_sel:[0,0,0] op_sel_hi:[1,0,1] neg_lo:[0,1,0] neg_hi:[0,1,0]
    v_pk_fma_f32 v[26:27], v[106:107], v[112:113], v[26:27] op_sel:[0,0,0] op_sel_hi:[1,0,1] neg_lo:[0,1,0] neg_hi:[0,1,0]
    v_pk_mul_f32 v[24:25], v[24:25], v[112:113] op_sel:[0,1] op_sel_hi:[1,1]
    v_pk_mul_f32 v[26:27], v[26:27], v[112:113] op_sel:[0,1] op_sel_hi:[1,1]
    v_cvt_pk_bf16_f32 v24, v24, v25
    v_cvt_pk_bf16_f32 v25, v26, v27
    v_pk_fma_f32 v[28:29], v[104:105], v[114:115], v[28:29] op_sel:[0,0,0] op_sel_hi:[1,0,1] neg_lo:[0,1,0] neg_hi:[0,1,0]
    v_pk_fma_f32 v[30:31], v[106:107], v[114:115], v[30:31] op_sel:[0,0,0] op_sel_hi:[1,0,1] neg_lo:[0,1,0] neg_hi:[0,1,0]
    v_pk_mul_f32 v[28:29], v[28:29], v[114:115] op_sel:[0,1] op_sel_hi:[1,1]
    v_pk_mul_f32 v[30:31], v[30:31], v[114:115] op_sel:[0,1] op_sel_hi:[1,1]
    v_cvt_pk_bf16_f32 v26, v28, v29
    v_cvt_pk_bf16_f32 v27, v30, v31
    v_pk_fma_f32 v[32:33], v[104:105], v[116:117], v[32:33] op_sel:[0,0,0] op_sel_hi:[1,0,1] neg_lo:[0,1,0] neg_hi:[0,1,0]
    v_pk_fma_f32 v[34:35], v[106:107], v[116:117], v[34:35] op_sel:[0,0,0] op_sel_hi:[1,0,1] neg_lo:[0,1,0] neg_hi:[0,1,0]
    v_pk_mul_f32 v[32:33], v[32:33], v[116:117] op_sel:[0,1] op_sel_hi:[1,1]
    v_pk_mul_f32 v[34:35], v[34:35], v[116:117] op_sel:[0,1] op_sel_hi:[1,1]
    v_cvt_pk_bf16_f32 v32, v32, v33
    v_cvt_pk_bf16_f32 v33, v34, v35
    v_pk_fma_f32 v[36:37], v[104:105], v[118:119], v[36:37] op_sel:[0,0,0] op_sel_hi:[1,0,1] neg_lo:[0,1,0] neg_hi:[0,1,0]
    v_pk_fma_f32 v[38:39], v[106:107], v[118:119], v[38:39] op_sel:[0,0,0] op_sel_hi:[1,0,1] neg_lo:[0,1,0] neg_hi:[0,1,0]
    v_pk_mul_f32 v[36:37], v[36:37], v[118:119] op_sel:[0,1] op_sel_hi:[1,1]
    v_pk_mul_f32 v[38:39], v[38:39], v[118:119] op_sel:[0,1] op_sel_hi:[1,1]
    v_cvt_pk_bf16_f32 v34, v36, v37
    v_cvt_pk_bf16_f32 v35, v38, v39
    v_permlane16_swap_b32 v24, v26
    v_permlane16_swap_b32 v25, v27
    v_permlane16_swap_b32 v32, v34
    v_permlane16_swap_b32 v33, v35
    s_waitcnt lgkmcnt(0)
    ds_read_b64_tr_b16 a[4:5], v4 offset:41984
    ds_read_b64_tr_b16 a[6:7], v4 offset:42496
    ds_read_b128 v[200:203], v241 offset:0
    ds_read_b128 v[204:207], v241 offset:2048
    ds_read_b128 v[208:211], v241 offset:4096
    ds_read_b128 v[212:215], v241 offset:6144
    v_pk_fma_f32 v[44:45], v[128:129], v[108:109], v[44:45] op_sel:[0,0,0] op_sel_hi:[1,0,1] neg_lo:[1,0,0] neg_hi:[1,0,0]
    buffer_store_dwordx4 v[24:27], v0, s[4:7], s73 offen offset:0 sc1
    v_pk_fma_f32 v[46:47], v[130:131], v[108:109], v[46:47] op_sel:[0,0,0] op_sel_hi:[1,0,1] neg_lo:[1,0,0] neg_hi:[1,0,0]
    v_pk_mul_f32 v[44:45], v[44:45], v[132:133]
    v_pk_mul_f32 v[46:47], v[46:47], v[134:135]
    v_cvt_pk_bf16_f32 v44, v44, v45
    v_cvt_pk_bf16_f32 v45, v46, v47
    v_pk_fma_f32 v[48:49], v[136:137], v[108:109], v[48:49] op_sel:[0,0,0] op_sel_hi:[1,0,1] neg_lo:[1,0,0] neg_hi:[1,0,0]
    v_pk_fma_f32 v[50:51], v[138:139], v[108:109], v[50:51] op_sel:[0,0,0] op_sel_hi:[1,0,1] neg_lo:[1,0,0] neg_hi:[1,0,0]
    v_pk_mul_f32 v[48:49], v[48:49], v[140:141]
    buffer_store_dwordx4 v[32:35], v0, s[4:7], s73 offen offset:2048 sc1
    v_pk_mul_f32 v[50:51], v[50:51], v[142:143]
    v_cvt_pk_bf16_f32 v46, v48, v49
    v_cvt_pk_bf16_f32 v47, v50, v51
    v_pk_fma_f32 v[52:53], v[144:145], v[108:109], v[52:53] op_sel:[0,0,0] op_sel_hi:[1,0,1] neg_lo:[1,0,0] neg_hi:[1,0,0]
    v_pk_fma_f32 v[54:55], v[146:147], v[108:109], v[54:55] op_sel:[0,0,0] op_sel_hi:[1,0,1] neg_lo:[1,0,0] neg_hi:[1,0,0]
    v_pk_mul_f32 v[52:53], v[52:53], v[148:149]
    v_pk_mul_f32 v[54:55], v[54:55], v[150:151]
    v_cvt_pk_bf16_f32 v52, v52, v53
    v_cvt_pk_bf16_f32 v53, v54, v55
    v_pk_fma_f32 v[56:57], v[152:153], v[108:109], v[56:57] op_sel:[0,0,0] op_sel_hi:[1,0,1] neg_lo:[1,0,0] neg_hi:[1,0,0]
    v_pk_fma_f32 v[58:59], v[154:155], v[108:109], v[58:59] op_sel:[0,0,0] op_sel_hi:[1,0,1] neg_lo:[1,0,0] neg_hi:[1,0,0]
    v_pk_mul_f32 v[56:57], v[56:57], v[156:157]
    v_pk_mul_f32 v[58:59], v[58:59], v[158:159]
    v_cvt_pk_bf16_f32 v54, v56, v57
    v_cvt_pk_bf16_f32 v55, v58, v59
    v_permlane16_swap_b32 v44, v46
    v_permlane16_swap_b32 v45, v47
    v_permlane16_swap_b32 v52, v54
    v_permlane16_swap_b32 v53, v55
    v_permlane32_swap_b32 v44, v46
    v_permlane32_swap_b32 v45, v47
    v_permlane32_swap_b32 v52, v54
    v_permlane32_swap_b32 v53, v55
    buffer_store_dwordx4 v[44:47], v0, s[4:7], s73 offen offset:1024 sc1
    buffer_store_dwordx4 v[52:55], v0, s[4:7], s73 offen offset:3072 sc1
    s_waitcnt lgkmcnt(15)
    v_mfma_f32_16x16x32_bf16 v[100:103], a[0:3], v[96:99], 0
    s_getpc_b64 s[30:31]
pc_1:
    v_mov_b32 v48, 0x3f803f80
    v_mfma_f32_16x16x32_bf16 v[8:11], a[0:3], v[184:187], 0
    s_add_u32 s30, s30, L_qa_e-pc_1
    s_addc_u32 s31, s31, 0
    v_mov_b32 v49, 0x3f803f80
    v_mfma_f32_16x16x32_bf16 v[12:15], a[0:3], v[188:191], 0
    s_mov_b64 exec, 0xf
    global_load_dword v123, v253, s[30:31]
    s_mov_b64 exec, -1
    v_mfma_f32_16x16x32_bf16 v[16:19], a[0:3], v[192:195], 0
    ds_read_b64_tr_b16 a[8:9], v4 offset:49152
    ds_read_b64_tr_b16 a[10:11], v4 offset:49664
    v_mfma_f32_16x16x32_bf16 v[20:23], a[0:3], v[196:199], 0
    ds_read_b128 v[168:171], v120 offset:8192
    ds_read_b128 v[172:175], v120 offset:10240
    ds_read_b128 v[176:179], v120 offset:12288
    ds_read_b128 v[180:183], v120 offset:14336
    s_waitcnt lgkmcnt(6)
    v_mfma_f32_16x16x32_bf16 v[100:103], a[4:7], v[96:99], v[100:103]
    ds_read_b64_tr_b16 a[12:13], v4 offset:50176
    ds_read_b64_tr_b16 a[14:15], v4 offset:50688
    v_mov_b32 v50, 0x3f803f80
    v_mfma_f32_16x16x32_bf16 v[8:11], a[4:7], v[200:203], v[8:11]
    ds_read_b128 v[184:187], v241 offset:8192
    ds_read_b128 v[188:191], v241 offset:10240
    v_mov_b32 v51, 0x3f803f80
    v_mfma_f32_16x16x32_bf16 v[12:15], a[4:7], v[204:207], v[12:15]
    s_mov_b64 exec, 0xffff
    buffer_load_dword v123, v254, s[12:15], 0 offen
    s_mov_b64 exec, -1
    v_mfma_f32_16x16x32_bf16 v[16:19], a[4:7], v[208:211], v[16:19]
    ds_read_b128 v[192:195], v241 offset:12288
    ds_read_b128 v[196:199], v241 offset:14336
    v_mfma_f32_16x16x32_bf16 v[20:23], a[4:7], v[212:215], v[20:23]
    s_waitcnt lgkmcnt(6)
    v_mfma_f32_16x16x32_bf16 v[100:103], a[8:11], v[96:99], v[100:103]
    ds_read_b64_tr_b16 a[16:17], v4 offset:57344
    ds_read_b64_tr_b16 a[18:19], v4 offset:57856
    v_mov_b32 v56, 0x3f803f80
    v_mfma_f32_16x16x32_bf16 v[8:11], a[8:11], v[168:171], v[8:11]
    ds_read_b128 v[200:203], v120 offset:16384
    ds_read_b128 v[204:207], v120 offset:18432
    v_mov_b32 v57, 0x3f803f80
    v_mfma_f32_16x16x32_bf16 v[12:15], a[8:11], v[172:175], v[12:15]
    s_mov_b64 exec, 0x3ff0000
    buffer_load_dword v123, v254, s[4:7], 0 offen
    s_mov_b64 exec, -1
    v_mfma_f32_16x16x32_bf16 v[16:19], a[8:11], v[176:179], v[16:19]
    ds_read_b128 v[208:211], v120 offset:20480
    ds_read_b128 v[212:215], v120 offset:22528
    v_mfma_f32_16x16x32_bf16 v[20:23], a[8:11], v[180:183], v[20:23]
    s_waitcnt vmcnt(16) lgkmcnt(6)
    s_barrier
    v_mfma_f32_16x16x32_bf16 v[100:103], a[12:15], v[96:99], v[100:103]
    ds_read_b64_tr_b16 a[20:21], v4 offset:58368
    ds_read_b64_tr_b16 a[22:23], v4 offset:58880
    v_mov_b32 v58, 0x3f803f80
    v_mfma_f32_16x16x32_bf16 v[8:11], a[12:15], v[184:187], v[8:11]
    v_xor_b32 v252, 0, v250
    v_mad_u32_u24 v252, v252, s79, v249
    v_mov_b32 v59, 0x3f803f80
    v_mfma_f32_16x16x32_bf16 v[12:15], a[12:15], v[188:191], v[12:15]
    s_mov_b64 exec, 0xffffff
    global_load_dword v123, v252, s[32:33]
    s_mov_b64 exec, -1
    v_mfma_f32_16x16x32_bf16 v[16:19], a[12:15], v[192:195], v[16:19]
    ds_read_b128 v[168:171], v241 offset:16384
    ds_read_b128 v[172:175], v241 offset:18432
    v_mfma_f32_16x16x32_bf16 v[20:23], a[12:15], v[196:199], v[20:23]
    ds_read_b128 v[176:179], v241 offset:20480
    ds_read_b128 v[180:183], v241 offset:22528
    s_waitcnt lgkmcnt(6)
    v_mfma_f32_16x16x32_bf16 v[100:103], a[16:19], v[96:99], v[100:103]
    ds_read_b64_tr_b16 a[24:25], v240 offset:0
    ds_read_b64_tr_b16 a[26:27], v240 offset:512
    v_mfma_f32_16x16x32_bf16 v[8:11], a[16:19], v[200:203], v[8:11]
    ds_read_b128 v[184:187], v120 offset:24576
    ds_read_b128 v[188:191], v120 offset:26624
    v_mfma_f32_16x16x32_bf16 v[12:15], a[16:19], v[204:207], v[12:15]
    ds_read_b128 v[192:195], v120 offset:28672
    ds_read_b128 v[196:199], v120 offset:30720
    v_mfma_f32_16x16x32_bf16 v[16:19], a[16:19], v[208:211], v[16:19]
    v_permlane16_swap_b32 v44, v48
    v_mfma_f32_16x16x32_bf16 v[20:23], a[16:19], v[212:215], v[20:23]
    v_permlane16_swap_b32 v45, v49
    s_waitcnt lgkmcnt(6)
    v_mfma_f32_16x16x32_bf16 v[100:103], a[20:23], v[96:99], v[100:103]
    ds_read_b64_tr_b16 a[28:29], v240 offset:1024
    ds_read_b64_tr_b16 a[30:31], v240 offset:1536
    v_mfma_f32_16x16x32_bf16 v[8:11], a[20:23], v[168:171], v[8:11]
    ds_read_b128 v[200:203], v241 offset:24576
    ds_read_b128 v[204:207], v241 offset:26624
    v_mfma_f32_16x16x32_bf16 v[12:15], a[20:23], v[172:175], v[12:15]
    ds_read_b128 v[208:211], v241 offset:28672
    ds_read_b128 v[212:215], v241 offset:30720
    v_mfma_f32_16x16x32_bf16 v[16:19], a[20:23], v[176:179], v[16:19]
    v_permlane16_swap_b32 v46, v50
    v_mfma_f32_16x16x32_bf16 v[20:23], a[20:23], v[180:183], v[20:23]
    v_permlane16_swap_b32 v47, v51
    s_waitcnt lgkmcnt(6)
    v_mfma_f32_16x16x32_bf16 v[100:103], a[24:27], v[96:99], v[100:103]
    ds_read_b64_tr_b16 a[32:33], v240 offset:8192
    ds_read_b64_tr_b16 a[34:35], v240 offset:8704
    v_mfma_f32_16x16x32_bf16 v[8:11], a[24:27], v[184:187], v[8:11]
    ds_read_b128 v[168:171], v120 offset:32768
    ds_read_b128 v[172:175], v120 offset:34816
    v_mfma_f32_16x16x32_bf16 v[12:15], a[24:27], v[188:191], v[12:15]
    ds_read_b128 v[176:179], v120 offset:36864
    ds_read_b128 v[180:183], v120 offset:38912
    v_mfma_f32_16x16x32_bf16 v[16:19], a[24:27], v[192:195], v[16:19]
    v_permlane16_swap_b32 v52, v56
    v_mfma_f32_16x16x32_bf16 v[20:23], a[24:27], v[196:199], v[20:23]
    s_waitcnt vmcnt(13) lgkmcnt(6)
    s_barrier
    v_mfma_f32_16x16x32_bf16 v[100:103], a[28:31], v[96:99], v[100:103]
    ds_read_b64_tr_b16 a[36:37], v240 offset:9216
    ds_read_b64_tr_b16 a[38:39], v240 offset:9728
    v_mfma_f32_16x16x32_bf16 v[8:11], a[28:31], v[200:203], v[8:11]
    ds_read_b128 v[184:187], v241 offset:32768
    ds_read_b128 v[188:191], v241 offset:34816
    v_mfma_f32_16x16x32_bf16 v[12:15], a[28:31], v[204:207], v[12:15]
    ds_read_b128 v[192:195], v241 offset:36864
    ds_read_b128 v[196:199], v241 offset:38912
    v_mfma_f32_16x16x32_bf16 v[16:19], a[28:31], v[208:211], v[16:19]
    v_permlane16_swap_b32 v53, v57
    v_mfma_f32_16x16x32_bf16 v[20:23], a[28:31], v[212:215], v[20:23]
    s_waitcnt lgkmcnt(6)
    v_mfma_f32_16x16x32_bf16 v[100:103], a[32:35], v[96:99], v[100:103]
    ds_read_b64_tr_b16 a[40:41], v240 offset:16384
    ds_read_b64_tr_b16 a[42:43], v240 offset:16896
    v_mfma_f32_16x16x32_bf16 v[8:11], a[32:35], v[168:171], v[8:11]
    ds_read_b128 v[200:203], v120 offset:40960
    ds_read_b128 v[204:207], v120 offset:43008
    v_mfma_f32_16x16x32_bf16 v[12:15], a[32:35], v[172:175], v[12:15]
    ds_read_b128 v[208:211], v120 offset:45056
    ds_read_b128 v[212:215], v120 offset:47104
    v_mfma_f32_16x16x32_bf16 v[16:19], a[32:35], v[176:179], v[16:19]
    v_permlane16_swap_b32 v54, v58
    v_mfma_f32_16x16x32_bf16 v[20:23], a[32:35], v[180:183], v[20:23]
    s_waitcnt lgkmcnt(6)
    v_mfma_f32_16x16x32_bf16 v[100:103], a[36:39], v[96:99], v[100:103]
    ds_read_b64_tr_b16 a[44:45], v240 offset:17408
    ds_read_b64_tr_b16 a[46:47], v240 offset:17920
    v_mfma_f32_16x16x32_bf16 v[8:11], a[36:39], v[184:187], v[8:11]
    ds_read_b128 v[168:171], v241 offset:40960
    ds_read_b128 v[172:175], v241 offset:43008
    v_mfma_f32_16x16x32_bf16 v[12:15], a[36:39], v[188:191], v[12:15]
    ds_read_b128 v[176:179], v241 offset:45056
    ds_read_b128 v[180:183], v241 offset:47104
    v_mfma_f32_16x16x32_bf16 v[16:19], a[36:39], v[192:195], v[16:19]
    v_permlane16_swap_b32 v55, v59
    v_mfma_f32_16x16x32_bf16 v[20:23], a[36:39], v[196:199], v[20:23]
    s_waitcnt lgkmcnt(6)
    v_mfma_f32_16x16x32_bf16 v[100:103], a[40:43], v[96:99], v[100:103]
    ds_read_b64_tr_b16 a[48:49], v4 offset:0
    ds_read_b64_tr_b16 a[50:51], v4 offset:512
    v_mfma_f32_16x16x32_bf16 v[8:11], a[40:43], v[200:203], v[8:11]
    ds_read_b128 v[184:187], v120 offset:49152
    ds_read_b128 v[188:191], v120 offset:51200
    v_mfma_f32_16x16x32_bf16 v[12:15], a[40:43], v[204:207], v[12:15]
    ds_read_b128 v[192:195], v120 offset:53248
    ds_read_b128 v[196:199], v120 offset:55296
    v_mfma_f32_16x16x32_bf16 v[16:19], a[40:43], v[208:211], v[16:19]
    s_mov_b32 s50, 0
    s_waitcnt vmcnt(8)
tb_3:
    v_readlane_b32 s48, v246, 0
    v_readlane_b32 s43, v247, 0
    v_readlane_b32 s101, v247, 1
    s_and_b32 s49, s48, 63
    s_cmp_eq_u32 s49, 32
    s_cselect_b32 s49, s43, 0
    s_min_u32 s49, s49, s101
    s_cmp_lg_u32 s49, 0
    s_cbranch_scc1 tb_3_ok
    buffer_load_dwordx2 v[246:247], v248, s[24:27], 0 offen sc1
    s_waitcnt vmcnt(0)
    s_add_u32 s50, s50, 1
    s_cmp_lt_u32 s50, 2000000
    s_cbranch_scc1 tb_3
    s_mov_b32 s44, 2000000
tb_3_ok:
    s_lshl_b32 s52, s52, 5
    s_cmp_eq_u32 s52, s48
    s_cselect_b32 s42, 1, 0
    s_add_u32 s48, s43, 1
    v_mov_b32_e64 v6, s48
    s_cmp_lg_u32 s42, 0
    s_mov_b64 exec, 1
    s_waitcnt vmcnt(4)
    s_cbranch_scc0 sig_4_s
    buffer_store_dword v6, off, s[4:7], s47
sig_4:
    buffer_store_dword v6, off, s[4:7], s47 offset:128 sc1
    s_mov_b64 exec, -1
    v_mfma_f32_16x16x32_bf16 v[20:23], a[40:43], v[212:215], v[20:23]
    s_waitcnt vmcnt(12) lgkmcnt(6)
    s_barrier
    v_mfma_f32_16x16x32_bf16 v[100:103], a[44:47], v[96:99], v[100:103]
    s_add_u32 m0, s1, 0
    s_xor_b32 s58, s0, 0
    v_and_b32 v6, 3, v1
    v_mfma_f32_16x16x32_bf16 v[8:11], a[44:47], v[168:171], v[8:11]
    buffer_load_dwordx4 v238, s[20:23], s58 offen lds
    v_mov_b32_e64 v122, s101
    v_mfma_f32_16x16x32_bf16 v[12:15], a[44:47], v[172:175], v[12:15]
    s_add_u32 m0, s1, 4096
    s_xor_b32 s58, s0, 32768
    v_mfma_f32_16x16x32_bf16 v[16:19], a[44:47], v[176:179], v[16:19]
    buffer_load_dwordx4 v238, s[20:23], s58 offen lds
    v_mfma_f32_16x16x32_bf16 v[20:23], a[44:47], v[180:183], v[20:23]
    ds_read_b64_tr_b16 a[52:53], v4 offset:1024
    ds_read_b64_tr_b16 a[54:55], v4 offset:1536
    ds_read_b128 v[200:203], v241 offset:49152
    ds_read_b128 v[204:207], v241 offset:51200
    ds_read_b128 v[208:211], v241 offset:53248
    ds_read_b128 v[212:215], v241 offset:55296
    s_waitcnt lgkmcnt(6)
    v_mfma_f32_16x16x32_bf16 v[100:103], a[48:51], v[96:99], v[100:103]
    s_add_u32 m0, s1, 8192
    s_xor_b32 s58, s0, 65536
    v_mov_b32 v7, s43
    v_cmp_gt_u32 s[48:49], s38, v6
    s_nop 1
    v_cndmask_b32 v122, v122, v7, s[48:49]
    v_add_u32 v122, 1, v122
    v_mfma_f32_16x16x32_bf16 v[8:11], a[48:51], v[184:187], v[8:11]
    buffer_load_dwordx4 v238, s[20:23], s58 offen lds
    s_add_u32 m0, s1, 12288
    s_xor_b32 s58, s0, 98304
    s_mov_b32 s64, 0xff000ff
    s_mov_b32 s65, 0xf000ff00
    v_mfma_f32_16x16x32_bf16 v[12:15], a[48:51], v[188:191], v[12:15]
    buffer_load_dwordx4 v238, s[20:23], s58 offen lds
    s_mov_b32 s66, 0x1fe001fe
    s_mov_b32 s67, 0xe000fe00
    s_mov_b32 s68, 0x3fc003fc
    s_mov_b32 s69, 0xc000fc00
    v_mfma_f32_16x16x32_bf16 v[16:19], a[48:51], v[192:195], v[16:19]
    ds_read_b64_tr_b16 a[56:57], v4 offset:8192
    ds_read_b64_tr_b16 a[58:59], v4 offset:8704
    s_mov_b32 s70, 0x7f8007f8
    v_mfma_f32_16x16x32_bf16 v[20:23], a[48:51], v[196:199], v[20:23]
    buffer_load_dword v126, v125, s[4:7], 0 offen sc1
    ds_read_b128 v[168:171], v120 offset:57344
    ds_read_b128 v[172:175], v120 offset:59392
    ds_read_b128 v[176:179], v120 offset:61440
    ds_read_b128 v[180:183], v120 offset:63488
    s_waitcnt lgkmcnt(6)
    v_mfma_f32_16x16x32_bf16 v[100:103], a[52:55], v[96:99], v[100:103]
    s_add_u32 m0, s1, 16384
    s_xor_b32 s58, s0, 131072
    s_mov_b32 s71, 0x8000f800
    v_lshlrev_b32 v6, 2, v3
    v_sub_u32_e64 v6, v2, v6
    s_mov_b32 s48, 0xffff0000
    v_mfma_f32_16x16x32_bf16 v[8:11], a[52:55], v[200:203], v[8:11]
    buffer_load_dwordx4 v238, s[20:23], s58 offen lds
    v_pk_add_i16 v6, v6, s48 op_sel_hi:[0,1]
    s_cmp_lg_u32 s40, 0
    s_cselect_b32 s48, -1, 0
    v_subrev_u32_e64 v7, 32, v1
    v_mfma_f32_16x16x32_bf16 v[12:15], a[52:55], v[204:207], v[12:15]
    s_add_u32 m0, s1, 20480
    s_xor_b32 s58, s0, 163840
    v_ashrrev_i32 v7, 31, v7
    v_and_b32 v7, s48, v7
    v_pk_add_i16 v216, v6, -8 op_sel_hi:[1,0]
    v_pk_ashrrev_i16 v216, 15, v216 op_sel_hi:[0,1]
    v_mfma_f32_16x16x32_bf16 v[16:19], a[52:55], v[208:211], v[16:19]
    buffer_load_dwordx4 v238, s[20:23], s58 offen lds
    v_pk_add_i16 v218, v6, 8 op_sel_hi:[1,0]
    v_pk_ashrrev_i16 v218, 15, v218 op_sel_hi:[0,1]
    v_pk_add_i16 v220, v6, 0 op_sel_hi:[1,0]
    v_pk_ashrrev_i16 v220, 15, v220 op_sel_hi:[0,1]
    v_mfma_f32_16x16x32_bf16 v[20:23], a[52:55], v[212:215], v[20:23]
    ds_read_b64_tr_b16 a[60:61], v4 offset:9216
    ds_read_b64_tr_b16 a[62:63], v4 offset:9728
    ds_read_b128 v[184:187], v241 offset:57344
    ds_read_b128 v[188:191], v241 offset:59392
    ds_read_b128 v[192:195], v241 offset:61440
    ds_read_b128 v[196:199], v241 offset:63488
    s_waitcnt lgkmcnt(6)
    v_mfma_f32_16x16x32_bf16 v[100:103], a[56:59], v[96:99], v[100:103]
    s_add_u32 m0, s1, 24576
    s_xor_b32 s58, s0, 196608
    v_bfi_b32 v216, v220, 0, v216
    v_and_b32 v220, v7, v220
    v_and_b32_e64 v222, s48, v218
    v_mfma_f32_16x16x32_bf16 v[8:11], a[56:59], v[168:171], v[8:11]
    buffer_load_dwordx4 v238, s[20:23], s58 offen lds
    v_pk_add_i16 v217, v6, -10 op_sel_hi:[1,0]
    v_pk_ashrrev_i16 v217, 15, v217 op_sel_hi:[0,1]
    v_pk_add_i16 v219, v6, 6 op_sel_hi:[1,0]
    v_mfma_f32_16x16x32_bf16 v[12:15], a[56:59], v[172:175], v[12:15]
    s_add_u32 m0, s1, 28672
    s_xor_b32 s58, s0, 229376
    v_pk_ashrrev_i16 v219, 15, v219 op_sel_hi:[0,1]
    v_pk_add_i16 v221, v6, -2 op_sel_hi:[1,0]
    v_pk_ashrrev_i16 v221, 15, v221 op_sel_hi:[0,1]
    v_mfma_f32_16x16x32_bf16 v[16:19], a[56:59], v[176:179], v[16:19]
    buffer_load_dwordx4 v238, s[20:23], s58 offen lds
    v_bfi_b32 v217, v221, 0, v217
    v_and_b32 v221, v7, v221
    v_and_b32 v223, s48, v219
    v_mfma_f32_16x16x32_bf16 v[20:23], a[56:59], v[180:183], v[20:23]
    v_add_u32 v6, 161792, v0
    ds_write_b128 v6, v[216:219]
    ds_write_b128 v6, v[220:223] offset:1024
    s_waitcnt lgkmcnt(2)
    s_barrier
    v_mfma_f32_16x16x32_bf16 v[100:103], a[60:63], v[96:99], v[100:103]
    s_sub_u32 s48, s40, 1
    s_and_b32 s48, s48, 31
    s_lshl_b32 s48, s48, 11
    s_cmp_eq_u32 s38, 0
    s_cselect_b32 s49, 128, 0
    v_mfma_f32_16x16x32_bf16 v[8:11], a[60:63], v[184:187], v[8:11]
    s_add_u32 s48, s48, s49
    s_lshl_b32 s49, s40, 11
    v_mov_b32 v6, s49
    v_mov_b32 v7, s48
    v_cmp_gt_u32 s[50:51], 32, v1
    v_mfma_f32_16x16x32_bf16 v[12:15], a[60:63], v[188:191], v[12:15]
    s_waitcnt vmcnt(4)
    v_sub_u32 v126, v126, v122
    v_cmp_gt_u32_e64 vcc, 16, v126
    s_nop 0
    s_or_b32 s81, s81, vcc_lo
    s_bitcmp1_b32 s81, 0
    s_cbranch_scc0 L_tp0
    s_add_u32 m0, s78, -2048
    s_sub_u32 s58, s73, 4096
    s_cmp_gt_u32 s40, 0
    s_cselect_b32 s58, s58, 2147418112
    buffer_load_dwordx4 v0, s[4:7], s58 offen offset:2048 sc1 lds
    buffer_load_dwordx4 v0, s[4:7], s58 offen offset:3072 sc1 lds
    s_add_u32 m0, s78, 2048
    s_mov_b32 s63, 1
    buffer_load_dwordx4 v0, s[4:7], s58 offen offset:0 sc1 lds
    buffer_load_dwordx4 v0, s[4:7], s58 offen offset:1024 sc1 lds
L_tp0:
    v_mfma_f32_16x16x32_bf16 v[16:19], a[60:63], v[192:195], v[16:19]
    v_cndmask_b32 v6, v7, v6, s[50:51]
    v_bfe_u32 v7, v1, 2, 3
    v_lshl_add_u32 v6, v7, 8, v6
    v_and_b32_e64 v7, 3, v1
    v_lshl_add_u32 v124, v7, 2, v6
    v_mfma_f32_16x16x32_bf16 v[20:23], a[60:63], v[196:199], v[20:23]
    s_mov_b64 s[16:17], s[32:33]
    s_mul_i32 s59, s3, 192
    s_add_u32 s59, s59, 156672
    v_lshl_add_u32 v6, v3, 4, s59
    v_lshl_add_u32 v7, v2, 2, s59
    ds_write_b128 v6, v[100:103]
    ds_write_b128 v6, v[104:107] offset:64
    ds_write_b32 v7, v108 offset:128
L_qepi:
    v_pk_fma_f32 v[16:17], v[100:101], v[116:117], v[16:17] op_sel:[0,0,0] op_sel_hi:[1,0,1] neg_lo:[0,1,0] neg_hi:[0,1,0]
    v_pk_fma_f32 v[18:19], v[102:103], v[116:117], v[18:19] op_sel:[0,0,0] op_sel_hi:[1,0,1] neg_lo:[0,1,0] neg_hi:[0,1,0]
    v_mul_f32 v117, s92, v117
    v_pk_mul_f32 v[16:17], v[16:17], v[116:117] op_sel:[0,1] op_sel_hi:[1,1]
    v_pk_mul_f32 v[18:19], v[18:19], v[116:117] op_sel:[0,1] op_sel_hi:[1,1]
    v_cvt_pk_bf16_f32 v16, v16, v17
    v_cvt_pk_bf16_f32 v17, v18, v19
    v_pk_fma_f32 v[20:21], v[100:101], v[118:119], v[20:21] op_sel:[0,0,0] op_sel_hi:[1,0,1] neg_lo:[0,1,0] neg_hi:[0,1,0]
    v_pk_fma_f32 v[22:23], v[102:103], v[118:119], v[22:23] op_sel:[0,0,0] op_sel_hi:[1,0,1] neg_lo:[0,1,0] neg_hi:[0,1,0]
    v_mul_f32_e64 v119, s92, v119
    v_pk_mul_f32 v[20:21], v[20:21], v[118:119] op_sel:[0,1] op_sel_hi:[1,1]
    v_pk_mul_f32 v[22:23], v[22:23], v[118:119] op_sel:[0,1] op_sel_hi:[1,1]
    v_cvt_pk_bf16_f32 v18, v20, v21
    v_cvt_pk_bf16_f32 v19, v22, v23
    v_pk_fma_f32 v[8:9], v[100:101], v[112:113], v[8:9] op_sel:[0,0,0] op_sel_hi:[1,0,1] neg_lo:[0,1,0] neg_hi:[0,1,0]
    v_pk_fma_f32 v[10:11], v[102:103], v[112:113], v[10:11] op_sel:[0,0,0] op_sel_hi:[1,0,1] neg_lo:[0,1,0] neg_hi:[0,1,0]
    v_mul_f32_e64 v113, s92, v113
    v_pk_mul_f32 v[8:9], v[8:9], v[112:113] op_sel:[0,1] op_sel_hi:[1,1]
    v_pk_mul_f32 v[10:11], v[10:11], v[112:113] op_sel:[0,1] op_sel_hi:[1,1]
    v_cvt_pk_bf16_f32 v8, v8, v9
    v_cvt_pk_bf16_f32 v9, v10, v11
    v_pk_fma_f32 v[12:13], v[100:101], v[114:115], v[12:13] op_sel:[0,0,0] op_sel_hi:[1,0,1] neg_lo:[0,1,0] neg_hi:[0,1,0]
    v_pk_fma_f32 v[14:15], v[102:103], v[114:115], v[14:15] op_sel:[0,0,0] op_sel_hi:[1,0,1] neg_lo:[0,1,0] neg_hi:[0,1,0]
    v_mul_f32_e64 v115, s92, v115
    v_pk_mul_f32 v[12:13], v[12:13], v[114:115] op_sel:[0,1] op_sel_hi:[1,1]
    v_pk_mul_f32 v[14:15], v[14:15], v[114:115] op_sel:[0,1] op_sel_hi:[1,1]
    v_cvt_pk_bf16_f32 v10, v12, v13
    v_cvt_pk_bf16_f32 v11, v14, v15
    v_permlane16_swap_b32 v16, v18
    v_permlane16_swap_b32 v17, v19
    v_permlane16_swap_b32 v8, v10
    v_permlane16_swap_b32 v9, v11
L_qa_e:
    s_cmp_lg_u32 s63, 0
    s_cbranch_scc1 aa_5_np
    buffer_load_dword v126, v125, s[4:7], 0 offen sc1
aa_5_np:
    v_mfma_f32_32x32x16_bf16 v[68:83], v[24:27], v[16:19], 0
    v_add_u32_e64 v120, s78, v0
    v_add_u32 v6, 159744, v0
    ds_read_b128 v[40:43], v6
    ds_read_b128 v[116:119], v6 offset:1024
    v_mov_b32 v7, 158208
    v_add_u32 v6, 1024, v120
    v_cndmask_b32 v20, v7, v6, s[94:95]
    v_add_u32 v6, 3072, v120
    v_cndmask_b32 v21, v7, v6, s[94:95]
    v_add_u32 v6, 5120, v120
    v_cndmask_b32 v22, v7, v6, s[94:95]
    s_sub_u32 s60, s73, 8192
    s_cmp_gt_u32 s40, 1
    s_cselect_b32 s60, s60, 2147418112
    s_sub_u32 s61, s73, 12288
    s_cmp_gt_u32 s40, 2
    s_cselect_b32 s61, s61, 2147418112
    s_sub_u32 s62, s73, 16384
    s_cmp_gt_u32 s40, 3
    s_cselect_b32 s62, s62, 2147418112
    v_mfma_f32_32x32x16_bf16 v[84:99], v[32:35], v[16:19], 0
    v_exp_f32 v68, v68
    v_exp_f32 v69, v69
    v_exp_f32 v70, v70
    v_exp_f32 v71, v71
    v_exp_f32 v72, v72
    v_exp_f32 v73, v73
    v_exp_f32 v74, v74
    v_exp_f32 v75, v75
    v_exp_f32 v76, v76
    v_exp_f32 v77, v77
    v_exp_f32 v78, v78
    v_exp_f32 v79, v79
    v_exp_f32 v80, v80
    v_exp_f32 v81, v81
    v_exp_f32 v82, v82
    v_exp_f32_e64 v83, v83
    v_cvt_pk_bf16_f32 v100, v68, v69
    v_cvt_pk_bf16_f32 v101, v70, v71
    v_cvt_pk_bf16_f32 v102, v72, v73
    v_cvt_pk_bf16_f32 v103, v74, v75
    v_cvt_pk_bf16_f32 v104, v76, v77
    v_cvt_pk_bf16_f32 v105, v78, v79
    v_cvt_pk_bf16_f32 v106, v80, v81
    v_cvt_pk_bf16_f32 v107, v82, v83
    s_cmp_lg_u32 s63, 0
    s_cbranch_scc1 sp_6_i
    s_waitcnt vmcnt(0)
    v_sub_u32 v126, v126, v122
    v_cmp_gt_u32 vcc, 16, v126
    s_nop 0
    s_or_b32 s81, s81, vcc_lo
    s_bitcmp1_b32 s81, 0
    s_nop 0
    s_cbranch_scc1 sp_6_g
    s_mov_b32 s49, s44
    s_mov_b64 exec, 15
    buffer_load_dword v126, v125, s[4:7], 0 offen sc1
    s_nop 7
    s_nop 7
kp_7:
    buffer_load_dword v127, v125, s[4:7], 0 offen sc1
    s_waitcnt vmcnt(1)
    v_sub_u32 v126, v126, v122
    v_cmp_gt_u32 vcc, 16, v126
    s_nop 0
    s_or_b32 s81, s81, vcc_lo
    s_and_b32 s48, s81, 1
    s_cmp_eq_u32 s48, 1
    s_cbranch_scc1 kp_7_ok
    buffer_load_dword v126, v125, s[4:7], 0 offen sc1
    s_waitcnt vmcnt(1)
    v_sub_u32 v127, v127, v122
    v_cmp_gt_u32 vcc, 16, v127
    s_nop 0
    s_or_b32 s81, s81, vcc_lo
    s_and_b32 s48, s81, 1
    s_cmp_eq_u32 s48, 1
    s_cbranch_scc1 kp_7_ok
    s_add_u32 s49, s49, 1
    s_cmp_lt_u32 s49, 2000000
    s_cbranch_scc1 kp_7
    s_mov_b32 s44, 2000000
kp_7_ok:
    s_mov_b64 exec, -1
sp_6_g:
    s_add_u32 m0, s78, -2048
    s_sub_u32 s58, s73, 4096
    s_cmp_gt_u32 s40, 0
    s_cselect_b32 s58, s58, 2147418112
    buffer_load_dwordx4 v0, s[4:7], s58 offen offset:2048 sc1 lds
    buffer_load_dwordx4 v0, s[4:7], s58 offen offset:3072 sc1 lds
    s_add_u32 m0, s78, 2048
    s_mov_b32 s63, 1
    buffer_load_dwordx4 v0, s[4:7], s58 offen offset:0 sc1 lds
    buffer_load_dwordx4 v0, s[4:7], s58 offen offset:1024 sc1 lds
sp_6_i:
    buffer_load_dword v126, v125, s[4:7], 0 offen sc1
    v_mfma_f32_32x32x16_bf16 v[68:83], v[24:27], v[8:11], 0
    v_exp_f32 v84, v84
    v_exp_f32 v85, v85
    v_exp_f32 v86, v86
    v_exp_f32 v87, v87
    v_exp_f32 v88, v88
    v_mfma_f32_32x32x16_bf16 v[24:39], v[44:47], v[100:103], 0
    v_exp_f32 v89, v89
    v_exp_f32 v90, v90
    v_exp_f32 v91, v91
    v_exp_f32 v92, v92
    v_exp_f32 v93, v93
    v_mfma_f32_32x32x16_bf16 v[24:39], v[48:51], v[104:107], v[24:39]
    v_exp_f32 v94, v94
    v_exp_f32 v95, v95
    v_exp_f32 v96, v96
    v_exp_f32 v97, v97
    v_exp_f32 v98, v98
    v_exp_f32_e64 v99, v99
    v_cvt_pk_bf16_f32 v108, v84, v85
    v_cvt_pk_bf16_f32 v109, v86, v87
    v_cvt_pk_bf16_f32 v110, v88, v89
    v_cvt_pk_bf16_f32 v111, v90, v91
    v_cvt_pk_bf16_f32 v112, v92, v93
    v_cvt_pk_bf16_f32 v113, v94, v95
    v_cvt_pk_bf16_f32 v114, v96, v97
    v_cvt_pk_bf16_f32 v115, v98, v99
    s_waitcnt lgkmcnt(0)
    v_and_b32 v108, v108, v40
    v_and_b32 v109, v109, v41
    v_and_b32 v110, v110, v42
    v_and_b32 v111, v111, v43
    v_and_b32 v112, v112, v116
    v_and_b32 v113, v113, v117
    v_and_b32 v114, v114, v118
    v_and_b32 v115, v115, v119
    s_bitcmp1_b32 s81, 1
    s_cbranch_scc1 aq_8
    s_waitcnt vmcnt(0)
    v_sub_u32 v126, v126, v122
    v_cmp_gt_u32 vcc, 16, v126
    s_nop 0
    s_or_b32 s81, s81, vcc_lo
    s_bitcmp1_b32 s81, 1
    s_nop 0
    s_cbranch_scc1 aq_8
    s_mov_b32 s49, s44
    s_mov_b64 exec, 15
    buffer_load_dword v126, v125, s[4:7], 0 offen sc1
    s_nop 7
    s_nop 7
kp_9:
    buffer_load_dword v127, v125, s[4:7], 0 offen sc1
    s_waitcnt vmcnt(1)
    v_sub_u32 v126, v126, v122
    v_cmp_gt_u32 vcc, 16, v126
    s_nop 0
    s_or_b32 s81, s81, vcc_lo
    s_and_b32 s48, s81, 2
    s_cmp_eq_u32 s48, 2
    s_cbranch_scc1 kp_9_ok
    buffer_load_dword v126, v125, s[4:7], 0 offen sc1
    s_waitcnt vmcnt(1)
    v_sub_u32 v127, v127, v122
    v_cmp_gt_u32 vcc, 16, v127
    s_nop 0
    s_or_b32 s81, s81, vcc_lo
    s_and_b32 s48, s81, 2
    s_cmp_eq_u32 s48, 2
    s_cbranch_scc1 kp_9_ok
    s_add_u32 s49, s49, 1
    s_cmp_lt_u32 s49, 2000000
    s_cbranch_scc1 kp_9
    s_mov_b32 s44, 2000000
kp_9_ok:
    s_mov_b64 exec, -1
aq_8:
    v_exp_f32 v68, v68
    s_add_u32 m0, s78, 2048
    v_exp_f32 v69, v69
    buffer_load_dwordx4 v0, s[4:7], s60 offen offset:2048 sc1 lds
    v_exp_f32 v70, v70
    v_exp_f32 v71, v71
    buffer_load_dwordx4 v0, s[4:7], s60 offen offset:3072 sc1 lds
    v_exp_f32 v72, v72
    v_mfma_f32_32x32x16_bf16 v[24:39], v[52:55], v[108:111], v[24:39]
    v_exp_f32 v73, v73
    buffer_load_dword v126, v125, s[4:7], 0 offen sc1
    v_exp_f32 v74, v74
    s_waitcnt vmcnt(7)
    ds_read_b128 v[12:15], v120 offset:0
    v_exp_f32 v75, v75
    v_exp_f32 v76, v76
    v_exp_f32 v77, v77
    v_mfma_f32_32x32x16_bf16 v[24:39], v[56:59], v[112:115], v[24:39]
    v_exp_f32 v78, v78
    v_exp_f32 v79, v79
    v_exp_f32 v80, v80
    v_exp_f32 v81, v81
    v_exp_f32 v82, v82
    s_waitcnt lgkmcnt(0)
    v_mfma_f32_32x32x16_bf16 v[84:99], v[12:15], v[8:11], 0
    v_exp_f32 v83, v83
    v_cvt_pk_bf16_f32 v100, v68, v69
    v_cvt_pk_bf16_f32 v101, v70, v71
    v_cvt_pk_bf16_f32 v102, v72, v73
    v_cvt_pk_bf16_f32 v103, v74, v75
    v_cvt_pk_bf16_f32 v104, v76, v77
    v_cvt_pk_bf16_f32 v105, v78, v79
    v_cvt_pk_bf16_f32 v106, v80, v81
    v_cvt_pk_bf16_f32 v107, v82, v83
    v_and_b32 v100, v100, v40
    v_and_b32 v101, v101, v41
    v_and_b32 v102, v102, v42
    v_and_b32 v103, v103, v43
    v_and_b32 v104, v104, v116
    v_and_b32 v105, v105, v117
    v_and_b32 v106, v106, v118
    v_and_b32 v107, v107, v119
    v_mfma_f32_32x32x16_bf16 v[68:83], v[12:15], v[16:19], 0
    v_exp_f32 v84, v84
    s_add_u32 m0, s78, 0
    v_exp_f32 v85, v85
    buffer_load_dwordx4 v0, s[4:7], s60 offen offset:0 sc1 lds
    v_exp_f32 v86, v86
    v_exp_f32 v87, v87
    v_exp_f32 v88, v88
    v_mfma_f32_32x32x16_bf16 v[52:67], v[44:47], v[100:103], 0
    v_exp_f32 v89, v89
    v_exp_f32 v90, v90
    v_exp_f32 v91, v91
    v_exp_f32 v92, v92
    v_exp_f32 v93, v93
    v_mfma_f32_32x32x16_bf16 v[52:67], v[48:51], v[104:107], v[52:67]
    v_exp_f32_e64 v94, v94
    s_cmp_eq_u32 s40, 0
    s_cbranch_scc1 z_10
z_10_b:
    s_waitcnt vmcnt(6)
    ds_read_b128 v[44:47], v20
    ds_read_b128 v[48:51], v20 offset:256
    ds_read_b128 v[12:15], v120 offset:2048
    v_exp_f32 v95, v95
    v_exp_f32 v96, v96
    v_exp_f32 v97, v97
    v_exp_f32 v98, v98
    v_exp_f32_e64 v99, v99
    v_cvt_pk_bf16_f32 v108, v84, v85
    v_cvt_pk_bf16_f32 v109, v86, v87
    v_cvt_pk_bf16_f32 v110, v88, v89
    v_cvt_pk_bf16_f32 v111, v90, v91
    v_cvt_pk_bf16_f32 v112, v92, v93
    v_cvt_pk_bf16_f32 v113, v94, v95
    v_cvt_pk_bf16_f32 v114, v96, v97
    v_cvt_pk_bf16_f32 v115, v98, v99
    s_bitcmp1_b32 s81, 2
    s_cbranch_scc1 aq_11
    s_waitcnt vmcnt(1)
    v_sub_u32 v126, v126, v122
    v_cmp_gt_u32 vcc, 16, v126
    s_nop 0
    s_or_b32 s81, s81, vcc_lo
    s_bitcmp1_b32 s81, 2
    s_nop 0
    s_cbranch_scc1 aq_11
    s_mov_b32 s49, s44
    s_mov_b64 exec, 15
    buffer_load_dword v126, v125, s[4:7], 0 offen sc1
    s_nop 7
    s_nop 7
kp_12:
    buffer_load_dword v127, v125, s[4:7], 0 offen sc1
    s_waitcnt vmcnt(1)
    v_sub_u32 v126, v126, v122
    v_cmp_gt_u32 vcc, 16, v126
    s_nop 0
    s_or_b32 s81, s81, vcc_lo
    s_and_b32 s48, s81, 4
    s_cmp_eq_u32 s48, 4
    s_cbranch_scc1 kp_12_ok
    buffer_load_dword v126, v125, s[4:7], 0 offen sc1
    s_waitcnt vmcnt(1)
    v_sub_u32 v127, v127, v122
    v_cmp_gt_u32 vcc, 16, v127
    s_nop 0
    s_or_b32 s81, s81, vcc_lo
    s_and_b32 s48, s81, 4
    s_cmp_eq_u32 s48, 4
    s_cbranch_scc1 kp_12_ok
    s_add_u32 s49, s49, 1
    s_cmp_lt_u32 s49, 2000000
    s_cbranch_scc1 kp_12
    s_mov_b32 s44, 2000000
kp_12_ok:
    s_mov_b64 exec, -1
aq_11:
    v_exp_f32 v68, v68
    v_exp_f32 v69, v69
    v_exp_f32 v70, v70
    s_add_u32 m0, s78, 0
    v_exp_f32 v71, v71
    s_waitcnt lgkmcnt(0)
    v_mfma_f32_32x32x16_bf16 v[84:99], v[12:15], v[8:11], 0
    v_exp_f32 v72, v72
    buffer_load_dwordx4 v0, s[4:7], s60 offen offset:1024 sc1 lds
    v_exp_f32 v73, v73
    v_exp_f32 v74, v74
    s_add_u32 m0, s78, 0
    v_exp_f32 v75, v75
    v_exp_f32_e64 v76, v76
    v_mfma_f32_32x32x16_bf16 v[52:67], v[44:47], v[108:111], v[52:67]
    buffer_load_dwordx4 v0, s[4:7], s61 offen offset:2048 sc1 lds
    v_exp_f32 v77, v77
    v_exp_f32 v78, v78
    v_exp_f32 v79, v79
    v_exp_f32 v80, v80
    v_exp_f32 v81, v81
    v_mfma_f32_32x32x16_bf16 v[52:67], v[48:51], v[112:115], v[52:67]
    v_exp_f32 v82, v82
    v_exp_f32_e64 v83, v83
    v_cvt_pk_bf16_f32 v100, v68, v69
    v_cvt_pk_bf16_f32 v101, v70, v71
    v_cvt_pk_bf16_f32 v102, v72, v73
    v_cvt_pk_bf16_f32 v103, v74, v75
    v_cvt_pk_bf16_f32 v104, v76, v77
    v_cvt_pk_bf16_f32 v105, v78, v79
    v_cvt_pk_bf16_f32 v106, v80, v81
    v_cvt_pk_bf16_f32 v107, v82, v83
    v_mfma_f32_32x32x16_bf16 v[68:83], v[12:15], v[16:19], 0
    v_exp_f32 v84, v84
    v_exp_f32 v85, v85
    v_exp_f32 v86, v86
    v_exp_f32 v87, v87
    v_exp_f32 v88, v88
    v_mfma_f32_32x32x16_bf16 v[24:39], v[44:47], v[100:103], v[24:39]
    v_exp_f32 v89, v89
    v_exp_f32 v90, v90
    v_exp_f32 v91, v91
    v_exp_f32 v92, v92
    v_exp_f32 v93, v93
    v_mfma_f32_32x32x16_bf16 v[24:39], v[48:51], v[104:107], v[24:39]
    v_exp_f32 v94, v94
    s_waitcnt vmcnt(5)
    ds_read_b128 v[44:47], v21
    ds_read_b128 v[48:51], v21 offset:256
    ds_read_b128 v[12:15], v120 offset:4096
    v_exp_f32 v95, v95
    v_exp_f32 v96, v96
    buffer_load_dword v126, v125, s[4:7], 0 offen sc1
    v_exp_f32 v97, v97
    v_exp_f32 v98, v98
    v_exp_f32_e64 v99, v99
    v_cvt_pk_bf16_f32 v108, v84, v85
    v_cvt_pk_bf16_f32 v109, v86, v87
    v_cvt_pk_bf16_f32 v110, v88, v89
    v_cvt_pk_bf16_f32 v111, v90, v91
    v_cvt_pk_bf16_f32 v112, v92, v93
    v_cvt_pk_bf16_f32 v113, v94, v95
    v_cvt_pk_bf16_f32 v114, v96, v97
    v_cvt_pk_bf16_f32 v115, v98, v99
    s_cmp_lg_u32 s41, 0
    s_cbranch_scc1 L_div
    v_exp_f32 v68, v68
    v_exp_f32 v69, v69
    s_mul_i32 s55, s3, 24576
    s_lshl_b32 s59, s39, 7
    s_add_u32 s55, s55, s59
    s_mul_i32 s56, s3, 3072
    s_add_u32 s56, s56, 65536
    s_add_u32 m0, s56, 0
    s_xor_b32 s59, s72, 0
    s_mul_i32 s59, s59, 98304
    s_add_u32 s59, s59, s55
    buffer_load_dwordx4 v5, s[16:19], s59 offen offset:0 lds
    v_exp_f32 v70, v70
    s_add_u32 m0, s78, 0
    v_exp_f32 v71, v71
    s_waitcnt lgkmcnt(0)
    v_mfma_f32_32x32x16_bf16 v[84:99], v[12:15], v[8:11], 0
    v_exp_f32 v72, v72
    buffer_load_dwordx4 v0, s[4:7], s61 offen offset:3072 sc1 lds
    v_exp_f32 v73, v73
    v_exp_f32 v74, v74
    s_add_u32 m0, s78, 4096
    v_exp_f32 v75, v75
    v_exp_f32 v76, v76
    v_mfma_f32_32x32x16_bf16 v[52:67], v[44:47], v[108:111], v[52:67]
    buffer_load_dwordx4 v0, s[4:7], s61 offen offset:0 sc1 lds
    v_exp_f32 v77, v77
    v_exp_f32 v78, v78
    v_exp_f32 v79, v79
    s_add_u32 m0, s56, 0
    s_nop 0
    buffer_load_dwordx4 v5, s[16:19], s59 offen offset:1024 lds
    v_exp_f32 v80, v80
    v_exp_f32 v81, v81
    v_mfma_f32_32x32x16_bf16 v[52:67], v[48:51], v[112:115], v[52:67]
    v_exp_f32 v82, v82
    s_add_u32 m0, s56, 0
    s_nop 0
    buffer_load_dwordx4 v5, s[16:19], s59 offen offset:2048 lds
    v_exp_f32_e64 v83, v83
    v_cvt_pk_bf16_f32 v100, v68, v69
    v_cvt_pk_bf16_f32 v101, v70, v71
    v_cvt_pk_bf16_f32 v102, v72, v73
    v_cvt_pk_bf16_f32 v103, v74, v75
    v_cvt_pk_bf16_f32 v104, v76, v77
    v_cvt_pk_bf16_f32 v105, v78, v79
    v_cvt_pk_bf16_f32 v106, v80, v81
    v_cvt_pk_bf16_f32 v107, v82, v83
    v_mfma_f32_32x32x16_bf16 v[68:83], v[12:15], v[16:19], 0
    v_exp_f32 v84, v84
    v_exp_f32 v85, v85
    s_add_u32 m0, s56, 12288
    s_xor_b32 s59, s72, 1
    s_mul_i32 s59, s59, 98304
    s_add_u32 s59, s59, s55
    buffer_load_dwordx4 v5, s[16:19], s59 offen offset:0 lds
    v_exp_f32 v86, v86
    v_exp_f32 v87, v87
    v_exp_f32 v88, v88
    v_mfma_f32_32x32x16_bf16 v[24:39], v[44:47], v[100:103], v[24:39]
    v_exp_f32 v89, v89
    v_exp_f32 v90, v90
    v_exp_f32 v91, v91
    v_exp_f32 v92, v92
    v_exp_f32 v93, v93
    v_mfma_f32_32x32x16_bf16 v[24:39], v[48:51], v[104:107], v[24:39]
    v_exp_f32 v94, v94
    s_cmp_eq_u32 s40, 1
    s_cbranch_scc1 z_18
z_18_b:
    s_waitcnt vmcnt(5)
    ds_read_b128 v[44:47], v22
    ds_read_b128 v[48:51], v22 offset:256
    ds_read_b128 v[12:15], v120 offset:0
    v_exp_f32 v95, v95
    s_add_u32 m0, s56, 12288
    s_nop 0
    buffer_load_dwordx4 v5, s[16:19], s59 offen offset:1024 lds
    v_exp_f32 v96, v96
    v_exp_f32 v97, v97
    v_exp_f32 v98, v98
    s_add_u32 m0, s56, 12288
    s_nop 0
    buffer_load_dwordx4 v5, s[16:19], s59 offen offset:2048 lds
    v_exp_f32_e64 v99, v99
    v_cvt_pk_bf16_f32 v108, v84, v85
    v_cvt_pk_bf16_f32 v109, v86, v87
    v_cvt_pk_bf16_f32 v110, v88, v89
    v_cvt_pk_bf16_f32 v111, v90, v91
    v_cvt_pk_bf16_f32 v112, v92, v93
    v_cvt_pk_bf16_f32 v113, v94, v95
    v_cvt_pk_bf16_f32 v114, v96, v97
    v_cvt_pk_bf16_f32 v115, v98, v99
    s_bitcmp1_b32 s81, 3
    s_cbranch_scc1 aq_19
    s_waitcnt vmcnt(2)
    v_sub_u32 v126, v126, v122
    v_cmp_gt_u32 vcc, 16, v126
    s_nop 0
    s_or_b32 s81, s81, vcc_lo
    s_bitcmp1_b32 s81, 3
    s_nop 0
    s_cbranch_scc1 aq_19
    s_mov_b32 s49, s44
    s_mov_b64 exec, 15
    buffer_load_dword v126, v125, s[4:7], 0 offen sc1
    s_nop 7
    s_nop 7
kp_20:
    buffer_load_dword v127, v125, s[4:7], 0 offen sc1
    s_waitcnt vmcnt(1)
    v_sub_u32 v126, v126, v122
    v_cmp_gt_u32 vcc, 16, v126
    s_nop 0
    s_or_b32 s81, s81, vcc_lo
    s_and_b32 s48, s81, 8
    s_cmp_eq_u32 s48, 8
    s_cbranch_scc1 kp_20_ok
    buffer_load_dword v126, v125, s[4:7], 0 offen sc1
    s_waitcnt vmcnt(1)
    v_sub_u32 v127, v127, v122
    v_cmp_gt_u32 vcc, 16, v127
    s_nop 0
    s_or_b32 s81, s81, vcc_lo
    s_and_b32 s48, s81, 8
    s_cmp_eq_u32 s48, 8
    s_cbranch_scc1 kp_20_ok
    s_add_u32 s49, s49, 1
    s_cmp_lt_u32 s49, 2000000
    s_cbranch_scc1 kp_20
    s_mov_b32 s44, 2000000
kp_20_ok:
    s_mov_b64 exec, -1
aq_19:
    v_exp_f32 v68, v68
    v_exp_f32 v69, v69
    s_add_u32 m0, s56, 24576
    s_xor_b32 s59, s72, 2
    s_mul_i32 s59, s59, 98304
    s_add_u32 s59, s59, s55
    buffer_load_dwordx4 v5, s[16:19], s59 offen offset:0 lds
    v_exp_f32 v70, v70
    s_add_u32 m0, s78, 4096
    v_exp_f32 v71, v71
    s_waitcnt lgkmcnt(0)
    v_mfma_f32_32x32x16_bf16 v[84:99], v[12:15], v[8:11], 0
    v_exp_f32 v72, v72
    buffer_load_dwordx4 v0, s[4:7], s61 offen offset:1024 sc1 lds
    v_exp_f32 v73, v73
    v_exp_f32 v74, v74
    s_add_u32 m0, s78, -2048
    v_exp_f32 v75, v75
    v_exp_f32_e64 v76, v76
    v_mfma_f32_32x32x16_bf16 v[52:67], v[44:47], v[108:111], v[52:67]
    buffer_load_dwordx4 v0, s[4:7], s62 offen offset:2048 sc1 lds
    v_exp_f32 v77, v77
    v_exp_f32 v78, v78
    v_exp_f32 v79, v79
    s_add_u32 m0, s56, 24576
    s_nop 0
    buffer_load_dwordx4 v5, s[16:19], s59 offen offset:1024 lds
    v_exp_f32 v80, v80
    v_exp_f32 v81, v81
    v_mfma_f32_32x32x16_bf16 v[52:67], v[48:51], v[112:115], v[52:67]
    v_exp_f32 v82, v82
    s_add_u32 m0, s56, 24576
    s_nop 0
    buffer_load_dwordx4 v5, s[16:19], s59 offen offset:2048 lds
    v_exp_f32_e64 v83, v83
    v_cvt_pk_bf16_f32 v100, v68, v69
    v_cvt_pk_bf16_f32 v101, v70, v71
    v_cvt_pk_bf16_f32 v102, v72, v73
    v_cvt_pk_bf16_f32 v103, v74, v75
    v_cvt_pk_bf16_f32 v104, v76, v77
    v_cvt_pk_bf16_f32 v105, v78, v79
    v_cvt_pk_bf16_f32 v106, v80, v81
    v_cvt_pk_bf16_f32 v107, v82, v83
    v_mfma_f32_32x32x16_bf16 v[68:83], v[12:15], v[16:19], 0
    v_exp_f32 v84, v84
    v_exp_f32 v85, v85
    s_add_u32 m0, s56, 36864
    s_xor_b32 s59, s72, 3
    s_mul_i32 s59, s59, 98304
    s_add_u32 s59, s59, s55
    buffer_load_dwordx4 v5, s[16:19], s59 offen offset:0 lds
    v_exp_f32 v86, v86
    v_exp_f32 v87, v87
    v_exp_f32 v88, v88
    v_mfma_f32_32x32x16_bf16 v[24:39], v[44:47], v[100:103], v[24:39]
    v_exp_f32 v89, v89
    v_exp_f32 v90, v90
    v_exp_f32 v91, v91
    v_exp_f32 v92, v92
    v_exp_f32 v93, v93
    v_mfma_f32_32x32x16_bf16 v[24:39], v[48:51], v[104:107], v[24:39]
    v_exp_f32 v94, v94
    s_waitcnt vmcnt(5)
    ds_read_b128 v[44:47], v20
    ds_read_b128 v[48:51], v20 offset:256
    ds_read_b128 v[12:15], v120 offset:2048
    v_exp_f32 v95, v95
    s_add_u32 m0, s56, 36864
    s_nop 0
    buffer_load_dwordx4 v5, s[16:19], s59 offen offset:1024 lds
    v_exp_f32 v96, v96
    v_exp_f32 v97, v97
    v_exp_f32 v98, v98
    s_add_u32 m0, s56, 36864
    s_nop 0
    buffer_load_dwordx4 v5, s[16:19], s59 offen offset:2048 lds
    v_exp_f32_e64 v99, v99
    v_cvt_pk_bf16_f32 v108, v84, v85
    v_cvt_pk_bf16_f32 v109, v86, v87
    v_cvt_pk_bf16_f32 v110, v88, v89
    v_cvt_pk_bf16_f32 v111, v90, v91
    v_cvt_pk_bf16_f32 v112, v92, v93
    v_cvt_pk_bf16_f32 v113, v94, v95
    v_cvt_pk_bf16_f32 v114, v96, v97
    v_cvt_pk_bf16_f32 v115, v98, v99
    v_exp_f32_e64 v68, v68
    s_add_u32 m0, s1, 32768
    s_xor_b32 s58, s0, 262144
    buffer_load_dwordx4 v238, s[20:23], s58 offen lds
    v_exp_f32 v69, v69
    v_exp_f32 v70, v70
    s_add_u32 m0, s78, -2048
    v_exp_f32 v71, v71
    s_waitcnt lgkmcnt(0)
    v_mfma_f32_32x32x16_bf16 v[84:99], v[12:15], v[8:11], 0
    v_exp_f32 v72, v72
    buffer_load_dwordx4 v0, s[4:7], s62 offen offset:3072 sc1 lds
    v_exp_f32 v73, v73
    v_exp_f32 v74, v74
    s_add_u32 m0, s78, 2048
    v_exp_f32 v75, v75
    v_exp_f32_e64 v76, v76
    v_mfma_f32_32x32x16_bf16 v[52:67], v[44:47], v[108:111], v[52:67]
    buffer_load_dwordx4 v0, s[4:7], s62 offen offset:0 sc1 lds
    v_exp_f32 v77, v77
    v_exp_f32 v78, v78
    v_exp_f32_e64 v79, v79
    s_add_u32 m0, s1, 36864
    s_xor_b32 s58, s0, 294912
    buffer_load_dwordx4 v238, s[20:23], s58 offen lds
    v_exp_f32 v80, v80
    v_exp_f32 v81, v81
    v_mfma_f32_32x32x16_bf16 v[52:67], v[48:51], v[112:115], v[52:67]
    v_exp_f32_e64 v82, v82
    s_add_u32 m0, s1, 40960
    s_xor_b32 s58, s0, 327680
    buffer_load_dwordx4 v238, s[20:23], s58 offen lds
    v_exp_f32_e64 v83, v83
    v_cvt_pk_bf16_f32 v100, v68, v69
    v_cvt_pk_bf16_f32 v101, v70, v71
    v_cvt_pk_bf16_f32 v102, v72, v73
    v_cvt_pk_bf16_f32 v103, v74, v75
    v_cvt_pk_bf16_f32 v104, v76, v77
    v_cvt_pk_bf16_f32 v105, v78, v79
    v_cvt_pk_bf16_f32 v106, v80, v81
    v_cvt_pk_bf16_f32 v107, v82, v83
    v_mfma_f32_32x32x16_bf16 v[68:83], v[12:15], v[16:19], 0
    v_exp_f32 v84, v84
    v_exp_f32 v85, v85
    s_add_u32 m0, s1, 45056
    s_xor_b32 s58, s0, 360448
    buffer_load_dwordx4 v238, s[20:23], s58 offen lds
    v_exp_f32 v86, v86
    v_exp_f32 v87, v87
    v_exp_f32 v88, v88
    v_mfma_f32_32x32x16_bf16 v[24:39], v[44:47], v[100:103], v[24:39]
    v_exp_f32 v89, v89
    s_add_u32 m0, s1, 49152
    s_xor_b32 s58, s0, 393216
    buffer_load_dwordx4 v238, s[20:23], s58 offen lds
    v_exp_f32 v90, v90
    v_exp_f32 v91, v91
    v_exp_f32 v92, v92
    v_exp_f32 v93, v93
    v_mfma_f32_32x32x16_bf16 v[24:39], v[48:51], v[104:107], v[24:39]
    v_exp_f32 v94, v94
    s_cmp_eq_u32 s40, 2
    s_cbranch_scc1 z_21
z_21_b:
    s_waitcnt vmcnt(9)
    ds_read_b128 v[44:47], v21
    ds_read_b128 v[48:51], v21 offset:256
    ds_read_b128 v[12:15], v120 offset:4096
    v_exp_f32_e64 v95, v95
    s_add_u32 m0, s1, 53248
    s_xor_b32 s58, s0, 425984
    buffer_load_dwordx4 v238, s[20:23], s58 offen lds
    v_exp_f32 v96, v96
    v_exp_f32 v97, v97
    v_exp_f32_e64 v98, v98
    s_add_u32 m0, s1, 57344
    s_xor_b32 s58, s0, 458752
    buffer_load_dwordx4 v238, s[20:23], s58 offen lds
    v_exp_f32_e64 v99, v99
    v_cvt_pk_bf16_f32 v108, v84, v85
    v_cvt_pk_bf16_f32 v109, v86, v87
    v_cvt_pk_bf16_f32 v110, v88, v89
    v_cvt_pk_bf16_f32 v111, v90, v91
    v_cvt_pk_bf16_f32 v112, v92, v93
    v_cvt_pk_bf16_f32 v113, v94, v95
    v_cvt_pk_bf16_f32 v114, v96, v97
    v_cvt_pk_bf16_f32 v115, v98, v99
    v_exp_f32_e64 v68, v68
    s_add_u32 m0, s1, 61440
    s_xor_b32 s58, s0, 491520
    buffer_load_dwordx4 v238, s[20:23], s58 offen lds
    v_exp_f32 v69, v69
    v_exp_f32 v70, v70
    s_add_u32 m0, s78, 2048
    v_exp_f32 v71, v71
    s_waitcnt lgkmcnt(0)
    v_mfma_f32_32x32x16_bf16 v[84:99], v[12:15], v[8:11], 0
    v_exp_f32 v72, v72
    buffer_load_dwordx4 v0, s[4:7], s62 offen offset:1024 sc1 lds
    v_exp_f32 v73, v73
    v_exp_f32 v74, v74
    v_exp_f32 v75, v75
    v_xor_b32_e64 v23, 4, v250
    v_mad_u32_u24 v23, v23, s79, v249
    s_mov_b64 exec, 0xffffff
    buffer_load_dword v123, v23, s[16:19], 0 offen
    s_mov_b64 exec, -1
    v_exp_f32 v76, v76
    v_mfma_f32_32x32x16_bf16 v[52:67], v[44:47], v[108:111], v[52:67]
    v_exp_f32 v77, v77
    v_xor_b32 v23, 8, v250
    v_mad_u32_u24 v23, v23, s79, v249
    s_mov_b64 exec, 0xffffff
    buffer_load_dword v123, v23, s[16:19], 0 offen
    s_mov_b64 exec, -1
    v_exp_f32 v78, v78
    v_exp_f32 v79, v79
    v_xor_b32 v23, 12, v250
    v_mad_u32_u24 v23, v23, s79, v249
    s_mov_b64 exec, 0xffffff
    buffer_load_dword v123, v23, s[16:19], 0 offen
    s_mov_b64 exec, -1
    v_exp_f32 v80, v80
    v_exp_f32 v81, v81
    v_mfma_f32_32x32x16_bf16 v[52:67], v[48:51], v[112:115], v[52:67]
    v_exp_f32 v82, v82
    v_exp_f32_e64 v83, v83
    v_cvt_pk_bf16_f32 v100, v68, v69
    v_cvt_pk_bf16_f32 v101, v70, v71
    v_cvt_pk_bf16_f32 v102, v72, v73
    v_cvt_pk_bf16_f32 v103, v74, v75
    v_cvt_pk_bf16_f32 v104, v76, v77
    v_cvt_pk_bf16_f32 v105, v78, v79
    v_cvt_pk_bf16_f32 v106, v80, v81
    v_cvt_pk_bf16_f32 v107, v82, v83
    v_mfma_f32_32x32x16_bf16 v[68:83], v[12:15], v[16:19], 0
    v_exp_f32 v84, v84
    v_exp_f32 v85, v85
    v_exp_f32 v86, v86
    v_exp_f32 v87, v87
    v_exp_f32 v88, v88
    v_mfma_f32_32x32x16_bf16 v[24:39], v[44:47], v[100:103], v[24:39]
    v_exp_f32 v89, v89
    v_exp_f32 v90, v90
    v_exp_f32 v91, v91
    v_exp_f32 v92, v92
    v_exp_f32 v93, v93
    v_mfma_f32_32x32x16_bf16 v[24:39], v[48:51], v[104:107], v[24:39]
    v_exp_f32 v94, v94
    s_waitcnt vmcnt(14)
    ds_read_b128 v[44:47], v22
    ds_read_b128 v[48:51], v22 offset:256
    ds_read_b128 v[12:15], v120 offset:0
    v_exp_f32 v95, v95
    v_exp_f32 v96, v96
    v_exp_f32 v97, v97
    v_exp_f32 v98, v98
    v_exp_f32_e64 v99, v99
    v_cvt_pk_bf16_f32 v108, v84, v85
    v_cvt_pk_bf16_f32 v109, v86, v87
    v_cvt_pk_bf16_f32 v110, v88, v89
    v_cvt_pk_bf16_f32 v111, v90, v91
    v_cvt_pk_bf16_f32 v112, v92, v93
    v_cvt_pk_bf16_f32 v113, v94, v95
    v_cvt_pk_bf16_f32 v114, v96, v97
    v_cvt_pk_bf16_f32 v115, v98, v99
    v_exp_f32 v68, v68
    v_exp_f32 v69, v69
    v_exp_f32 v70, v70
    v_exp_f32 v71, v71
    s_waitcnt lgkmcnt(0)
    v_mfma_f32_32x32x16_bf16 v[84:99], v[12:15], v[8:11], 0
    v_exp_f32 v72, v72
    v_exp_f32 v73, v73
    v_exp_f32 v74, v74
    v_exp_f32 v75, v75
    v_exp_f32 v76, v76
    v_mfma_f32_32x32x16_bf16 v[52:67], v[44:47], v[108:111], v[52:67]
    v_exp_f32 v77, v77
    v_exp_f32 v78, v78
    v_exp_f32 v79, v79
    v_exp_f32 v80, v80
    v_exp_f32 v81, v81
    v_mfma_f32_32x32x16_bf16 v[52:67], v[48:51], v[112:115], v[52:67]
    v_exp_f32 v82, v82
    v_exp_f32_e64 v83, v83
    v_cvt_pk_bf16_f32 v100, v68, v69
    v_cvt_pk_bf16_f32 v101, v70, v71
    v_cvt_pk_bf16_f32 v102, v72, v73
    v_cvt_pk_bf16_f32 v103, v74, v75
    v_cvt_pk_bf16_f32 v104, v76, v77
    v_cvt_pk_bf16_f32 v105, v78, v79
    v_cvt_pk_bf16_f32 v106, v80, v81
    v_cvt_pk_bf16_f32 v107, v82, v83
    v_mfma_f32_32x32x16_bf16 v[68:83], v[12:15], v[16:19], 0
    v_exp_f32 v84, v84
    v_exp_f32 v85, v85
    v_exp_f32 v86, v86
    v_exp_f32 v87, v87
    v_exp_f32 v88, v88
    v_mfma_f32_32x32x16_bf16 v[24:39], v[44:47], v[100:103], v[24:39]
    v_exp_f32 v89, v89
    v_exp_f32 v90, v90
    v_exp_f32 v91, v91
    v_exp_f32 v92, v92
    v_exp_f32 v93, v93
    v_mfma_f32_32x32x16_bf16 v[24:39], v[48:51], v[104:107], v[24:39]
    v_exp_f32 v94, v94
    s_cmp_eq_u32 s40, 3
    s_cbranch_scc1 z_22
z_22_b:
    s_waitcnt vmcnt(11)
    ds_read_b128 v[44:47], v20
    ds_read_b128 v[48:51], v20 offset:256
    ds_read_b128 v[12:15], v120 offset:2048
    v_exp_f32 v95, v95
    v_exp_f32 v96, v96
    v_exp_f32 v97, v97
    v_exp_f32 v98, v98
    v_exp_f32_e64 v99, v99
    v_cvt_pk_bf16_f32 v108, v84, v85
    v_cvt_pk_bf16_f32 v109, v86, v87
    v_cvt_pk_bf16_f32 v110, v88, v89
    v_cvt_pk_bf16_f32 v111, v90, v91
    v_cvt_pk_bf16_f32 v112, v92, v93
    v_cvt_pk_bf16_f32 v113, v94, v95
    v_cvt_pk_bf16_f32 v114, v96, v97
    v_cvt_pk_bf16_f32 v115, v98, v99
    v_exp_f32 v68, v68
    v_exp_f32 v69, v69
    v_exp_f32 v70, v70
    v_exp_f32 v71, v71
    s_waitcnt lgkmcnt(0)
    v_mfma_f32_32x32x16_bf16 v[84:99], v[12:15], v[8:11], 0
    v_exp_f32 v72, v72
    v_exp_f32 v73, v73
    v_exp_f32 v74, v74
    v_exp_f32 v75, v75
    v_exp_f32 v76, v76
    v_mfma_f32_32x32x16_bf16 v[52:67], v[44:47], v[108:111], v[52:67]
    v_exp_f32 v77, v77
    v_exp_f32 v78, v78
    v_exp_f32 v79, v79
    v_exp_f32 v80, v80
    v_exp_f32 v81, v81
    v_mfma_f32_32x32x16_bf16 v[52:67], v[48:51], v[112:115], v[52:67]
    v_exp_f32 v82, v82
    v_exp_f32_e64 v83, v83
    v_cvt_pk_bf16_f32 v100, v68, v69
    v_cvt_pk_bf16_f32 v101, v70, v71
    v_cvt_pk_bf16_f32 v102, v72, v73
    v_cvt_pk_bf16_f32 v103, v74, v75
    v_cvt_pk_bf16_f32 v104, v76, v77
    v_cvt_pk_bf16_f32 v105, v78, v79
    v_cvt_pk_bf16_f32 v106, v80, v81
    v_cvt_pk_bf16_f32 v107, v82, v83
    v_bfi_b32 v100, v40, 0, v100
    v_bfi_b32 v101, v41, 0, v101
    v_bfi_b32 v102, v42, 0, v102
    v_bfi_b32 v103, v43, 0, v103
    v_bfi_b32 v104, v116, 0, v104
    v_bfi_b32 v105, v117, 0, v105
    v_bfi_b32 v106, v118, 0, v106
    v_bfi_b32 v107, v119, 0, v107
    v_exp_f32 v84, v84
    v_exp_f32 v85, v85
    v_exp_f32 v86, v86
    v_exp_f32 v87, v87
    v_exp_f32 v88, v88
    v_mfma_f32_32x32x16_bf16 v[24:39], v[44:47], v[100:103], v[24:39]
    v_exp_f32 v89, v89
    v_exp_f32 v90, v90
    v_exp_f32 v91, v91
    v_exp_f32 v92, v92
    v_exp_f32 v93, v93
    v_mfma_f32_32x32x16_bf16 v[24:39], v[48:51], v[104:107], v[24:39]
    v_exp_f32 v94, v94
    s_waitcnt vmcnt(3)
    ds_read_b128 v[44:47], v21
    ds_read_b128 v[48:51], v21 offset:256
    v_exp_f32 v95, v95
    v_exp_f32 v96, v96
    v_exp_f32 v97, v97
    v_exp_f32 v98, v98
    v_exp_f32_e64 v99, v99
    v_cvt_pk_bf16_f32 v108, v84, v85
    v_cvt_pk_bf16_f32 v109, v86, v87
    v_cvt_pk_bf16_f32 v110, v88, v89
    v_cvt_pk_bf16_f32 v111, v90, v91
    v_cvt_pk_bf16_f32 v112, v92, v93
    v_cvt_pk_bf16_f32 v113, v94, v95
    v_cvt_pk_bf16_f32 v114, v96, v97
    v_cvt_pk_bf16_f32 v115, v98, v99
    v_bfi_b32 v108, v40, 0, v108
    v_bfi_b32 v109, v41, 0, v109
    v_bfi_b32 v110, v42, 0, v110
    v_bfi_b32 v111, v43, 0, v111
    v_bfi_b32 v112, v116, 0, v112
    v_bfi_b32 v113, v117, 0, v113
    v_bfi_b32 v114, v118, 0, v114
    v_bfi_b32 v115, v119, 0, v115
    s_waitcnt lgkmcnt(0)
L_div_e:
    v_mfma_f32_32x32x16_bf16 v[52:67], v[44:47], v[108:111], v[52:67]
    v_mfma_f32_32x32x16_bf16 v[52:67], v[48:51], v[112:115], v[52:67]
    s_mov_b32 s57, 0x21800000
    s_mov_b32 s58, 0x5d800000
    v_lshrrev_b32 v120, 1, v3
    v_lshl_add_u32 v120, v120, 4, v2
    v_lshlrev_b32 v120, 4, v120
    v_and_b32 v6, 1, v3
    v_lshl_add_u32 v120, v6, 9, v120
    v_rcp_f32 v32, v32
    s_nop 0
    v_pk_mul_f32 v[24:25], v[24:25], v[32:33] op_sel:[0,0] op_sel_hi:[1,0]
    v_pk_mul_f32 v[26:27], v[26:27], v[32:33] op_sel:[0,0] op_sel_hi:[1,0]
    v_pk_mul_f32 v[28:29], v[28:29], v[32:33] op_sel:[0,0] op_sel_hi:[1,0]
    v_pk_mul_f32 v[30:31], v[30:31], v[32:33] op_sel:[0,0] op_sel_hi:[1,0]
    v_cvt_pk_bf16_f32 v104, v24, v25
    v_cvt_pk_bf16_f32 v105, v26, v27
    v_cvt_pk_bf16_f32 v106, v28, v29
    v_cvt_pk_bf16_f32 v107, v30, v31
    s_nop 0
    v_permlane32_swap_b32 v104, v106
    v_permlane32_swap_b32 v105, v107
    s_cmp_lg_u32 s42, 0
    s_cbranch_scc0 st_23_s
    buffer_store_dwordx4 v[104:107], v120, s[4:7], s75 offen
st_23:
    v_rcp_f32_e64 v60, v60
    s_nop 0
    v_pk_mul_f32 v[52:53], v[52:53], v[60:61] op_sel:[0,0] op_sel_hi:[1,0]
    v_pk_mul_f32 v[54:55], v[54:55], v[60:61] op_sel:[0,0] op_sel_hi:[1,0]
    v_pk_mul_f32 v[56:57], v[56:57], v[60:61] op_sel:[0,0] op_sel_hi:[1,0]
    v_pk_mul_f32 v[58:59], v[58:59], v[60:61] op_sel:[0,0] op_sel_hi:[1,0]
    v_cvt_pk_bf16_f32 v100, v52, v53
    v_cvt_pk_bf16_f32 v101, v54, v55
    v_cvt_pk_bf16_f32 v102, v56, v57
    v_cvt_pk_bf16_f32 v103, v58, v59
    s_nop 0
    v_permlane32_swap_b32 v100, v102
    v_permlane32_swap_b32 v101, v103
    s_cmp_lg_u32 s42, 0
    s_cbranch_scc0 st_24_s
    buffer_store_dwordx4 v[100:103], v120, s[4:7], s74 offen
st_24:
    v_pk_mul_f32 v[6:7], v[24:25], 0 op_sel_hi:[1,0]
    v_pk_fma_f32 v[6:7], v[26:27], 0, v[6:7] op_sel_hi:[1,0,1]
    v_pk_fma_f32 v[6:7], v[28:29], 0, v[6:7] op_sel_hi:[1,0,1]
    v_pk_fma_f32 v[6:7], v[30:31], 0, v[6:7] op_sel_hi:[1,0,1]
    v_add_f32 v6, v6, v7
    v_add_f32 v6, v6, v32
    v_cmp_le_f32 vcc, s57, v6
    v_cmp_ge_f32 s[48:49], s58, v6
    s_nop 0
    s_and_b64 vcc, vcc, s[48:49]
    s_cmp_eq_u64 vcc, exec
    s_nop 0
    s_cbranch_scc0 aa_5_s1
aa_5_ok1:
    v_pk_mul_f32 v[6:7], v[52:53], 0 op_sel_hi:[1,0]
    v_pk_fma_f32 v[6:7], v[54:55], 0, v[6:7] op_sel_hi:[1,0,1]
    v_pk_fma_f32 v[6:7], v[56:57], 0, v[6:7] op_sel_hi:[1,0,1]
    v_pk_fma_f32 v[6:7], v[58:59], 0, v[6:7] op_sel_hi:[1,0,1]
    v_add_f32 v6, v6, v7
    v_add_f32 v6, v6, v60
    v_cmp_le_f32 vcc, s57, v6
    v_cmp_ge_f32 s[48:49], s58, v6
    s_nop 0
    s_and_b64 vcc, vcc, s[48:49]
    s_cmp_eq_u64 vcc, exec
    s_nop 0
    s_cbranch_scc0 aa_5_s0
aa_5_ok0:
    s_cmp_lg_u32 s41, 0
    s_cbranch_scc1 L_oa_r
    v_lshlrev_b32 v7, 11, v2
    v_lshl_add_u32 v7, v3, 3, v7
    buffer_load_dwordx2 v[88:89], v7, s[8:11], s84 offen offset:0
    buffer_load_dwordx2 v[90:91], v7, s[8:11], s84 offen offset:32
    buffer_load_dwordx2 v[92:93], v7, s[8:11], s84 offen offset:64
    buffer_load_dwordx2 v[94:95], v7, s[8:11], s84 offen offset:96
    v_mov_b32_e64 v246, v5
    v_bfe_u32 v245, v1, 3, 1
    v_bfe_u32 v244, v1, 4, 1
    v_lshl_or_b32 v245, v244, 1, v245
    v_xor_b32 v245, s3, v245
    v_lshlrev_b32 v245, 5, v245
    v_and_b32_e64 v244, 3, v1
    v_lshl_add_u32 v245, v244, 3, v245
    v_bfe_u32 v244, v1, 2, 2
    v_lshl_add_u32 v245, v244, 7, v245
    v_mul_u32_u24 v244, 3072, v3
    v_add_u32_e64 v247, v245, v244
    v_add_u32 v247, 65536, v247
    v_mov_b32 v228, 0x3f803f80
    v_mov_b32 v229, 0x3f803f80
    v_mov_b32 v230, 0x3f803f80
    v_mov_b32 v231, 0x3f803f80
    s_mul_i32 s55, s3, 24576
    s_lshl_b32 s59, s39, 7
    s_add_u32 s55, s55, s59
    s_mul_i32 s60, s3, 3072
    s_add_u32 s60, s60, 65536
    v_bfe_u32 v5, v1, 3, 1
    v_bfe_u32 v6, v1, 4, 1
    v_lshl_or_b32 v5, v6, 1, v5
    v_xor_b32 v5, 0, v5
    v_lshlrev_b32 v5, 5, v5
    v_and_b32_e64 v6, 3, v1
    v_lshl_add_u32 v5, v6, 3, v5
    v_bfe_u32 v6, v1, 2, 2
    v_lshl_add_u32 v5, v6, 7, v5
    v_mul_u32_u24 v6, 1024, v3
    v_add_u32 v4, v5, v6
    v_xor_b32 v5, 32, v4
    v_xor_b32 v52, 64, v4
    v_xor_b32 v120, 96, v4
    s_add_u32 s48, s43, 2
    v_mov_b32 v6, s48
    s_cmp_lg_u32 s42, 0
    s_mov_b64 exec, 1
    s_waitcnt vmcnt(4)
    s_cbranch_scc0 sig_26_s
    buffer_store_dword v6, off, s[4:7], s47
sig_26:
    s_mov_b64 exec, -1
    v_lshrrev_b32 v6, 1, v3
    v_and_b32 v7, 1, v3
    v_lshlrev_b32_e64 v122, 4, v2
    v_lshl_add_u32 v6, v7, 1, v6
    v_lshl_add_u32 v122, v6, 8, v122
    v_lshrrev_b32 v6, 5, v1
    v_lshl_add_u32 v7, v6, 9, v0
    s_mov_b32 s56, s83
    s_barrier
    ds_read_b64_tr_b16 a[192:193], v247 offset:0
    ds_read_b64_tr_b16 a[194:195], v247 offset:512
    ds_read_b64_tr_b16 v[128:129], v247 offset:1024
    ds_read_b64_tr_b16 v[130:131], v247 offset:1536
    ds_read_b64_tr_b16 v[192:193], v247 offset:2048
    ds_read_b64_tr_b16 v[194:195], v247 offset:2560
    ds_read_b64_tr_b16 a[196:197], v247 offset:12288
    ds_read_b64_tr_b16 a[198:199], v247 offset:12800
    ds_read_b64_tr_b16 v[132:133], v247 offset:13312
    ds_read_b64_tr_b16 v[134:135], v247 offset:13824
    ds_read_b64_tr_b16 v[196:197], v247 offset:14336
    ds_read_b64_tr_b16 v[198:199], v247 offset:14848
    ds_read_b64_tr_b16 a[200:201], v247 offset:24576
    ds_read_b64_tr_b16 a[202:203], v247 offset:25088
    ds_read_b64_tr_b16 v[136:137], v247 offset:25600
    ds_read_b64_tr_b16 v[138:139], v247 offset:26112
    ds_read_b64_tr_b16 v[200:201], v247 offset:26624
    ds_read_b64_tr_b16 v[202:203], v247 offset:27136
    ds_read_b64_tr_b16 a[204:205], v247 offset:36864
    ds_read_b64_tr_b16 a[206:207], v247 offset:37376
    ds_read_b64_tr_b16 v[140:141], v247 offset:37888
    ds_read_b64_tr_b16 v[142:143], v247 offset:38400
    ds_read_b64_tr_b16 v[204:205], v247 offset:38912
    ds_read_b64_tr_b16 v[206:207], v247 offset:39424
    ds_read_b64_tr_b16 v[56:57], v4 offset:0
    ds_read_b64_tr_b16 v[58:59], v4 offset:512
    ds_read_b64_tr_b16 v[60:61], v5 offset:0
    ds_read_b64_tr_b16 v[62:63], v5 offset:512
    ds_read_b64_tr_b16 v[64:65], v52 offset:0
    ds_read_b64_tr_b16 v[66:67], v52 offset:512
    ds_read_b64_tr_b16 v[68:69], v120 offset:0
    ds_read_b64_tr_b16 v[70:71], v120 offset:512
    ds_read_b64_tr_b16 v[72:73], v4 offset:4096
    ds_read_b64_tr_b16 v[74:75], v4 offset:4608
    ds_read_b64_tr_b16 v[76:77], v5 offset:4096
    ds_read_b64_tr_b16 v[78:79], v5 offset:4608
    ds_read_b64_tr_b16 v[80:81], v52 offset:4096
    ds_read_b64_tr_b16 v[82:83], v52 offset:4608
    ds_read_b64_tr_b16 v[84:85], v120 offset:4096
    ds_read_b64_tr_b16 v[86:87], v120 offset:4608
    s_mov_b32 exec_hi, 0
    buffer_load_dword v126, v124, s[4:7], 0 offen sc1
    s_mov_b32 exec_hi, -1
    s_waitcnt vmcnt(2)
    v_lshlrev_b32 v104, 16, v88
    v_and_b32 v105, 0xffff0000, v88
    v_lshlrev_b32 v106, 16, v89
    v_and_b32 v107, 0xffff0000, v89
    v_lshlrev_b32 v108, 16, v90
    v_and_b32 v109, 0xffff0000, v90
    v_lshlrev_b32 v110, 16, v91
    v_and_b32 v111, 0xffff0000, v91
    v_lshlrev_b32 v112, 16, v92
    v_and_b32 v113, 0xffff0000, v92
    v_lshlrev_b32 v114, 16, v93
    v_and_b32 v115, 0xffff0000, v93
    v_lshlrev_b32 v116, 16, v94
    v_and_b32 v117, 0xffff0000, v94
    v_lshlrev_b32 v118, 16, v95
    v_and_b32 v119, 0xffff0000, v95
    s_waitcnt lgkmcnt(15)
    s_barrier
    v_mfma_f32_16x16x32_bf16 v[232:235], a[192:195], v[228:231], 0
    s_add_u32 m0, s60, 49152
    s_xor_b32 s59, s72, 4
    s_mul_i32 s59, s59, 98304
    s_add_u32 s59, s59, s55
    buffer_load_dwordx4 v246, s[16:19], s59 offen offset:0 lds
    v_mfma_f32_16x16x32_bf16 v[236:239], v[128:131], v[228:231], 0
    v_mfma_f32_16x16x32_bf16 v[240:243], v[228:231], v[192:195], 0
    v_mfma_f32_16x16x32_bf16 v[232:235], a[196:199], v[228:231], v[232:235]
    v_mfma_f32_16x16x32_bf16 v[236:239], v[132:135], v[228:231], v[236:239]
    buffer_load_dwordx4 v246, s[16:19], s59 offen offset:1024 lds
    v_mfma_f32_16x16x32_bf16 v[240:243], v[228:231], v[196:199], v[240:243]
    v_mfma_f32_16x16x32_bf16 v[232:235], a[200:203], v[228:231], v[232:235]
    v_mfma_f32_16x16x32_bf16 v[236:239], v[136:139], v[228:231], v[236:239]
    v_mfma_f32_16x16x32_bf16 v[240:243], v[228:231], v[200:203], v[240:243]
    buffer_load_dwordx4 v246, s[16:19], s59 offen offset:2048 lds
    v_mfma_f32_16x16x32_bf16 v[232:235], a[204:207], v[228:231], v[232:235]
    v_mfma_f32_16x16x32_bf16 v[236:239], v[140:143], v[228:231], v[236:239]
    v_mfma_f32_16x16x32_bf16 v[240:243], v[228:231], v[204:207], v[240:243]
    s_mov_b32 s50, 0xffffffff
    s_mov_b32 s51, 0x0
    s_add_i32 s48, s43, 2
    s_mov_b32 s49, s44
    s_mov_b64 exec, s[50:51]
poll_27:
    buffer_load_dword v127, v124, s[4:7], 0 offen sc1
    s_waitcnt vmcnt(1)
    v_subrev_u32 v126, s48, v126
    v_cmp_gt_u32 vcc, 16, v126
    s_nop 0
    s_cmp_eq_u64 vcc, s[50:51]
    s_nop 1
    s_cbranch_scc1 poll_27_ok
    buffer_load_dword v126, v124, s[4:7], 0 offen sc1
    s_waitcnt vmcnt(1)
    v_subrev_u32 v127, s48, v127
    v_cmp_gt_u32 vcc, 16, v127
    s_nop 0
    s_cmp_eq_u64 vcc, s[50:51]
    s_nop 1
    s_cbranch_scc1 poll_27_ok
    s_add_u32 s49, s49, 1
    s_cmp_lt_u32 s49, 2000000
    s_cbranch_scc1 poll_27
    s_mov_b32 s44, 2000000
poll_27_ok:
    s_mov_b64 exec, -1
    buffer_load_dwordx4 v[8:11], v7, s[4:7], s56 offen offset:0 sc1
    buffer_load_dwordx4 v[12:15], v7, s[4:7], s56 offen offset:2048 sc1
    s_xor_b32 s56, s83, 4096
    buffer_load_dwordx4 v[16:19], v7, s[4:7], s56 offen offset:0 sc1
    buffer_load_dwordx4 v[20:23], v7, s[4:7], s56 offen offset:2048 sc1
    s_xor_b32 s56, s83, 8192
    buffer_load_dwordx4 v[24:27], v7, s[4:7], s56 offen offset:0 sc1
    buffer_load_dwordx4 v[28:31], v7, s[4:7], s56 offen offset:2048 sc1
    s_waitcnt vmcnt(5) lgkmcnt(8)
    v_mfma_f32_16x16x32_bf16 v[104:107], v[56:59], v[8:11], v[104:107]
    s_xor_b32 s56, s83, 12288
    buffer_load_dwordx4 v[32:35], v7, s[4:7], s56 offen offset:0 sc1
    ds_read_b64_tr_b16 v[88:89], v4 offset:8192
    v_mfma_f32_16x16x32_bf16 v[108:111], v[60:63], v[8:11], v[108:111]
    ds_read_b64_tr_b16 v[90:91], v4 offset:8704
    ds_read_b64_tr_b16 v[92:93], v5 offset:8192
    v_mfma_f32_16x16x32_bf16 v[112:115], v[64:67], v[8:11], v[112:115]
    ds_read_b64_tr_b16 v[94:95], v5 offset:8704
    ds_read_b64_tr_b16 v[96:97], v52 offset:8192
    ds_read_b64_tr_b16 v[98:99], v52 offset:8704
    v_mfma_f32_16x16x32_bf16 v[116:119], v[68:71], v[8:11], v[116:119]
    ds_read_b64_tr_b16 v[100:101], v120 offset:8192
    ds_read_b64_tr_b16 v[102:103], v120 offset:8704
    s_waitcnt vmcnt(5) lgkmcnt(8)
    v_mfma_f32_16x16x32_bf16 v[104:107], v[72:75], v[12:15], v[104:107]
    buffer_load_dwordx4 v[36:39], v7, s[4:7], s56 offen offset:2048 sc1
    ds_read_b64_tr_b16 v[56:57], v4 offset:12288
    ds_read_b64_tr_b16 v[58:59], v4 offset:12800
    v_mfma_f32_16x16x32_bf16 v[108:111], v[76:79], v[12:15], v[108:111]
    ds_read_b64_tr_b16 v[60:61], v5 offset:12288
    ds_read_b64_tr_b16 v[62:63], v5 offset:12800
    v_mfma_f32_16x16x32_bf16 v[112:115], v[80:83], v[12:15], v[112:115]
    ds_read_b64_tr_b16 v[64:65], v52 offset:12288
    ds_read_b64_tr_b16 v[66:67], v52 offset:12800
    v_mfma_f32_16x16x32_bf16 v[116:119], v[84:87], v[12:15], v[116:119]
    ds_read_b64_tr_b16 v[68:69], v120 offset:12288
    ds_read_b64_tr_b16 v[70:71], v120 offset:12800
    s_waitcnt vmcnt(5) lgkmcnt(8)
    v_mfma_f32_16x16x32_bf16 v[104:107], v[88:91], v[16:19], v[104:107]
    s_xor_b32 s56, s83, 16384
    buffer_load_dwordx4 v[40:43], v7, s[4:7], s56 offen offset:0 sc1
    ds_read_b64_tr_b16 v[72:73], v4 offset:16384
    v_mfma_f32_16x16x32_bf16 v[108:111], v[92:95], v[16:19], v[108:111]
    ds_read_b64_tr_b16 v[74:75], v4 offset:16896
    ds_read_b64_tr_b16 v[76:77], v5 offset:16384
    v_mfma_f32_16x16x32_bf16 v[112:115], v[96:99], v[16:19], v[112:115]
    ds_read_b64_tr_b16 v[78:79], v5 offset:16896
    ds_read_b64_tr_b16 v[80:81], v52 offset:16384
    ds_read_b64_tr_b16 v[82:83], v52 offset:16896
    v_mfma_f32_16x16x32_bf16 v[116:119], v[100:103], v[16:19], v[116:119]
    ds_read_b64_tr_b16 v[84:85], v120 offset:16384
    ds_read_b64_tr_b16 v[86:87], v120 offset:16896
    s_waitcnt vmcnt(5) lgkmcnt(8)
    v_mfma_f32_16x16x32_bf16 v[104:107], v[56:59], v[20:23], v[104:107]
    buffer_load_dwordx4 v[44:47], v7, s[4:7], s56 offen offset:2048 sc1
    ds_read_b64_tr_b16 v[88:89], v4 offset:20480
    ds_read_b64_tr_b16 v[90:91], v4 offset:20992
    v_mfma_f32_16x16x32_bf16 v[108:111], v[60:63], v[20:23], v[108:111]
    ds_read_b64_tr_b16 v[92:93], v5 offset:20480
    ds_read_b64_tr_b16 v[94:95], v5 offset:20992
    v_mfma_f32_16x16x32_bf16 v[112:115], v[64:67], v[20:23], v[112:115]
    ds_read_b64_tr_b16 v[96:97], v52 offset:20480
    ds_read_b64_tr_b16 v[98:99], v52 offset:20992
    v_mfma_f32_16x16x32_bf16 v[116:119], v[68:71], v[20:23], v[116:119]
    ds_read_b64_tr_b16 v[100:101], v120 offset:20480
    ds_read_b64_tr_b16 v[102:103], v120 offset:20992
    s_waitcnt vmcnt(5) lgkmcnt(8)
    v_mfma_f32_16x16x32_bf16 v[104:107], v[72:75], v[24:27], v[104:107]
    s_xor_b32 s56, s83, 20480
    buffer_load_dwordx4 v[48:51], v7, s[4:7], s56 offen offset:0 sc1
    ds_read_b64_tr_b16 v[56:57], v4 offset:24576
    v_mfma_f32_16x16x32_bf16 v[108:111], v[76:79], v[24:27], v[108:111]
    ds_read_b64_tr_b16 v[58:59], v4 offset:25088
    ds_read_b64_tr_b16 v[60:61], v5 offset:24576
    v_mfma_f32_16x16x32_bf16 v[112:115], v[80:83], v[24:27], v[112:115]
    ds_read_b64_tr_b16 v[62:63], v5 offset:25088
    ds_read_b64_tr_b16 v[64:65], v52 offset:24576
    ds_read_b64_tr_b16 v[66:67], v52 offset:25088
    v_mfma_f32_16x16x32_bf16 v[116:119], v[84:87], v[24:27], v[116:119]
    ds_read_b64_tr_b16 v[68:69], v120 offset:24576
    ds_read_b64_tr_b16 v[70:71], v120 offset:25088
    s_waitcnt vmcnt(5) lgkmcnt(8)
    v_mfma_f32_16x16x32_bf16 v[104:107], v[88:91], v[28:31], v[104:107]
    buffer_load_dwordx4 v[8:11], v7, s[4:7], s56 offen offset:2048 sc1
    ds_read_b64_tr_b16 v[72:73], v4 offset:28672
    ds_read_b64_tr_b16 v[74:75], v4 offset:29184
    v_mfma_f32_16x16x32_bf16 v[108:111], v[92:95], v[28:31], v[108:111]
    ds_read_b64_tr_b16 v[76:77], v5 offset:28672
    ds_read_b64_tr_b16 v[78:79], v5 offset:29184
    v_mfma_f32_16x16x32_bf16 v[112:115], v[96:99], v[28:31], v[112:115]
    ds_read_b64_tr_b16 v[80:81], v52 offset:28672
    ds_read_b64_tr_b16 v[82:83], v52 offset:29184
    v_mfma_f32_16x16x32_bf16 v[116:119], v[100:103], v[28:31], v[116:119]
    ds_read_b64_tr_b16 v[84:85], v120 offset:28672
    ds_read_b64_tr_b16 v[86:87], v120 offset:29184
    s_waitcnt vmcnt(5) lgkmcnt(8)
    v_mfma_f32_16x16x32_bf16 v[104:107], v[56:59], v[32:35], v[104:107]
    s_xor_b32 s56, s83, 24576
    buffer_load_dwordx4 v[12:15], v7, s[4:7], s56 offen offset:0 sc1
    ds_read_b64_tr_b16 v[88:89], v4 offset:32768
    v_mfma_f32_16x16x32_bf16 v[108:111], v[60:63], v[32:35], v[108:111]
    ds_read_b64_tr_b16 v[90:91], v4 offset:33280
    ds_read_b64_tr_b16 v[92:93], v5 offset:32768
    v_mfma_f32_16x16x32_bf16 v[112:115], v[64:67], v[32:35], v[112:115]
    ds_read_b64_tr_b16 v[94:95], v5 offset:33280
    ds_read_b64_tr_b16 v[96:97], v52 offset:32768
    ds_read_b64_tr_b16 v[98:99], v52 offset:33280
    v_mfma_f32_16x16x32_bf16 v[116:119], v[68:71], v[32:35], v[116:119]
    ds_read_b64_tr_b16 v[100:101], v120 offset:32768
    ds_read_b64_tr_b16 v[102:103], v120 offset:33280
    s_waitcnt vmcnt(5) lgkmcnt(8)
    v_mfma_f32_16x16x32_bf16 v[104:107], v[72:75], v[36:39], v[104:107]
    buffer_load_dwordx4 v[16:19], v7, s[4:7], s56 offen offset:2048 sc1
    ds_read_b64_tr_b16 v[56:57], v4 offset:36864
    ds_read_b64_tr_b16 v[58:59], v4 offset:37376
    v_mfma_f32_16x16x32_bf16 v[108:111], v[76:79], v[36:39], v[108:111]
    ds_read_b64_tr_b16 v[60:61], v5 offset:36864
    ds_read_b64_tr_b16 v[62:63], v5 offset:37376
    v_mfma_f32_16x16x32_bf16 v[112:115], v[80:83], v[36:39], v[112:115]
    ds_read_b64_tr_b16 v[64:65], v52 offset:36864
    ds_read_b64_tr_b16 v[66:67], v52 offset:37376
    v_mfma_f32_16x16x32_bf16 v[116:119], v[84:87], v[36:39], v[116:119]
    ds_read_b64_tr_b16 v[68:69], v120 offset:36864
    ds_read_b64_tr_b16 v[70:71], v120 offset:37376
    s_waitcnt vmcnt(5) lgkmcnt(8)
    v_mfma_f32_16x16x32_bf16 v[104:107], v[88:91], v[40:43], v[104:107]
    s_xor_b32 s56, s83, 28672
    buffer_load_dwordx4 v[20:23], v7, s[4:7], s56 offen offset:0 sc1
    ds_read_b64_tr_b16 v[72:73], v4 offset:40960
    v_mfma_f32_16x16x32_bf16 v[108:111], v[92:95], v[40:43], v[108:111]
    ds_read_b64_tr_b16 v[74:75], v4 offset:41472
    ds_read_b64_tr_b16 v[76:77], v5 offset:40960
    v_mfma_f32_16x16x32_bf16 v[112:115], v[96:99], v[40:43], v[112:115]
    ds_read_b64_tr_b16 v[78:79], v5 offset:41472
    ds_read_b64_tr_b16 v[80:81], v52 offset:40960
    ds_read_b64_tr_b16 v[82:83], v52 offset:41472
    v_mfma_f32_16x16x32_bf16 v[116:119], v[100:103], v[40:43], v[116:119]
    ds_read_b64_tr_b16 v[84:85], v120 offset:40960
    ds_read_b64_tr_b16 v[86:87], v120 offset:41472
    s_waitcnt vmcnt(5) lgkmcnt(8)
    v_mfma_f32_16x16x32_bf16 v[104:107], v[56:59], v[44:47], v[104:107]
    buffer_load_dwordx4 v[24:27], v7, s[4:7], s56 offen offset:2048 sc1
    ds_read_b64_tr_b16 v[88:89], v4 offset:45056
    ds_read_b64_tr_b16 v[90:91], v4 offset:45568
    v_mfma_f32_16x16x32_bf16 v[108:111], v[60:63], v[44:47], v[108:111]
    ds_read_b64_tr_b16 v[92:93], v5 offset:45056
    ds_read_b64_tr_b16 v[94:95], v5 offset:45568
    v_mfma_f32_16x16x32_bf16 v[112:115], v[64:67], v[44:47], v[112:115]
    ds_read_b64_tr_b16 v[96:97], v52 offset:45056
    ds_read_b64_tr_b16 v[98:99], v52 offset:45568
    v_mfma_f32_16x16x32_bf16 v[116:119], v[68:71], v[44:47], v[116:119]
    ds_read_b64_tr_b16 v[100:101], v120 offset:45056
    ds_read_b64_tr_b16 v[102:103], v120 offset:45568
    s_waitcnt vmcnt(5) lgkmcnt(8)
    v_mfma_f32_16x16x32_bf16 v[104:107], v[72:75], v[48:51], v[104:107]
    s_add_u32 m0, s60, 0
    s_xor_b32 s59, s72, 5
    s_mul_i32 s59, s59, 98304
    s_add_u32 s59, s59, s55
    buffer_load_dwordx4 v246, s[16:19], s59 offen offset:0 lds
    ds_read_b64_tr_b16 v[56:57], v4 offset:49152
    buffer_load_dwordx4 v246, s[16:19], s59 offen offset:1024 lds
    v_mfma_f32_16x16x32_bf16 v[108:111], v[76:79], v[48:51], v[108:111]
    ds_read_b64_tr_b16 v[58:59], v4 offset:49664
    ds_read_b64_tr_b16 v[60:61], v5 offset:49152
    v_mfma_f32_16x16x32_bf16 v[112:115], v[80:83], v[48:51], v[112:115]
    ds_read_b64_tr_b16 v[62:63], v5 offset:49664
    ds_read_b64_tr_b16 v[64:65], v52 offset:49152
    ds_read_b64_tr_b16 v[66:67], v52 offset:49664
    v_mfma_f32_16x16x32_bf16 v[116:119], v[84:87], v[48:51], v[116:119]
    ds_read_b64_tr_b16 v[68:69], v120 offset:49152
    ds_read_b64_tr_b16 v[70:71], v120 offset:49664
    s_waitcnt vmcnt(6) lgkmcnt(8)
    v_mfma_f32_16x16x32_bf16 v[104:107], v[88:91], v[8:11], v[104:107]
    buffer_load_dwordx4 v246, s[16:19], s59 offen offset:2048 lds
    ds_read_b64_tr_b16 v[72:73], v4 offset:53248
    s_add_u32 m0, s60, 12288
    s_xor_b32 s59, s72, 6
    s_mul_i32 s59, s59, 98304
    s_add_u32 s59, s59, s55
    buffer_load_dwordx4 v246, s[16:19], s59 offen offset:0 lds
    v_mfma_f32_16x16x32_bf16 v[108:111], v[92:95], v[8:11], v[108:111]
    ds_read_b64_tr_b16 v[74:75], v4 offset:53760
    ds_read_b64_tr_b16 v[76:77], v5 offset:53248
    v_mfma_f32_16x16x32_bf16 v[112:115], v[96:99], v[8:11], v[112:115]
    ds_read_b64_tr_b16 v[78:79], v5 offset:53760
    ds_read_b64_tr_b16 v[80:81], v52 offset:53248
    ds_read_b64_tr_b16 v[82:83], v52 offset:53760
    v_mfma_f32_16x16x32_bf16 v[116:119], v[100:103], v[8:11], v[116:119]
    ds_read_b64_tr_b16 v[84:85], v120 offset:53248
    ds_read_b64_tr_b16 v[86:87], v120 offset:53760
    s_waitcnt vmcnt(7) lgkmcnt(8)
    v_mfma_f32_16x16x32_bf16 v[104:107], v[56:59], v[12:15], v[104:107]
    buffer_load_dwordx4 v246, s[16:19], s59 offen offset:1024 lds
    ds_read_b64_tr_b16 v[88:89], v4 offset:57344
    ds_read_b64_tr_b16 v[90:91], v4 offset:57856
    v_mfma_f32_16x16x32_bf16 v[108:111], v[60:63], v[12:15], v[108:111]
    ds_read_b64_tr_b16 v[92:93], v5 offset:57344
    ds_read_b64_tr_b16 v[94:95], v5 offset:57856
    v_mfma_f32_16x16x32_bf16 v[112:115], v[64:67], v[12:15], v[112:115]
    ds_read_b64_tr_b16 v[96:97], v52 offset:57344
    ds_read_b64_tr_b16 v[98:99], v52 offset:57856
    v_mfma_f32_16x16x32_bf16 v[116:119], v[68:71], v[12:15], v[116:119]
    ds_read_b64_tr_b16 v[100:101], v120 offset:57344
    ds_read_b64_tr_b16 v[102:103], v120 offset:57856
    s_waitcnt vmcnt(7) lgkmcnt(8)
    v_mfma_f32_16x16x32_bf16 v[104:107], v[72:75], v[16:19], v[104:107]
    buffer_load_dwordx4 v246, s[16:19], s59 offen offset:2048 lds
    ds_read_b64_tr_b16 v[56:57], v4 offset:61440
    ds_read_b64_tr_b16 v[58:59], v4 offset:61952
    v_mfma_f32_16x16x32_bf16 v[108:111], v[76:79], v[16:19], v[108:111]
    ds_read_b64_tr_b16 v[60:61], v5 offset:61440
    ds_read_b64_tr_b16 v[62:63], v5 offset:61952
    v_mfma_f32_16x16x32_bf16 v[112:115], v[80:83], v[16:19], v[112:115]
    ds_read_b64_tr_b16 v[64:65], v52 offset:61440
    ds_read_b64_tr_b16 v[66:67], v52 offset:61952
    v_mfma_f32_16x16x32_bf16 v[116:119], v[84:87], v[16:19], v[116:119]
    ds_read_b64_tr_b16 v[68:69], v120 offset:61440
    ds_read_b64_tr_b16 v[70:71], v120 offset:61952
    s_waitcnt vmcnt(7) lgkmcnt(8)
    v_mfma_f32_16x16x32_bf16 v[104:107], v[88:91], v[20:23], v[104:107]
    v_mfma_f32_16x16x32_bf16 v[108:111], v[92:95], v[20:23], v[108:111]
    s_waitcnt vmcnt(6) lgkmcnt(0)
    v_mfma_f32_16x16x32_bf16 v[104:107], v[56:59], v[24:27], v[104:107]
    v_mfma_f32_16x16x32_bf16 v[108:111], v[60:63], v[24:27], v[108:111]
    v_mfma_f32_16x16x32_bf16 v[112:115], v[96:99], v[20:23], v[112:115]
    v_mfma_f32_16x16x32_bf16 v[116:119], v[100:103], v[20:23], v[116:119]
    s_nop 4
    v_cvt_pk_bf16_f32 v40, v104, v105
    v_cvt_pk_bf16_f32 v41, v106, v107
    v_cvt_pk_bf16_f32 v42, v108, v109
    v_mfma_f32_16x16x32_bf16 v[112:115], v[64:67], v[24:27], v[112:115]
    v_cvt_pk_bf16_f32 v43, v110, v111
    v_permlane16_swap_b32 v40, v42
    v_mfma_f32_16x16x32_bf16 v[116:119], v[68:71], v[24:27], v[116:119]
    v_permlane16_swap_b32 v41, v43
    s_cmp_lg_u32 s42, 0
    s_cbranch_scc0 st_28_s
    buffer_store_dwordx4 v[40:43], v122, s[12:15], s85 offen offset:0
st_28:
    v_add_u32_e64 v48, s78, v122
    v_cvt_pk_bf16_f32 v60, v112, v113
    v_cvt_pk_bf16_f32 v61, v114, v115
    s_nop 0
    v_cvt_pk_bf16_f32 v62, v116, v117
    v_cvt_pk_bf16_f32 v63, v118, v119
    s_nop 0
    v_permlane16_swap_b32 v60, v62
    v_permlane16_swap_b32 v61, v63
    s_cmp_lg_u32 s42, 0
    s_cbranch_scc0 st_29_s
    buffer_store_dwordx4 v[60:63], v122, s[12:15], s85 offen offset:1024
st_29:
    ds_write_b128 v48, v[40:43]
    ds_write_b128 v48, v[60:63] offset:1024
    v_pk_mul_f32 v[46:47], v[104:105], v[104:105]
    v_pk_add_f32 v[44:45], v[104:105], v[106:107]
    v_pk_fma_f32 v[46:47], v[106:107], v[106:107], v[46:47]
    v_pk_fma_f32 v[46:47], v[108:109], v[108:109], v[46:47]
    v_pk_add_f32 v[44:45], v[44:45], v[108:109]
    v_pk_fma_f32 v[46:47], v[110:111], v[110:111], v[46:47]
    v_pk_add_f32 v[44:45], v[44:45], v[110:111]
    v_pk_fma_f32 v[46:47], v[112:113], v[112:113], v[46:47]
    v_pk_add_f32 v[44:45], v[44:45], v[112:113]
    v_pk_fma_f32 v[46:47], v[114:115], v[114:115], v[46:47]
    v_pk_add_f32 v[44:45], v[44:45], v[114:115]
    v_pk_fma_f32 v[46:47], v[116:117], v[116:117], v[46:47]
    v_pk_add_f32 v[44:45], v[44:45], v[116:117]
    v_pk_fma_f32 v[46:47], v[118:119], v[118:119], v[46:47]
    v_pk_add_f32 v[44:45], v[44:45], v[118:119]
    v_add_f32 v112, v44, v45
    v_add_f32 v113, v46, v47
    v_lshlrev_b32 v114, 6, v2
    s_nop 0
    v_permlane32_swap_b32 v112, v113
    v_add_f32 v112, v112, v113
    v_mov_b32 v113, v112
    s_nop 1
    v_permlane16_swap_b32 v112, v113
    v_add_f32 v112, v112, v113
    v_mov_b32 v113, v112
    s_nop 1
    v_permlane32_swap_b32 v112, v113
    s_add_u32 s48, s43, 3
    v_mov_b32 v6, s48
    s_cmp_lg_u32 s42, 0
    s_mov_b64 exec, 1
    s_waitcnt vmcnt(0)
    s_cbranch_scc0 sig_30_s
    buffer_store_dword v6, off, s[4:7], s47
sig_30:
    s_mov_b64 exec, -1
    s_cmp_lg_u32 s42, 0
    s_cbranch_scc0 st_31_s
    s_mov_b64 exec, 0xffff
    buffer_store_dwordx2 v[112:113], v114, s[4:7], s86 offen
    s_mov_b64 exec, -1
st_31:
    s_cmp_eq_u32 s38, 3
    s_cselect_b32 s54, s3, 0
    s_cselect_b32 s48, 0, s3
    s_lshr_b32 s54, s54, 1
    s_cmp_lt_u32 s48, 2
    s_cbranch_scc1 op_25_nohalo
    s_cmp_lg_u32 s42, 0
    s_cbranch_scc0 st_32_s
    s_mov_b32 exec_lo, 0xff00ff00
    s_mov_b32 exec_hi, 0xff00ff00
    buffer_store_dwordx4 v[40:43], v122, s[4:7], s87 offen
    buffer_store_dwordx4 v[60:63], v122, s[4:7], s87 offen offset:1024
    s_mov_b64 exec, 0xff00
    buffer_store_dwordx2 v[112:113], v114, s[4:7], s88 offen
    s_mov_b64 exec, -1
st_32:
op_25_nohalo:
    s_mov_b64 s[16:17], s[32:33]
    v_bfe_u32 v6, v1, 4, 1
    s_and_b32 s48, s3, 1
    s_lshl_b32 s48, s48, 1
    v_or_b32 v6, s48, v6
    v_lshlrev_b32 v6, 1, v6
    v_and_b32 v5, 7, v1
    v_xor_b32 v5, v5, v6
    v_lshlrev_b32 v5, 4, v5
    v_lshrrev_b32 v6, 3, v1
    v_mul_u32_u24 v6, 3072, v6
    v_add_u32 v5, v5, v6
    s_mul_i32 s55, s3, 24576
    s_lshl_b32 s56, s39, 7
    s_add_u32 s55, s55, s56
    s_mul_i32 s56, s3, 3072
    s_add_u32 s56, s56, 65536
    v_add_u32 v120, 131072, v0
    v_bfe_u32 v6, v1, 3, 1
    v_bfe_u32 v7, v1, 4, 1
    v_lshl_or_b32 v6, v7, 1, v6
    v_xor_b32 v6, s3, v6
    v_lshlrev_b32 v6, 5, v6
    v_and_b32_e64 v7, 3, v1
    v_lshl_add_u32 v6, v7, 3, v6
    v_bfe_u32 v7, v1, 2, 2
    v_lshl_add_u32 v6, v7, 7, v6
    v_mul_u32_u24 v7, 3072, v3
    v_add_u32_e64 v4, v6, v7
    v_add_u32 v4, 65536, v4
    v_mov_b32 v96, 0x3f803f80
    v_mov_b32 v97, 0x3f803f80
    v_mov_b32 v98, 0x3f803f80
    v_mov_b32 v99, 0x3f803f80
    v_lshlrev_b32 v121, 6, v2
    v_lshl_add_u32 v121, v3, 4, v121
    s_cmp_eq_u32 s40, 0
    s_cselect_b32 s62, 2147418112, s89
    s_cselect_b32 s63, 2147418112, s90
    s_add_u32 m0, s78, 2048
    s_xor_b32 s58, s85, 2048
    s_lshl_b32 s50, 0x11111111, s3
    s_mov_b32 s51, 0
    s_waitcnt lgkmcnt(0)
    s_barrier
    ds_read_b128 v[64:67], v120 offset:0
    ds_read_b128 v[68:71], v120 offset:6144
    ds_read_b128 v[72:75], v120 offset:12288
    ds_read_b128 v[76:79], v120 offset:18432
    ds_read_b64_tr_b16 a[208:209], v4 offset:49152
    ds_read_b64_tr_b16 a[210:211], v4 offset:49664
    ds_read_b64_tr_b16 v[144:145], v4 offset:50176
    ds_read_b64_tr_b16 v[146:147], v4 offset:50688
    ds_read_b64_tr_b16 v[208:209], v4 offset:51200
    ds_read_b64_tr_b16 v[210:211], v4 offset:51712
    ds_read_b64_tr_b16 a[212:213], v4 offset:0
    ds_read_b64_tr_b16 a[214:215], v4 offset:512
    ds_read_b64_tr_b16 v[148:149], v4 offset:1024
    ds_read_b64_tr_b16 v[150:151], v4 offset:1536
    ds_read_b64_tr_b16 v[212:213], v4 offset:2048
    ds_read_b64_tr_b16 v[214:215], v4 offset:2560
    ds_read_b64_tr_b16 a[216:217], v4 offset:12288
    ds_read_b64_tr_b16 a[218:219], v4 offset:12800
    ds_read_b64_tr_b16 v[152:153], v4 offset:13312
    ds_read_b64_tr_b16 v[154:155], v4 offset:13824
    ds_read_b64_tr_b16 v[216:217], v4 offset:14336
    ds_read_b64_tr_b16 v[218:219], v4 offset:14848
    s_add_i32 s48, s43, 3
    s_mov_b32 s49, s44
    s_mov_b64 exec, s[50:51]
    buffer_load_dword v126, v124, s[4:7], 0 offen sc1
    s_nop 7
    s_nop 7
poll_33:
    buffer_load_dword v127, v124, s[4:7], 0 offen sc1
    s_waitcnt vmcnt(1)
    v_subrev_u32 v126, s48, v126
    v_cmp_gt_u32 vcc, 16, v126
    s_nop 0
    s_cmp_eq_u64 vcc, s[50:51]
    s_nop 1
    s_cbranch_scc1 poll_33_ok
    buffer_load_dword v126, v124, s[4:7], 0 offen sc1
    s_waitcnt vmcnt(1)
    v_subrev_u32 v127, s48, v127
    v_cmp_gt_u32 vcc, 16, v127
    s_nop 0
    s_cmp_eq_u64 vcc, s[50:51]
    s_nop 1
    s_cbranch_scc1 poll_33_ok
    s_add_u32 s49, s49, 1
    s_cmp_lt_u32 s49, 2000000
    s_cbranch_scc1 poll_33
    s_mov_b32 s44, 2000000
poll_33_ok:
    s_mov_b64 exec, -1
    buffer_load_dwordx4 v0, s[12:15], s58 offen sc1 lds
    buffer_load_dwordx4 v0, s[12:15], s58 offen offset:1024 sc1 lds
    s_add_u32 s48, s43, 4
    v_mov_b32 v6, s48
    s_cmp_lg_u32 s42, 0
    s_mov_b64 exec, 1
    s_cbranch_scc0 sig_34_s
    buffer_store_dword v6, off, s[4:7], s47
sig_34:
    s_mov_b64 exec, -1
    s_cmp_eq_u32 s54, 0
    s_cselect_b32 s52, 2147418112, s87
    s_cselect_b32 s53, 2147418112, s88
    s_waitcnt lgkmcnt(15)
    v_mfma_f32_16x16x32_bf16 v[24:27], v[128:131], v[64:67], 0
    s_add_u32 m0, s78, 4096
    s_xor_b32 s58, s85, 4096
    v_mfma_f32_16x16x32_bf16 v[8:11], a[192:195], v[64:67], 0
    buffer_load_dwordx4 v0, s[12:15], s58 offen sc1 lds
    v_mfma_f32_16x16x32_bf16 v[28:31], v[128:131], v[68:71], 0
    ds_read_b128 v[80:83], v120 offset:1024
    v_mfma_f32_16x16x32_bf16 v[12:15], a[192:195], v[68:71], 0
    buffer_load_dwordx4 v0, s[12:15], s58 offen offset:1024 sc1 lds
    v_mfma_f32_16x16x32_bf16 v[32:35], v[128:131], v[72:75], 0
    ds_read_b128 v[84:87], v120 offset:7168
    v_mfma_f32_16x16x32_bf16 v[16:19], a[192:195], v[72:75], 0
    ds_read_b128 v[88:91], v120 offset:13312
    v_mfma_f32_16x16x32_bf16 v[36:39], v[128:131], v[76:79], 0
    s_mov_b32 exec_lo, 0xff00ff00
    s_mov_b32 exec_hi, 0xff00ff00
    buffer_store_dwordx4 v[40:43], v122, s[4:7], s52 offen sc1
    s_mov_b64 exec, -1
    v_mfma_f32_16x16x32_bf16 v[20:23], a[192:195], v[76:79], 0
    ds_read_b128 v[92:95], v120 offset:19456
    v_mfma_f32_16x16x32_bf16 v[44:47], v[64:67], v[192:195], 0
    s_mov_b32 exec_lo, 0xff00ff00
    s_mov_b32 exec_hi, 0xff00ff00
    buffer_store_dwordx4 v[60:63], v122, s[4:7], s52 offen offset:1024 sc1
    s_mov_b64 exec, -1
    v_mfma_f32_16x16x32_bf16 v[48:51], v[68:71], v[192:195], 0
    s_add_u32 s57, s43, 4
    v_mfma_f32_16x16x32_bf16 v[52:55], v[72:75], v[192:195], 0
    s_mov_b64 exec, 0xff00
    buffer_store_dwordx2 v[112:113], v114, s[4:7], s53 offen sc1
    s_mov_b64 exec, -1
    v_mfma_f32_16x16x32_bf16 v[56:59], v[76:79], v[192:195], 0
    s_waitcnt lgkmcnt(0)
    v_mfma_f32_16x16x32_bf16 v[100:103], a[208:211], v[96:99], v[232:235]
    s_lshl_b32 s60, 0x11111111, s3
    v_mfma_f32_16x16x32_bf16 v[104:107], v[144:147], v[96:99], v[236:239]
    v_mfma_f32_16x16x32_bf16 v[108:111], v[96:99], v[208:211], v[240:243]
    v_mfma_f32_16x16x32_bf16 v[100:103], a[212:215], v[96:99], v[100:103]
    v_mfma_f32_16x16x32_bf16 v[104:107], v[148:151], v[96:99], v[104:107]
    v_mfma_f32_16x16x32_bf16 v[108:111], v[96:99], v[212:215], v[108:111]
    v_mfma_f32_16x16x32_bf16 v[100:103], a[216:219], v[96:99], v[100:103]
    v_mfma_f32_16x16x32_bf16 v[104:107], v[152:155], v[96:99], v[104:107]
    v_mfma_f32_16x16x32_bf16 v[108:111], v[96:99], v[216:219], v[108:111]
    v_mfma_f32_16x16x32_bf16 v[24:27], v[132:135], v[80:83], v[24:27]
    v_mfma_f32_16x16x32_bf16 v[8:11], a[196:199], v[80:83], v[8:11]
    v_mfma_f32_16x16x32_bf16 v[28:31], v[132:135], v[84:87], v[28:31]
    v_mfma_f32_16x16x32_bf16 v[12:15], a[196:199], v[84:87], v[12:15]
    s_waitcnt vmcnt(6)
    s_barrier
    v_mfma_f32_16x16x32_bf16 v[32:35], v[132:135], v[88:91], v[32:35]
    s_add_u32 m0, s78, 0
    s_xor_b32 s58, s85, 6144
    v_mfma_f32_16x16x32_bf16 v[16:19], a[196:199], v[88:91], v[16:19]
    buffer_load_dwordx4 v0, s[12:15], s58 offen sc1 lds
    v_mfma_f32_16x16x32_bf16 v[36:39], v[132:135], v[92:95], v[36:39]
    buffer_load_dwordx4 v0, s[12:15], s58 offen offset:1024 sc1 lds
    s_add_u32 m0, s56, 24576
    s_xor_b32 s58, s72, 7
    v_mfma_f32_16x16x32_bf16 v[20:23], a[196:199], v[92:95], v[20:23]
    s_mul_i32 s58, s58, 98304
    s_add_u32 s58, s58, s55
    v_mfma_f32_16x16x32_bf16 v[44:47], v[80:83], v[196:199], v[44:47]
    buffer_load_dwordx4 v5, s[16:19], s58 offen offset:0 lds
    v_mfma_f32_16x16x32_bf16 v[48:51], v[84:87], v[196:199], v[48:51]
    buffer_load_dwordx4 v5, s[16:19], s58 offen offset:1024 lds
    v_mfma_f32_16x16x32_bf16 v[52:55], v[88:91], v[196:199], v[52:55]
    ds_read_b128 v[64:67], v120 offset:2048
    v_mfma_f32_16x16x32_bf16 v[56:59], v[92:95], v[196:199], v[56:59]
    buffer_load_dwordx4 v5, s[16:19], s58 offen offset:2048 lds
    ds_read_b128 v[68:71], v120 offset:8192
    ds_read_b128 v[72:75], v120 offset:14336
    ds_read_b128 v[76:79], v120 offset:20480
    s_waitcnt lgkmcnt(0)
    v_mfma_f32_16x16x32_bf16 v[24:27], v[136:139], v[64:67], v[24:27]
    ds_read_b128 v[80:83], v120 offset:3072
    v_mfma_f32_16x16x32_bf16 v[8:11], a[200:203], v[64:67], v[8:11]
    s_mov_b32 exec_hi, 0
    buffer_load_dword v126, v124, s[4:7], 0 offen sc1
    s_mov_b32 exec_hi, -1
    v_mfma_f32_16x16x32_bf16 v[28:31], v[136:139], v[68:71], v[28:31]
    s_add_u32 m0, s56, 36864
    s_xor_b32 s58, s72, 8
    v_mfma_f32_16x16x32_bf16 v[12:15], a[200:203], v[68:71], v[12:15]
    s_mul_i32 s58, s58, 98304
    s_add_u32 s58, s58, s55
    v_mfma_f32_16x16x32_bf16 v[32:35], v[136:139], v[72:75], v[32:35]
    buffer_load_dwordx4 v5, s[16:19], s58 offen offset:0 lds
    v_mfma_f32_16x16x32_bf16 v[16:19], a[200:203], v[72:75], v[16:19]
    ds_read_b128 v[84:87], v120 offset:9216
    v_mfma_f32_16x16x32_bf16 v[36:39], v[136:139], v[76:79], v[36:39]
    ds_read_b128 v[88:91], v120 offset:15360
    v_mfma_f32_16x16x32_bf16 v[20:23], a[200:203], v[76:79], v[20:23]
    buffer_load_dwordx4 v5, s[16:19], s58 offen offset:1024 lds
    v_mfma_f32_16x16x32_bf16 v[44:47], v[64:67], v[200:203], v[44:47]
    ds_read_b128 v[92:95], v120 offset:21504
    v_mfma_f32_16x16x32_bf16 v[48:51], v[68:71], v[200:203], v[48:51]
    v_mfma_f32_16x16x32_bf16 v[52:55], v[72:75], v[200:203], v[52:55]
    buffer_load_dwordx4 v5, s[16:19], s58 offen offset:2048 lds
    v_mfma_f32_16x16x32_bf16 v[56:59], v[76:79], v[200:203], v[56:59]
    s_waitcnt vmcnt(12) lgkmcnt(0)
    s_barrier
    v_mfma_f32_16x16x32_bf16 v[24:27], v[140:143], v[80:83], v[24:27]
    s_add_u32 m0, s78, 2048
    s_xor_b32 s58, s85, 8192
    v_mfma_f32_16x16x32_bf16 v[8:11], a[204:207], v[80:83], v[8:11]
    buffer_load_dwordx4 v0, s[12:15], s58 offen sc1 lds
    v_mfma_f32_16x16x32_bf16 v[28:31], v[140:143], v[84:87], v[28:31]
    ds_read_b128 v[64:67], v120 offset:4096
    v_mfma_f32_16x16x32_bf16 v[12:15], a[204:207], v[84:87], v[12:15]
    buffer_load_dwordx4 v0, s[12:15], s58 offen offset:1024 sc1 lds
    v_mfma_f32_16x16x32_bf16 v[32:35], v[140:143], v[88:91], v[32:35]
    s_add_u32 m0, s56, 49152
    s_xor_b32 s58, s72, 9
    v_mfma_f32_16x16x32_bf16 v[16:19], a[204:207], v[88:91], v[16:19]
    s_mul_i32 s58, s58, 98304
    s_add_u32 s58, s58, s55
    v_mfma_f32_16x16x32_bf16 v[36:39], v[140:143], v[92:95], v[36:39]
    buffer_load_dwordx4 v5, s[16:19], s58 offen offset:0 lds
    v_mfma_f32_16x16x32_bf16 v[20:23], a[204:207], v[92:95], v[20:23]
    ds_read_b128 v[68:71], v120 offset:10240
    v_mfma_f32_16x16x32_bf16 v[44:47], v[80:83], v[204:207], v[44:47]
    buffer_load_dwordx4 v5, s[16:19], s58 offen offset:1024 lds
    v_mfma_f32_16x16x32_bf16 v[48:51], v[84:87], v[204:207], v[48:51]
    ds_read_b128 v[72:75], v120 offset:16384
    v_mfma_f32_16x16x32_bf16 v[52:55], v[88:91], v[204:207], v[52:55]
    buffer_load_dwordx4 v5, s[16:19], s58 offen offset:2048 lds
    v_mfma_f32_16x16x32_bf16 v[56:59], v[92:95], v[204:207], v[56:59]
    ds_read_b128 v[76:79], v120 offset:22528
    s_waitcnt lgkmcnt(0)
    v_mfma_f32_16x16x32_bf16 v[24:27], v[144:147], v[64:67], v[24:27]
    s_add_u32 m0, s56, 0
    s_xor_b32 s58, s72, 10
    v_mfma_f32_16x16x32_bf16 v[8:11], a[208:211], v[64:67], v[8:11]
    s_mul_i32 s58, s58, 98304
    s_add_u32 s58, s58, s55
    v_mfma_f32_16x16x32_bf16 v[28:31], v[144:147], v[68:71], v[28:31]
    buffer_load_dwordx4 v5, s[16:19], s58 offen offset:0 lds
    v_mfma_f32_16x16x32_bf16 v[12:15], a[208:211], v[68:71], v[12:15]
    ds_read_b128 v[80:83], v120 offset:5120
    v_mfma_f32_16x16x32_bf16 v[32:35], v[144:147], v[72:75], v[32:35]
    ds_read_b128 v[84:87], v120 offset:11264
    v_mfma_f32_16x16x32_bf16 v[16:19], a[208:211], v[72:75], v[16:19]
    ds_read_b128 v[88:91], v120 offset:17408
    v_mfma_f32_16x16x32_bf16 v[36:39], v[144:147], v[76:79], v[36:39]
    buffer_load_dwordx4 v5, s[16:19], s58 offen offset:1024 lds
    v_mfma_f32_16x16x32_bf16 v[20:23], a[208:211], v[76:79], v[20:23]
    ds_read_b128 v[92:95], v120 offset:23552
    v_mfma_f32_16x16x32_bf16 v[44:47], v[64:67], v[208:211], v[44:47]
    s_waitcnt vmcnt(10)
    v_subrev_u32 v126, s57, v126
    v_cmp_le_u32 vcc, 16, v126
    s_nop 0
    s_and_b32 s48, vcc_lo, s60
    s_cbranch_scc1 sq_35_c
sq_35:
    buffer_load_dwordx4 v[40:43], v121, s[4:7], s77 offen sc1
    v_mfma_f32_16x16x32_bf16 v[48:51], v[68:71], v[208:211], v[48:51]
    s_cmp_eq_u32 s54, 0
    s_cselect_b32 s48, 2147418112, s47
    v_mfma_f32_16x16x32_bf16 v[52:55], v[72:75], v[208:211], v[52:55]
    buffer_load_dwordx4 v5, s[16:19], s58 offen offset:2048 lds
    v_mfma_f32_16x16x32_bf16 v[56:59], v[76:79], v[208:211], v[56:59]
    s_waitcnt vmcnt(9) lgkmcnt(0)
    s_barrier
    v_mfma_f32_16x16x32_bf16 v[24:27], v[148:151], v[80:83], v[24:27]
    s_add_u32 m0, s78, 4096
    s_xor_b32 s58, s85, 10240
    v_mov_b32 v6, s57
    v_mfma_f32_16x16x32_bf16 v[8:11], a[212:215], v[80:83], v[8:11]
    buffer_load_dwordx4 v0, s[12:15], s58 offen sc1 lds
    s_mov_b64 exec, 1
    buffer_store_dword v6, off, s[4:7], s48 offset:128 sc1
    s_mov_b64 exec, -1
    v_mfma_f32_16x16x32_bf16 v[28:31], v[148:151], v[84:87], v[28:31]
    ds_read_b64_tr_b16 a[220:221], v4 offset:24576
    ds_read_b64_tr_b16 a[222:223], v4 offset:25088
    v_mfma_f32_16x16x32_bf16 v[12:15], a[212:215], v[84:87], v[12:15]
    buffer_load_dwordx4 v0, s[12:15], s58 offen offset:1024 sc1 lds
    v_mfma_f32_16x16x32_bf16 v[32:35], v[148:151], v[88:91], v[32:35]
    s_add_u32 m0, s56, 12288
    s_xor_b32 s58, s72, 11
    v_mfma_f32_16x16x32_bf16 v[16:19], a[212:215], v[88:91], v[16:19]
    s_mul_i32 s58, s58, 98304
    s_add_u32 s58, s58, s55
    v_mfma_f32_16x16x32_bf16 v[36:39], v[148:151], v[92:95], v[36:39]
    buffer_load_dwordx4 v5, s[16:19], s58 offen offset:0 lds
    v_mfma_f32_16x16x32_bf16 v[20:23], a[212:215], v[92:95], v[20:23]
    ds_read_b64_tr_b16 v[156:157], v4 offset:25600
    ds_read_b64_tr_b16 v[158:159], v4 offset:26112
    v_mfma_f32_16x16x32_bf16 v[44:47], v[80:83], v[212:215], v[44:47]
    buffer_load_dwordx4 v5, s[16:19], s58 offen offset:1024 lds
    v_mfma_f32_16x16x32_bf16 v[48:51], v[84:87], v[212:215], v[48:51]
    ds_read_b64_tr_b16 v[220:221], v4 offset:26624
    ds_read_b64_tr_b16 v[222:223], v4 offset:27136
    v_mfma_f32_16x16x32_bf16 v[52:55], v[88:91], v[212:215], v[52:55]
    buffer_load_dwordx4 v5, s[16:19], s58 offen offset:2048 lds
    v_mfma_f32_16x16x32_bf16 v[56:59], v[92:95], v[212:215], v[56:59]
    ds_read_b128 v[64:67], v120 offset:0
    ds_read_b128 v[68:71], v120 offset:6144
    ds_read_b128 v[72:75], v120 offset:12288
    ds_read_b128 v[76:79], v120 offset:18432
    s_waitcnt lgkmcnt(0)
    v_mfma_f32_16x16x32_bf16 v[100:103], a[220:223], v[96:99], v[100:103]
    ds_read_b64_tr_b16 a[224:225], v4 offset:36864
    ds_read_b64_tr_b16 a[226:227], v4 offset:37376
    v_mfma_f32_16x16x32_bf16 v[104:107], v[156:159], v[96:99], v[104:107]
    ds_read_b64_tr_b16 v[160:161], v4 offset:37888
    ds_read_b64_tr_b16 v[162:163], v4 offset:38400
    v_mfma_f32_16x16x32_bf16 v[108:111], v[96:99], v[220:223], v[108:111]
    ds_read_b64_tr_b16 v[224:225], v4 offset:38912
    ds_read_b64_tr_b16 v[226:227], v4 offset:39424
    v_mfma_f32_16x16x32_bf16 v[24:27], v[152:155], v[64:67], v[24:27]
    ds_read_b128 v[80:83], v120 offset:1024
    ds_read_b128 v[84:87], v120 offset:7168
    v_mfma_f32_16x16x32_bf16 v[8:11], a[216:219], v[64:67], v[8:11]
    ds_read_b128 v[88:91], v120 offset:13312
    ds_read_b128 v[92:95], v120 offset:19456
    v_mfma_f32_16x16x32_bf16 v[28:31], v[152:155], v[68:71], v[28:31]
    s_waitcnt vmcnt(7)
    v_mfma_f32_16x16x32_bf16 v[12:15], a[216:219], v[68:71], v[12:15]
    v_add_f32 v112, v40, v42
    v_mfma_f32_16x16x32_bf16 v[32:35], v[152:155], v[72:75], v[32:35]
    v_add_f32 v113, v41, v43
    v_mfma_f32_16x16x32_bf16 v[16:19], a[216:219], v[72:75], v[16:19]
    s_nop 0
    v_permlane32_swap_b32 v112, v113
    v_mfma_f32_16x16x32_bf16 v[36:39], v[152:155], v[76:79], v[36:39]
    v_add_f32 v112, v112, v113
    v_mfma_f32_16x16x32_bf16 v[20:23], a[216:219], v[76:79], v[20:23]
    v_mov_b32 v113, v112
    v_mfma_f32_16x16x32_bf16 v[44:47], v[64:67], v[216:219], v[44:47]
    s_nop 0
    v_permlane16_swap_b32 v112, v113
    v_mfma_f32_16x16x32_bf16 v[48:51], v[68:71], v[216:219], v[48:51]
    v_add_f32 v112, v112, v113
    v_mfma_f32_16x16x32_bf16 v[52:55], v[72:75], v[216:219], v[52:55]
    v_mov_b32 v113, v112
    v_mfma_f32_16x16x32_bf16 v[56:59], v[76:79], v[216:219], v[56:59]
    s_waitcnt vmcnt(6) lgkmcnt(0)
    s_barrier
    v_mfma_f32_16x16x32_bf16 v[100:103], a[224:227], v[96:99], v[100:103]
    s_add_u32 m0, s78, 0
    s_xor_b32 s58, s85, 12288
    v_permlane32_swap_b32 v112, v113
    v_mfma_f32_16x16x32_bf16 v[104:107], v[160:163], v[96:99], v[104:107]
    buffer_load_dwordx4 v0, s[12:15], s58 offen sc1 lds
    v_mul_f32 v112, 0x3b000000, v112
    v_mul_f32 v113, 0x3b000000, v113
    v_mfma_f32_16x16x32_bf16 v[108:111], v[96:99], v[224:227], v[108:111]
    ds_read_b64_tr_b16 a[228:229], v4 offset:49152
    ds_read_b64_tr_b16 a[230:231], v4 offset:49664
    v_fma_f32 v113, -v112, v112, v113
    v_max_f32_e64 v113, 0, v113
    v_mfma_f32_16x16x32_bf16 v[24:27], v[156:159], v[80:83], v[24:27]
    ds_read_b64_tr_b16 v[164:165], v4 offset:50176
    ds_read_b64_tr_b16 v[166:167], v4 offset:50688
    v_cvt_pk_bf16_f32 v6, v112, v113
    v_lshlrev_b32_e64 v112, 16, v6
    v_mfma_f32_16x16x32_bf16 v[8:11], a[220:223], v[80:83], v[8:11]
    buffer_load_dwordx4 v0, s[12:15], s58 offen offset:1024 sc1 lds
    v_and_b32 v113, 0xffff0000, v6
    v_add_f32 v113, 0x3727c5ac, v113
    v_mfma_f32_16x16x32_bf16 v[28:31], v[156:159], v[84:87], v[28:31]
    s_add_u32 m0, s56, 24576
    s_xor_b32 s58, s72, 12
    v_cvt_pk_bf16_f32 v6, v113, v113
    v_and_b32 v113, 0xffff0000, v6
    v_mfma_f32_16x16x32_bf16 v[12:15], a[220:223], v[84:87], v[12:15]
    s_mul_i32 s58, s58, 98304
    s_add_u32 s58, s58, s55
    v_sqrt_f32_e64 v113, v113
    v_mfma_f32_16x16x32_bf16 v[32:35], v[156:159], v[88:91], v[32:35]
    buffer_load_dwordx4 v5, s[16:19], s58 offen offset:0 lds
    v_cvt_pk_bf16_f32 v6, v113, v113
    v_mfma_f32_16x16x32_bf16 v[16:19], a[220:223], v[88:91], v[16:19]
    ds_read_b64_tr_b16 v[228:229], v4 offset:51200
    ds_read_b64_tr_b16 v[230:231], v4 offset:51712
    v_mfma_f32_16x16x32_bf16 v[36:39], v[156:159], v[92:95], v[36:39]
    ds_read_b128 v[64:67], v120 offset:2048
    ds_read_b128 v[68:71], v120 offset:8192
    v_mfma_f32_16x16x32_bf16 v[20:23], a[220:223], v[92:95], v[20:23]
    buffer_load_dwordx4 v5, s[16:19], s58 offen offset:1024 lds
    v_mfma_f32_16x16x32_bf16 v[44:47], v[80:83], v[220:223], v[44:47]
    ds_read_b128 v[72:75], v120 offset:14336
    ds_read_b128 v[76:79], v120 offset:20480
    v_mfma_f32_16x16x32_bf16 v[48:51], v[84:87], v[220:223], v[48:51]
    v_mfma_f32_16x16x32_bf16 v[52:55], v[88:91], v[220:223], v[52:55]
    buffer_load_dwordx4 v5, s[16:19], s58 offen offset:2048 lds
    v_mfma_f32_16x16x32_bf16 v[56:59], v[92:95], v[220:223], v[56:59]
    s_waitcnt lgkmcnt(0)
    v_mfma_f32_16x16x32_bf16 v[100:103], a[228:231], v[96:99], v[100:103]
    s_add_u32 m0, s56, 36864
    s_xor_b32 s58, s72, 13
    v_and_b32 v113, 0xffff0000, v6
    v_mfma_f32_16x16x32_bf16 v[104:107], v[164:167], v[96:99], v[104:107]
    s_mul_i32 s58, s58, 98304
    s_add_u32 s58, s58, s55
    v_mfma_f32_16x16x32_bf16 v[108:111], v[96:99], v[228:231], v[108:111]
    buffer_load_dwordx4 v5, s[16:19], s58 offen offset:0 lds
    v_mfma_f32_16x16x32_bf16 v[24:27], v[160:163], v[64:67], v[24:27]
    ds_read_b64_tr_b16 a[232:233], v4 offset:0
    ds_read_b64_tr_b16 a[234:235], v4 offset:512
    v_mfma_f32_16x16x32_bf16 v[8:11], a[224:227], v[64:67], v[8:11]
    ds_read_b64_tr_b16 v[168:169], v4 offset:1024
    ds_read_b64_tr_b16 v[170:171], v4 offset:1536
    v_mfma_f32_16x16x32_bf16 v[28:31], v[160:163], v[68:71], v[28:31]
    ds_read_b64_tr_b16 v[232:233], v4 offset:2048
    ds_read_b64_tr_b16 v[234:235], v4 offset:2560
    v_mfma_f32_16x16x32_bf16 v[12:15], a[224:227], v[68:71], v[12:15]
    ds_read_b128 v[80:83], v120 offset:3072
    ds_read_b128 v[84:87], v120 offset:9216
    v_mfma_f32_16x16x32_bf16 v[32:35], v[160:163], v[72:75], v[32:35]
    buffer_load_dwordx4 v5, s[16:19], s58 offen offset:1024 lds
    v_mfma_f32_16x16x32_bf16 v[16:19], a[224:227], v[72:75], v[16:19]
    ds_read_b128 v[88:91], v120 offset:15360
    ds_read_b128 v[92:95], v120 offset:21504
    v_mfma_f32_16x16x32_bf16 v[36:39], v[160:163], v[76:79], v[36:39]
    v_rcp_f32_e64 v113, v113
    s_lshl_b32 s59, s3, 7
    v_mfma_f32_16x16x32_bf16 v[20:23], a[224:227], v[76:79], v[20:23]
    v_lshl_add_u32 v7, v2, 3, s59
    v_add_u32 v6, 155648, v7
    ds_write_b64 v6, v[112:113]
    v_mfma_f32_16x16x32_bf16 v[44:47], v[64:67], v[224:227], v[44:47]
    v_lshrrev_b32_e64 v7, 1, v7
    v_add_u32 v7, 156160, v7
    ds_write2_b32 v7, v112, v113 offset0:0 offset1:64
    v_mfma_f32_16x16x32_bf16 v[48:51], v[68:71], v[224:227], v[48:51]
    buffer_load_dwordx4 v5, s[16:19], s58 offen offset:2048 lds
    s_mov_b64 s[20:21], s[34:35]
    v_mfma_f32_16x16x32_bf16 v[52:55], v[72:75], v[224:227], v[52:55]
    v_bfe_u32 v6, v1, 4, 1
    s_and_b32 s48, s3, 1
    s_lshl_b32 s48, s48, 1
    v_mfma_f32_16x16x32_bf16 v[56:59], v[76:79], v[224:227], v[56:59]
    s_waitcnt vmcnt(8) lgkmcnt(2)
    s_barrier
    v_mfma_f32_16x16x32_bf16 v[100:103], a[232:235], v[96:99], v[100:103]
    s_add_u32 m0, s78, 2048
    s_xor_b32 s58, s85, 14336
    v_or_b32 v6, s48, v6
    v_mfma_f32_16x16x32_bf16 v[104:107], v[168:171], v[96:99], v[104:107]
    buffer_load_dwordx4 v0, s[12:15], s58 offen sc1 lds
    v_lshlrev_b32_e64 v6, 1, v6
    v_mfma_f32_16x16x32_bf16 v[108:111], v[96:99], v[232:235], v[108:111]
    ds_read_b64_tr_b16 a[236:237], v4 offset:12288
    ds_read_b64_tr_b16 a[238:239], v4 offset:12800
    v_and_b32_e64 v122, 7, v1
    v_mfma_f32_16x16x32_bf16 v[24:27], v[164:167], v[80:83], v[24:27]
    buffer_load_dwordx4 v0, s[12:15], s58 offen offset:1024 sc1 lds
    v_xor_b32_e64 v122, v122, v6
    v_mfma_f32_16x16x32_bf16 v[8:11], a[228:231], v[80:83], v[8:11]
    s_add_u32 m0, s56, 49152
    s_xor_b32 s58, s72, 14
    v_lshlrev_b32 v122, 4, v122
    v_mfma_f32_16x16x32_bf16 v[28:31], v[164:167], v[84:87], v[28:31]
    s_mul_i32 s58, s58, 98304
    s_add_u32 s58, s58, s55
    v_lshrrev_b32 v6, 3, v1
    v_mfma_f32_16x16x32_bf16 v[12:15], a[228:231], v[84:87], v[12:15]
    buffer_load_dwordx4 v5, s[16:19], s58 offen offset:0 lds
    v_mul_u32_u24 v6, 1024, v6
    v_mfma_f32_16x16x32_bf16 v[32:35], v[164:167], v[88:91], v[32:35]
    ds_read_b64_tr_b16 v[172:173], v4 offset:13312
    ds_read_b64_tr_b16 v[174:175], v4 offset:13824
    v_add_u32_e64 v122, v122, v6
    v_mfma_f32_16x16x32_bf16 v[16:19], a[228:231], v[88:91], v[16:19]
    buffer_load_dwordx4 v5, s[16:19], s58 offen offset:1024 lds
    s_lshl_b32 s0, s3, 13
    v_mfma_f32_16x16x32_bf16 v[36:39], v[164:167], v[92:95], v[36:39]
    ds_read_b64_tr_b16 v[236:237], v4 offset:14336
    ds_read_b64_tr_b16 v[238:239], v4 offset:14848
    s_bfe_u32 s1, s76, 0xa0004
    v_mfma_f32_16x16x32_bf16 v[20:23], a[228:231], v[92:95], v[20:23]
    ds_read_b128 v[64:67], v120 offset:4096
    ds_read_b128 v[68:71], v120 offset:10240
    s_add_u32 s0, s0, s1
    v_mfma_f32_16x16x32_bf16 v[44:47], v[80:83], v[228:231], v[44:47]
    buffer_load_dwordx4 v5, s[16:19], s58 offen offset:2048 lds
    s_lshl_b32 s1, s3, 10
    v_mfma_f32_16x16x32_bf16 v[48:51], v[84:87], v[228:231], v[48:51]
    ds_read_b128 v[72:75], v120 offset:16384
    ds_read_b128 v[76:79], v120 offset:22528
    s_add_u32 s1, s1, 65536
    v_mfma_f32_16x16x32_bf16 v[52:55], v[88:91], v[228:231], v[52:55]
    buffer_load_dword v126, v124, s[4:7], 0 offen sc1
    v_mfma_f32_16x16x32_bf16 v[56:59], v[92:95], v[228:231], v[56:59]
    s_waitcnt lgkmcnt(0)
    v_mfma_f32_16x16x32_bf16 v[100:103], a[236:239], v[96:99], v[100:103]
    s_add_u32 m0, s56, 0
    s_xor_b32 s58, s72, 15
    v_mfma_f32_16x16x32_bf16 v[104:107], v[172:175], v[96:99], v[104:107]
    s_mul_i32 s58, s58, 98304
    s_add_u32 s58, s58, s55
    v_mfma_f32_16x16x32_bf16 v[108:111], v[96:99], v[236:239], v[108:111]
    buffer_load_dwordx4 v5, s[16:19], s58 offen offset:0 lds
    v_mfma_f32_16x16x32_bf16 v[24:27], v[168:171], v[64:67], v[24:27]
    ds_read_b128 v[80:83], v120 offset:5120
    v_mfma_f32_16x16x32_bf16 v[8:11], a[232:235], v[64:67], v[8:11]
    ds_read_b128 v[84:87], v120 offset:11264
    v_mfma_f32_16x16x32_bf16 v[28:31], v[168:171], v[68:71], v[28:31]
    ds_read_b128 v[88:91], v120 offset:17408
    v_mfma_f32_16x16x32_bf16 v[12:15], a[232:235], v[68:71], v[12:15]
    ds_read_b128 v[92:95], v120 offset:23552
    v_mfma_f32_16x16x32_bf16 v[32:35], v[168:171], v[72:75], v[32:35]
    buffer_load_dwordx4 v5, s[16:19], s58 offen offset:1024 lds
    v_mfma_f32_16x16x32_bf16 v[16:19], a[232:235], v[72:75], v[16:19]
    s_cmp_eq_u32 s38, 0
    s_cselect_b32 s52, s101, s43
    v_mfma_f32_16x16x32_bf16 v[36:39], v[168:171], v[76:79], v[36:39]
    s_add_u32 s53, s52, 4
    v_mfma_f32_16x16x32_bf16 v[20:23], a[232:235], v[76:79], v[20:23]
    v_mfma_f32_16x16x32_bf16 v[44:47], v[64:67], v[232:235], v[44:47]
    v_mfma_f32_16x16x32_bf16 v[48:51], v[68:71], v[232:235], v[48:51]
    buffer_load_dwordx4 v5, s[16:19], s58 offen offset:2048 lds
    v_mfma_f32_16x16x32_bf16 v[52:55], v[72:75], v[232:235], v[52:55]
    v_mfma_f32_16x16x32_bf16 v[56:59], v[76:79], v[232:235], v[56:59]
    s_waitcnt vmcnt(9) lgkmcnt(0)
    s_barrier
    v_mfma_f32_16x16x32_bf16 v[24:27], v[172:175], v[80:83], v[24:27]
    ds_read_b64_tr_b16 a[240:241], v4 offset:24576
    ds_read_b64_tr_b16 a[242:243], v4 offset:25088
    v_mfma_f32_16x16x32_bf16 v[8:11], a[236:239], v[80:83], v[8:11]
    ds_read_b64_tr_b16 v[176:177], v4 offset:25600
    ds_read_b64_tr_b16 v[178:179], v4 offset:26112
    v_mfma_f32_16x16x32_bf16 v[28:31], v[172:175], v[84:87], v[28:31]
    s_waitcnt vmcnt(3)
    v_subrev_u32 v126, s53, v126
    v_cmp_le_u32 vcc, 16, v126
    s_nop 0
    s_and_b32 s48, vcc_hi, 0xcccccccc
    s_cselect_b32 s48, s40, 0
    s_cmp_eq_u32 s48, 0
    s_cbranch_scc1 hp_36
    s_mov_b32 s50, 0x0
    s_mov_b32 s51, 0xcccccccc
    s_add_i32 s48, s52, 4
    s_mov_b32 s49, s44
    s_mov_b64 exec, s[50:51]
    buffer_load_dword v126, v124, s[4:7], 0 offen sc1
    s_nop 7
    s_nop 7
poll_37:
    buffer_load_dword v127, v124, s[4:7], 0 offen sc1
    s_waitcnt vmcnt(1)
    v_subrev_u32 v126, s48, v126
    v_cmp_gt_u32 vcc, 16, v126
    s_nop 0
    s_cmp_eq_u64 vcc, s[50:51]
    s_nop 1
    s_cbranch_scc1 poll_37_ok
    buffer_load_dword v126, v124, s[4:7], 0 offen sc1
    s_waitcnt vmcnt(1)
    v_subrev_u32 v127, s48, v127
    v_cmp_gt_u32 vcc, 16, v127
    s_nop 0
    s_cmp_eq_u64 vcc, s[50:51]
    s_nop 1
    s_cbranch_scc1 poll_37_ok
    s_add_u32 s49, s49, 1
    s_cmp_lt_u32 s49, 2000000
    s_cbranch_scc1 poll_37
    s_mov_b32 s44, 2000000
poll_37_ok:
    s_mov_b64 exec, -1
hp_36:
    buffer_load_dwordx4 v[116:119], v121, s[4:7], s63 offen sc1
    v_mfma_f32_16x16x32_bf16 v[12:15], a[236:239], v[84:87], v[12:15]
    ds_read_b64_tr_b16 v[240:241], v4 offset:26624
    ds_read_b64_tr_b16 v[242:243], v4 offset:27136
    v_mfma_f32_16x16x32_bf16 v[32:35], v[172:175], v[88:91], v[32:35]
    ds_read_b128 v[64:67], v120 offset:0
    ds_read_b128 v[68:71], v120 offset:6144
    v_mfma_f32_16x16x32_bf16 v[16:19], a[236:239], v[88:91], v[16:19]
    s_add_u32 m0, s78, 4096
    s_xor_b32 s58, s62, 0
    v_mfma_f32_16x16x32_bf16 v[36:39], v[172:175], v[92:95], v[36:39]
    buffer_load_dwordx4 v0, s[4:7], s58 offen sc1 lds
    v_mfma_f32_16x16x32_bf16 v[20:23], a[236:239], v[92:95], v[20:23]
    ds_read_b128 v[72:75], v120 offset:12288
    ds_read_b128 v[76:79], v120 offset:18432
    v_mfma_f32_16x16x32_bf16 v[44:47], v[80:83], v[236:239], v[44:47]
    v_mfma_f32_16x16x32_bf16 v[48:51], v[84:87], v[236:239], v[48:51]
    v_mfma_f32_16x16x32_bf16 v[52:55], v[88:91], v[236:239], v[52:55]
    buffer_load_dwordx4 v0, s[4:7], s58 offen offset:1024 sc1 lds
    v_mfma_f32_16x16x32_bf16 v[56:59], v[92:95], v[236:239], v[56:59]
    s_waitcnt lgkmcnt(0)
    v_mfma_f32_16x16x32_bf16 v[100:103], a[240:243], v[96:99], v[100:103]
    ds_read_b64_tr_b16 a[244:245], v4 offset:36864
    ds_read_b64_tr_b16 a[246:247], v4 offset:37376
    v_mfma_f32_16x16x32_bf16 v[104:107], v[176:179], v[96:99], v[104:107]
    ds_read_b64_tr_b16 v[180:181], v4 offset:37888
    ds_read_b64_tr_b16 v[182:183], v4 offset:38400
    v_mfma_f32_16x16x32_bf16 v[108:111], v[96:99], v[240:243], v[108:111]
    ds_read_b64_tr_b16 v[244:245], v4 offset:38912
    ds_read_b64_tr_b16 v[246:247], v4 offset:39424
    v_mfma_f32_16x16x32_bf16 v[24:27], v[176:179], v[64:67], v[24:27]
    ds_read_b128 v[80:83], v120 offset:1024
    ds_read_b128 v[84:87], v120 offset:7168
    v_mfma_f32_16x16x32_bf16 v[8:11], a[240:243], v[64:67], v[8:11]
    ds_read_b128 v[88:91], v120 offset:13312
    ds_read_b128 v[92:95], v120 offset:19456
    v_mfma_f32_16x16x32_bf16 v[28:31], v[176:179], v[68:71], v[28:31]
    v_mfma_f32_16x16x32_bf16 v[12:15], a[240:243], v[68:71], v[12:15]
    v_mfma_f32_16x16x32_bf16 v[32:35], v[176:179], v[72:75], v[32:35]
    v_mfma_f32_16x16x32_bf16 v[16:19], a[240:243], v[72:75], v[16:19]
    v_mfma_f32_16x16x32_bf16 v[36:39], v[176:179], v[76:79], v[36:39]
    v_mfma_f32_16x16x32_bf16 v[20:23], a[240:243], v[76:79], v[20:23]
    v_mfma_f32_16x16x32_bf16 v[44:47], v[64:67], v[240:243], v[44:47]
    v_mfma_f32_16x16x32_bf16 v[48:51], v[68:71], v[240:243], v[48:51]
    v_mfma_f32_16x16x32_bf16 v[52:55], v[72:75], v[240:243], v[52:55]
    v_mfma_f32_16x16x32_bf16 v[56:59], v[76:79], v[240:243], v[56:59]
    s_waitcnt vmcnt(3) lgkmcnt(0)
    s_barrier
    v_mfma_f32_16x16x32_bf16 v[100:103], a[244:247], v[96:99], v[100:103]
    ds_read_b64_tr_b16 a[248:249], v4 offset:49152
    ds_read_b64_tr_b16 a[250:251], v4 offset:49664
    v_mfma_f32_16x16x32_bf16 v[104:107], v[180:183], v[96:99], v[104:107]
    s_add_u32 m0, s78, 0
    s_xor_b32 s58, s62, 8192
    v_mfma_f32_16x16x32_bf16 v[108:111], v[96:99], v[244:247], v[108:111]
    buffer_load_dwordx4 v0, s[4:7], s58 offen sc1 lds
    v_mfma_f32_16x16x32_bf16 v[24:27], v[180:183], v[80:83], v[24:27]
    ds_read_b64_tr_b16 v[184:185], v4 offset:50176
    ds_read_b64_tr_b16 v[186:187], v4 offset:50688
    v_mfma_f32_16x16x32_bf16 v[8:11], a[244:247], v[80:83], v[8:11]
    ds_read_b64_tr_b16 v[248:249], v4 offset:51200
    ds_read_b64_tr_b16 v[250:251], v4 offset:51712
    v_mfma_f32_16x16x32_bf16 v[28:31], v[180:183], v[84:87], v[28:31]
    ds_read_b128 v[64:67], v120 offset:2048
    ds_read_b128 v[68:71], v120 offset:8192
    v_mfma_f32_16x16x32_bf16 v[12:15], a[244:247], v[84:87], v[12:15]
    ds_read_b128 v[72:75], v120 offset:14336
    ds_read_b128 v[76:79], v120 offset:20480
    v_mfma_f32_16x16x32_bf16 v[32:35], v[180:183], v[88:91], v[32:35]
    buffer_load_dwordx4 v0, s[4:7], s58 offen offset:1024 sc1 lds
    v_mfma_f32_16x16x32_bf16 v[16:19], a[244:247], v[88:91], v[16:19]
    v_mfma_f32_16x16x32_bf16 v[36:39], v[180:183], v[92:95], v[36:39]
    v_mfma_f32_16x16x32_bf16 v[20:23], a[244:247], v[92:95], v[20:23]
    v_mfma_f32_16x16x32_bf16 v[44:47], v[80:83], v[244:247], v[44:47]
    v_lshlrev_b32 v123, 7, v1
    v_mfma_f32_16x16x32_bf16 v[48:51], v[84:87], v[244:247], v[48:51]
    s_mov_b64 exec, 0xffffffff
    buffer_load_dword v123, v123, s[20:23], s93 offen
    s_mov_b64 exec, -1
    v_mfma_f32_16x16x32_bf16 v[52:55], v[88:91], v[244:247], v[52:55]
    v_mfma_f32_16x16x32_bf16 v[56:59], v[92:95], v[244:247], v[56:59]
    s_waitcnt lgkmcnt(0)
    v_mfma_f32_16x16x32_bf16 v[100:103], a[248:251], v[96:99], v[100:103]
    ds_read_b64_tr_b16 a[252:253], v4 offset:0
    ds_read_b64_tr_b16 a[254:255], v4 offset:512
    v_lshlrev_b32_e64 v121, 4, v3
    v_mfma_f32_16x16x32_bf16 v[104:107], v[184:187], v[96:99], v[104:107]
    ds_read_b64_tr_b16 v[188:189], v4 offset:1024
    ds_read_b64_tr_b16 v[190:191], v4 offset:1536
    v_add_u32 v121, 156160, v121
    v_mfma_f32_16x16x32_bf16 v[108:111], v[96:99], v[248:251], v[108:111]
    ds_read_b64_tr_b16 v[252:253], v4 offset:2048
    ds_read_b64_tr_b16 v[254:255], v4 offset:2560
    s_waitcnt vmcnt(5)
    v_mfma_f32_16x16x32_bf16 v[24:27], v[184:187], v[64:67], v[24:27]
    ds_read_b128 v[80:83], v120 offset:3072
    ds_read_b128 v[84:87], v120 offset:9216
    v_add_f32 v114, v116, v118
    v_mfma_f32_16x16x32_bf16 v[8:11], a[248:251], v[64:67], v[8:11]
    ds_read_b128 v[88:91], v120 offset:15360
    ds_read_b128 v[92:95], v120 offset:21504
    v_add_f32 v115, v117, v119
    v_mfma_f32_16x16x32_bf16 v[28:31], v[184:187], v[68:71], v[28:31]
    s_nop 0
    v_permlane32_swap_b32 v114, v115
    v_add_f32 v114, v114, v115
    v_mfma_f32_16x16x32_bf16 v[12:15], a[248:251], v[68:71], v[12:15]
    v_mov_b32 v115, v114
    s_nop 1
    v_permlane16_swap_b32 v114, v115
    v_mfma_f32_16x16x32_bf16 v[32:35], v[184:187], v[72:75], v[32:35]
    v_add_f32 v114, v114, v115
    v_mov_b32 v115, v114
    v_mfma_f32_16x16x32_bf16 v[16:19], a[248:251], v[72:75], v[16:19]
    s_nop 0
    v_permlane32_swap_b32 v114, v115
    v_mul_f32 v114, 0x3b000000, v114
    v_mfma_f32_16x16x32_bf16 v[36:39], v[184:187], v[76:79], v[36:39]
    v_mul_f32 v115, 0x3b000000, v115
    v_fma_f32 v115, -v114, v114, v115
    v_mfma_f32_16x16x32_bf16 v[20:23], a[248:251], v[76:79], v[20:23]
    v_mfma_f32_16x16x32_bf16 v[44:47], v[64:67], v[248:251], v[44:47]
    v_mfma_f32_16x16x32_bf16 v[48:51], v[68:71], v[248:251], v[48:51]
    v_mfma_f32_16x16x32_bf16 v[52:55], v[72:75], v[248:251], v[52:55]
    v_mfma_f32_16x16x32_bf16 v[56:59], v[76:79], v[248:251], v[56:59]
    s_waitcnt lgkmcnt(0)
    v_mfma_f32_16x16x32_bf16 v[100:103], a[252:255], v[96:99], v[100:103]
    v_max_f32_e64 v115, 0, v115
    v_cvt_pk_bf16_f32 v6, v114, v115
    v_mfma_f32_16x16x32_bf16 v[104:107], v[188:191], v[96:99], v[104:107]
    v_lshlrev_b32_e64 v114, 16, v6
    v_and_b32 v115, 0xffff0000, v6
    v_mfma_f32_16x16x32_bf16 v[108:111], v[96:99], v[252:255], v[108:111]
    v_add_f32 v115, 0x3727c5ac, v115
    v_cvt_pk_bf16_f32 v6, v115, v115
    v_mfma_f32_16x16x32_bf16 v[24:27], v[188:191], v[80:83], v[24:27]
    v_and_b32 v115, 0xffff0000, v6
    v_mfma_f32_16x16x32_bf16 v[8:11], a[252:255], v[80:83], v[8:11]
    v_sqrt_f32_e64 v115, v115
    v_mfma_f32_16x16x32_bf16 v[28:31], v[188:191], v[84:87], v[28:31]
    v_cvt_pk_bf16_f32 v6, v115, v115
    v_and_b32 v115, 0xffff0000, v6
    v_mfma_f32_16x16x32_bf16 v[12:15], a[252:255], v[84:87], v[12:15]
    v_rcp_f32 v115, v115
    v_mfma_f32_16x16x32_bf16 v[32:35], v[188:191], v[88:91], v[32:35]
    s_lshl_b32 s59, s3, 8
    s_add_u32 s59, s59, 158720
    v_mfma_f32_16x16x32_bf16 v[16:19], a[252:255], v[88:91], v[16:19]
    v_lshl_add_u32 v6, v2, 2, s59
    ds_write2_b32 v6, v114, v115 offset0:0 offset1:16
    v_mfma_f32_16x16x32_bf16 v[36:39], v[188:191], v[92:95], v[36:39]
    v_mfma_f32_16x16x32_bf16 v[20:23], a[252:255], v[92:95], v[20:23]
    v_mfma_f32_16x16x32_bf16 v[44:47], v[80:83], v[252:255], v[44:47]
    v_mfma_f32_16x16x32_bf16 v[48:51], v[84:87], v[252:255], v[48:51]
    v_mfma_f32_16x16x32_bf16 v[52:55], v[88:91], v[252:255], v[52:55]
    v_mfma_f32_16x16x32_bf16 v[56:59], v[92:95], v[252:255], v[56:59]
    s_mul_i32 s59, s3, 192
    s_add_u32 s59, s59, 157440
    v_lshl_add_u32 v6, v3, 4, s59
    v_lshl_add_u32 v7, v2, 2, s59
    ds_write_b128 v6, v[100:103]
    ds_write_b128 v6, v[104:107] offset:64
    ds_write_b32 v7, v108 offset:128
    s_waitcnt vmcnt(1) lgkmcnt(0)
    s_barrier
    v_lshlrev_b32_e64 v6, 3, v2
    v_add_u32 v6, 155648, v6
    ds_read2_b64 v[88:91], v6 offset0:0 offset1:16
    ds_read2_b64 v[92:95], v6 offset0:32 offset1:48
    ds_read_b128 v[64:67], v120 offset:4096
    ds_read_b128 v[68:71], v120 offset:5120
    ds_read_b128 v[72:75], v120 offset:10240
    ds_read_b128 v[76:79], v120 offset:11264
    v_lshrrev_b32 v6, 1, v3
    v_lshlrev_b32 v7, 4, v2
    v_lshl_add_u32 v7, v6, 8, v7
    v_and_b32 v6, 1, v3
    v_lshl_add_u32 v7, v6, 3, v7
    s_waitcnt lgkmcnt(2)
    v_mfma_f32_16x16x32_bf16 v[40:43], v[128:131], v[64:67], 0
    ds_read_b128 v[80:83], v120 offset:16384
    ds_read_b128 v[84:87], v120 offset:17408
    v_fma_f32 v24, -v104, v88, v24
    v_mfma_f32_16x16x32_bf16 v[60:63], v[64:67], v[192:195], 0
    v_fma_f32 v25, -v105, v88, v25
    v_fma_f32 v26, -v106, v88, v26
    v_fma_f32 v27, -v107, v88, v27
    v_mfma_f32_16x16x32_bf16 v[40:43], v[132:135], v[68:71], v[40:43]
    v_mul_f32 v24, v24, v89
    v_mul_f32 v25, v25, v89
    v_mul_f32 v26, v26, v89
    v_mfma_f32_16x16x32_bf16 v[60:63], v[68:71], v[196:199], v[60:63]
    v_mul_f32 v27, v27, v89
    v_cvt_pk_bf16_f32 v24, v24, v25
    v_cvt_pk_bf16_f32 v25, v26, v27
    s_waitcnt lgkmcnt(2)
    v_mfma_f32_16x16x32_bf16 v[40:43], v[136:139], v[72:75], v[40:43]
    ds_read_b128 v[64:67], v120 offset:22528
    ds_read_b128 v[68:71], v120 offset:23552
    v_fma_f32 v28, -v104, v90, v28
    v_mfma_f32_16x16x32_bf16 v[60:63], v[72:75], v[200:203], v[60:63]
    v_fma_f32 v29, -v105, v90, v29
    v_fma_f32 v30, -v106, v90, v30
    v_fma_f32 v31, -v107, v90, v31
    v_mfma_f32_16x16x32_bf16 v[40:43], v[140:143], v[76:79], v[40:43]
    v_mul_f32 v28, v28, v91
    v_mul_f32 v29, v29, v91
    v_mul_f32 v30, v30, v91
    v_mfma_f32_16x16x32_bf16 v[60:63], v[76:79], v[204:207], v[60:63]
    v_mul_f32_e64 v31, v31, v91
    v_cvt_pk_bf16_f32 v28, v28, v29
    v_cvt_pk_bf16_f32 v29, v30, v31
    s_waitcnt lgkmcnt(2)
    v_mfma_f32_16x16x32_bf16 v[40:43], v[144:147], v[80:83], v[40:43]
    ds_read_b128 v[72:75], v120 offset:0
    ds_read_b128 v[76:79], v120 offset:1024
    v_fma_f32 v32, -v104, v92, v32
    v_mfma_f32_16x16x32_bf16 v[60:63], v[80:83], v[208:211], v[60:63]
    v_fma_f32 v33, -v105, v92, v33
    v_fma_f32 v34, -v106, v92, v34
    v_fma_f32 v35, -v107, v92, v35
    v_mfma_f32_16x16x32_bf16 v[40:43], v[148:151], v[84:87], v[40:43]
    v_mul_f32 v32, v32, v93
    v_mul_f32 v33, v33, v93
    v_mul_f32 v34, v34, v93
    v_mfma_f32_16x16x32_bf16 v[60:63], v[84:87], v[212:215], v[60:63]
    v_mul_f32_e64 v35, v35, v93
    v_cvt_pk_bf16_f32 v32, v32, v33
    v_cvt_pk_bf16_f32 v33, v34, v35
    s_waitcnt lgkmcnt(2)
    v_mfma_f32_16x16x32_bf16 v[40:43], v[152:155], v[64:67], v[40:43]
    ds_read_b128 v[80:83], v120 offset:6144
    ds_read_b128 v[84:87], v120 offset:7168
    v_fma_f32 v36, -v104, v94, v36
    v_mfma_f32_16x16x32_bf16 v[60:63], v[64:67], v[216:219], v[60:63]
    v_fma_f32 v37, -v105, v94, v37
    v_fma_f32 v38, -v106, v94, v38
    v_fma_f32 v39, -v107, v94, v39
    v_mfma_f32_16x16x32_bf16 v[40:43], v[156:159], v[68:71], v[40:43]
    v_mul_f32 v36, v36, v95
    v_mul_f32 v37, v37, v95
    v_mul_f32 v38, v38, v95
    v_mfma_f32_16x16x32_bf16 v[60:63], v[68:71], v[220:223], v[60:63]
    v_mul_f32_e64 v39, v39, v95
    v_cvt_pk_bf16_f32 v36, v36, v37
    v_cvt_pk_bf16_f32 v37, v38, v39
    s_waitcnt lgkmcnt(2)
    v_mfma_f32_16x16x32_bf16 v[40:43], v[160:163], v[72:75], v[40:43]
    buffer_load_dwordx2 v[26:27], v7, s[12:15], s76 offen offset:0 sc1
    ds_read_b128 v[64:67], v120 offset:12288
    ds_read_b128 v[68:71], v120 offset:13312
    v_mul_f32 v93, s92, v93
    v_mfma_f32_16x16x32_bf16 v[60:63], v[72:75], v[224:227], v[60:63]
    v_fma_f32 v16, -v100, v92, v16
    v_fma_f32 v17, -v101, v92, v17
    v_fma_f32 v18, -v102, v92, v18
    s_add_u32 m0, s1, 0
    s_xor_b32 s58, s0, 0
    buffer_load_dwordx4 v122, s[20:23], s58 offen lds
    v_mfma_f32_16x16x32_bf16 v[40:43], v[164:167], v[76:79], v[40:43]
    v_fma_f32 v19, -v103, v92, v19
    v_mul_f32 v16, v16, v93
    v_mul_f32 v17, v17, v93
    v_mfma_f32_16x16x32_bf16 v[60:63], v[76:79], v[228:231], v[60:63]
    v_mul_f32 v18, v18, v93
    v_mul_f32 v19, v19, v93
    v_cvt_pk_bf16_f32 v16, v16, v17
    s_waitcnt lgkmcnt(2)
    v_mfma_f32_16x16x32_bf16 v[40:43], v[168:171], v[80:83], v[40:43]
    s_add_u32 m0, s1, 4096
    s_xor_b32 s58, s0, 32768
    buffer_load_dwordx4 v122, s[20:23], s58 offen lds
    buffer_load_dwordx2 v[30:31], v7, s[12:15], s76 offen offset:512 sc1
    ds_read_b128 v[72:75], v120 offset:18432
    ds_read_b128 v[76:79], v120 offset:19456
    v_cvt_pk_bf16_f32 v17, v18, v19
    v_mfma_f32_16x16x32_bf16 v[60:63], v[80:83], v[232:235], v[60:63]
    v_mul_f32 v95, s92, v95
    v_fma_f32 v20, -v100, v94, v20
    v_fma_f32 v21, -v101, v94, v21
    v_mfma_f32_16x16x32_bf16 v[40:43], v[172:175], v[84:87], v[40:43]
    v_fma_f32 v22, -v102, v94, v22
    s_add_u32 m0, s1, 8192
    s_xor_b32 s58, s0, 65536
    buffer_load_dwordx4 v122, s[20:23], s58 offen lds
    v_fma_f32 v23, -v103, v94, v23
    v_mul_f32 v20, v20, v95
    v_mfma_f32_16x16x32_bf16 v[60:63], v[84:87], v[236:239], v[60:63]
    v_mul_f32 v21, v21, v95
    v_mul_f32 v22, v22, v95
    v_mul_f32_e64 v23, v23, v95
    s_waitcnt lgkmcnt(2)
    v_mfma_f32_16x16x32_bf16 v[40:43], v[176:179], v[64:67], v[40:43]
    buffer_load_dwordx2 v[34:35], v7, s[12:15], s76 offen offset:1024 sc1
    ds_read_b128 v[80:83], v121 offset:128
    s_add_u32 m0, s1, 12288
    s_xor_b32 s58, s0, 98304
    buffer_load_dwordx4 v122, s[20:23], s58 offen lds
    ds_read_b128 v[84:87], v121 offset:384
    v_cvt_pk_bf16_f32 v20, v20, v21
    v_cvt_pk_bf16_f32 v21, v22, v23
    v_mfma_f32_16x16x32_bf16 v[60:63], v[64:67], v[240:243], v[60:63]
    v_mul_f32_e64 v89, s92, v89
    v_fma_f32 v8, -v100, v88, v8
    v_fma_f32 v9, -v101, v88, v9
    v_mfma_f32_16x16x32_bf16 v[40:43], v[180:183], v[68:71], v[40:43]
    v_fma_f32 v10, -v102, v88, v10
    v_fma_f32 v11, -v103, v88, v11
    s_add_u32 m0, s1, 16384
    s_xor_b32 s58, s0, 131072
    buffer_load_dwordx4 v122, s[20:23], s58 offen lds
    v_mul_f32 v8, v8, v89
    v_mul_f32 v9, v9, v89
    v_mfma_f32_16x16x32_bf16 v[60:63], v[68:71], v[244:247], v[60:63]
    v_mul_f32 v10, v10, v89
    v_mul_f32 v11, v11, v89
    v_cvt_pk_bf16_f32 v8, v8, v9
    s_waitcnt lgkmcnt(2)
    v_mfma_f32_16x16x32_bf16 v[40:43], v[184:187], v[72:75], v[40:43]
    buffer_load_dwordx2 v[38:39], v7, s[12:15], s76 offen offset:1536 sc1
    v_cvt_pk_bf16_f32 v9, v10, v11
    s_add_u32 m0, s1, 20480
    s_xor_b32 s58, s0, 163840
    buffer_load_dwordx4 v122, s[20:23], s58 offen lds
    v_mul_f32 v91, s92, v91
    v_fma_f32 v12, -v100, v90, v12
    v_mfma_f32_16x16x32_bf16 v[60:63], v[72:75], v[248:251], v[60:63]
    v_fma_f32 v13, -v101, v90, v13
    v_fma_f32 v14, -v102, v90, v14
    v_fma_f32 v15, -v103, v90, v15
    v_mfma_f32_16x16x32_bf16 v[40:43], v[188:191], v[76:79], v[40:43]
    v_mul_f32 v12, v12, v91
    v_mul_f32 v13, v13, v91
    v_mul_f32_e64 v14, v14, v91
    s_add_u32 m0, s1, 24576
    s_xor_b32 s58, s0, 196608
    buffer_load_dwordx4 v122, s[20:23], s58 offen lds
    v_mfma_f32_16x16x32_bf16 v[60:63], v[76:79], v[252:255], v[60:63]
    v_mul_f32_e64 v15, v15, v91
    v_cvt_pk_bf16_f32 v12, v12, v13
    v_cvt_pk_bf16_f32 v13, v14, v15
    ds_read_b128 v[64:67], v121 offset:0
    ds_read_b128 v[68:71], v121 offset:256
    ds_read_b128 v[72:75], v121 offset:64
    ds_read_b128 v[76:79], v121 offset:320
    s_lshl_b32 s59, s3, 8
    s_add_u32 s59, s59, 158720
    s_add_u32 m0, s1, 28672
    s_xor_b32 s58, s0, 229376
    buffer_load_dwordx4 v122, s[20:23], s58 offen lds
    v_lshl_add_u32 v6, v3, 4, s59
    ds_read_b128 v[88:91], v121 offset:192
    ds_read_b128 v[92:95], v121 offset:448
    s_waitcnt lgkmcnt(6)
    v_pk_fma_f32 v[52:53], v[80:81], v[108:109], v[52:53] op_sel:[0,0,0] op_sel_hi:[1,0,1] neg_lo:[1,0,0] neg_hi:[1,0,0]
    v_pk_fma_f32 v[54:55], v[82:83], v[108:109], v[54:55] op_sel:[0,0,0] op_sel_hi:[1,0,1] neg_lo:[1,0,0] neg_hi:[1,0,0]
    v_pk_mul_f32 v[52:53], v[52:53], v[84:85]
    v_pk_mul_f32 v[54:55], v[54:55], v[86:87]
    v_cvt_pk_bf16_f32 v96, v52, v53
    v_cvt_pk_bf16_f32 v97, v54, v55
    s_add_u32 m0, s1, 32768
    s_xor_b32 s58, s0, 262144
    buffer_load_dwordx4 v122, s[20:23], s58 offen lds
    v_pk_fma_f32 v[40:41], v[104:105], v[114:115], v[40:41] op_sel:[0,0,0] op_sel_hi:[1,0,1] neg_lo:[0,1,0] neg_hi:[0,1,0]
    v_pk_fma_f32 v[42:43], v[106:107], v[114:115], v[42:43] op_sel:[0,0,0] op_sel_hi:[1,0,1] neg_lo:[0,1,0] neg_hi:[0,1,0]
    v_pk_mul_f32 v[40:41], v[40:41], v[114:115] op_sel:[0,1] op_sel_hi:[1,1]
    v_pk_mul_f32 v[42:43], v[42:43], v[114:115] op_sel:[0,1] op_sel_hi:[1,1]
    v_cvt_pk_bf16_f32 v40, v40, v41
    v_cvt_pk_bf16_f32 v41, v42, v43
    ds_read_b128 v[112:115], v6
    ds_read_b128 v[116:119], v6 offset:64
    v_add_u32 v6, 161792, v0
    s_waitcnt lgkmcnt(2)
    s_add_u32 m0, s1, 36864
    s_xor_b32 s58, s0, 294912
    buffer_load_dwordx4 v122, s[20:23], s58 offen lds
    v_pk_fma_f32 v[44:45], v[64:65], v[108:109], v[44:45] op_sel:[0,0,0] op_sel_hi:[1,0,1] neg_lo:[1,0,0] neg_hi:[1,0,0]
    v_pk_fma_f32 v[46:47], v[66:67], v[108:109], v[46:47] op_sel:[0,0,0] op_sel_hi:[1,0,1] neg_lo:[1,0,0] neg_hi:[1,0,0]
    v_pk_mul_f32 v[44:45], v[44:45], v[68:69]
    v_pk_mul_f32 v[46:47], v[46:47], v[70:71]
    v_cvt_pk_bf16_f32 v98, v44, v45
    v_cvt_pk_bf16_f32 v99, v46, v47
    v_pk_fma_f32 v[48:49], v[72:73], v[108:109], v[48:49] op_sel:[0,0,0] op_sel_hi:[1,0,1] neg_lo:[1,0,0] neg_hi:[1,0,0]
    v_pk_fma_f32 v[50:51], v[74:75], v[108:109], v[50:51] op_sel:[0,0,0] op_sel_hi:[1,0,1] neg_lo:[1,0,0] neg_hi:[1,0,0]
    v_pk_mul_f32 v[48:49], v[48:49], v[76:77]
    v_pk_mul_f32 v[50:51], v[50:51], v[78:79]
    s_add_u32 m0, s1, 40960
    s_xor_b32 s58, s0, 327680
    buffer_load_dwordx4 v122, s[20:23], s58 offen lds
    v_cvt_pk_bf16_f32 v104, v48, v49
    v_cvt_pk_bf16_f32 v105, v50, v51
    s_waitcnt lgkmcnt(0)
    v_pk_fma_f32 v[56:57], v[88:89], v[108:109], v[56:57] op_sel:[0,0,0] op_sel_hi:[1,0,1] neg_lo:[1,0,0] neg_hi:[1,0,0]
    v_pk_fma_f32 v[58:59], v[90:91], v[108:109], v[58:59] op_sel:[0,0,0] op_sel_hi:[1,0,1] neg_lo:[1,0,0] neg_hi:[1,0,0]
    v_pk_mul_f32 v[56:57], v[56:57], v[92:93]
    v_pk_mul_f32 v[58:59], v[58:59], v[94:95]
    v_cvt_pk_bf16_f32 v102, v56, v57
    v_cvt_pk_bf16_f32 v103, v58, v59
    v_pk_fma_f32 v[60:61], v[112:113], v[108:109], v[60:61] op_sel:[0,0,0] op_sel_hi:[1,0,1] neg_lo:[1,0,0] neg_hi:[1,0,0]
    s_add_u32 m0, s1, 45056
    s_xor_b32 s58, s0, 360448
    buffer_load_dwordx4 v122, s[20:23], s58 offen lds
    v_pk_fma_f32 v[62:63], v[114:115], v[108:109], v[62:63] op_sel:[0,0,0] op_sel_hi:[1,0,1] neg_lo:[1,0,0] neg_hi:[1,0,0]
    v_pk_mul_f32 v[60:61], v[60:61], v[116:117]
    v_pk_mul_f32 v[62:63], v[62:63], v[118:119]
    v_cvt_pk_bf16_f32 v100, v60, v61
    v_cvt_pk_bf16_f32 v101, v62, v63
    v_cvt_pk_bf16_f32 v106, v60, v61
    v_cvt_pk_bf16_f32 v107, v62, v63
    ds_read_b128 v[112:115], v6
    ds_read_b128 v[116:119], v6 offset:1024
    v_mfma_f32_16x16x16_bf16 v[72:75], v[32:33], v[16:17], 0
    s_add_u32 m0, s1, 49152
    s_xor_b32 s58, s0, 393216
    buffer_load_dwordx4 v122, s[20:23], s58 offen lds
    v_mov_b32 v108, 0x3f803f80
    v_mov_b32 v109, 0x3f803f80
    v_mov_b32 v110, 0x3f803f80
    v_mfma_f32_16x16x16_bf16 v[88:91], v[24:25], v[16:17], 0
    v_mov_b32 v111, 0x3f803f80
    v_lshrrev_b32_e64 v120, 1, v3
    v_mfma_f32_16x16x16_bf16 v[76:79], v[36:37], v[20:21], 0
    v_lshl_add_u32 v120, v120, 4, v2
    v_lshlrev_b32_e64 v120, 4, v120
    v_mfma_f32_16x16x16_bf16 v[92:95], v[28:29], v[20:21], 0
    s_add_u32 m0, s1, 53248
    s_xor_b32 s58, s0, 425984
    buffer_load_dwordx4 v122, s[20:23], s58 offen lds
    v_and_b32_e64 v6, 1, v3
    v_lshl_add_u32 v120, v6, 9, v120
    v_cndmask_b32 v72, v88, v72, s[64:65]
    v_cndmask_b32 v73, v89, v73, s[66:67]
    v_mfma_f32_16x16x16_bf16 v[64:67], v[24:25], v[8:9], 0
    v_cndmask_b32 v74, v90, v74, s[68:69]
    v_cndmask_b32 v75, v91, v75, s[70:71]
    v_exp_f32 v72, v72
    v_mfma_f32_16x16x16_bf16 v[80:83], v[40:41], v[8:9], 0
    v_exp_f32 v73, v73
    s_add_u32 m0, s1, 57344
    s_xor_b32 s58, s0, 458752
    buffer_load_dwordx4 v122, s[20:23], s58 offen lds
    v_exp_f32 v74, v74
    v_exp_f32 v75, v75
    v_cvt_pk_bf16_f32 v72, v72, v73
    v_cvt_pk_bf16_f32 v73, v74, v75
    s_waitcnt lgkmcnt(0)
    v_and_b32 v52, v72, v112
    v_and_b32 v54, v72, v114
    v_and_b32 v53, v73, v113
    v_and_b32_e64 v55, v73, v115
    v_cndmask_b32 v76, v92, v76, s[64:65]
    s_add_u32 m0, s1, 61440
    s_xor_b32 s58, s0, 491520
    buffer_load_dwordx4 v122, s[20:23], s58 offen lds
    v_cndmask_b32 v77, v93, v77, s[66:67]
    v_mfma_f32_16x16x32_bf16 v[72:75], v[96:99], v[52:55], 0
    v_cndmask_b32 v78, v94, v78, s[68:69]
    v_cndmask_b32 v79, v95, v79, s[70:71]
    v_exp_f32 v76, v76
    v_mfma_f32_16x16x32_bf16 v[88:91], v[108:111], v[52:55], 0
    v_exp_f32 v77, v77
    v_exp_f32 v78, v78
    v_exp_f32 v79, v79
    v_mfma_f32_16x16x16_bf16 v[68:71], v[28:29], v[12:13], 0
    v_cvt_pk_bf16_f32 v76, v76, v77
    v_cvt_pk_bf16_f32 v77, v78, v79
    v_and_b32 v56, v76, v112
    v_mfma_f32_16x16x16_bf16 v[84:87], v[40:41], v[12:13], 0
    v_and_b32 v58, v76, v114
    v_and_b32 v57, v77, v113
    v_and_b32 v59, v77, v115
    v_cndmask_b32 v64, v80, v64, s[64:65]
    v_cndmask_b32 v65, v81, v65, s[66:67]
    v_mfma_f32_16x16x32_bf16 v[76:79], v[102:105], v[56:59], 0
    v_cndmask_b32 v66, v82, v66, s[68:69]
    v_cndmask_b32 v67, v83, v67, s[70:71]
    v_exp_f32 v64, v64
    v_mfma_f32_16x16x32_bf16 v[92:95], v[108:111], v[56:59], 0
    v_exp_f32 v65, v65
    v_exp_f32 v66, v66
    v_exp_f32 v67, v67
    v_cvt_pk_bf16_f32 v64, v64, v65
    v_cvt_pk_bf16_f32 v65, v66, v67
    v_and_b32 v44, v64, v112
    v_and_b32 v46, v64, v116
    v_and_b32 v45, v65, v113
    v_and_b32 v47, v65, v117
    v_cndmask_b32 v68, v84, v68, s[64:65]
    v_cndmask_b32 v69, v85, v69, s[66:67]
    v_mfma_f32_16x16x32_bf16 v[64:67], v[98:101], v[44:47], 0
    v_cndmask_b32 v70, v86, v70, s[68:69]
    v_cndmask_b32 v71, v87, v71, s[70:71]
    v_exp_f32 v68, v68
    v_mfma_f32_16x16x32_bf16 v[80:83], v[108:111], v[44:47], 0
    v_exp_f32 v69, v69
    v_exp_f32 v70, v70
    v_exp_f32 v71, v71
    v_cvt_pk_bf16_f32 v68, v68, v69
    v_cvt_pk_bf16_f32 v69, v70, v71
    v_and_b32 v48, v68, v112
    v_and_b32 v50, v68, v118
    v_and_b32 v49, v69, v113
    v_and_b32_e64 v51, v69, v119
    s_nop 1
    v_mfma_f32_16x16x32_bf16 v[68:71], v[104:107], v[48:51], 0
    v_mfma_f32_16x16x32_bf16 v[84:87], v[108:111], v[48:51], 0
    s_mov_b32 s52, 0x21800000
    s_mov_b32 s53, 0x5d800000
    v_rcp_f32 v88, v88
    v_rcp_f32 v92, v92
    v_rcp_f32 v80, v80
    s_nop 2
    v_rcp_f32_e64 v84, v84
    v_pk_mul_f32 v[72:73], v[72:73], v[88:89] op_sel:[0,0] op_sel_hi:[1,0]
    v_pk_mul_f32 v[74:75], v[74:75], v[88:89] op_sel:[0,0] op_sel_hi:[1,0]
    v_cvt_pk_bf16_f32 v44, v72, v73
    v_cvt_pk_bf16_f32 v45, v74, v75
    v_pk_mul_f32 v[76:77], v[76:77], v[92:93] op_sel:[0,0] op_sel_hi:[1,0]
    v_pk_mul_f32 v[78:79], v[78:79], v[92:93] op_sel:[0,0] op_sel_hi:[1,0]
    v_cvt_pk_bf16_f32 v46, v76, v77
    v_cvt_pk_bf16_f32 v47, v78, v79
    v_pk_mul_f32 v[64:65], v[64:65], v[80:81] op_sel:[0,0] op_sel_hi:[1,0]
    v_pk_mul_f32 v[66:67], v[66:67], v[80:81] op_sel:[0,0] op_sel_hi:[1,0]
    v_cvt_pk_bf16_f32 v48, v64, v65
    v_cvt_pk_bf16_f32 v49, v66, v67
    v_pk_mul_f32 v[68:69], v[68:69], v[84:85] op_sel:[0,0] op_sel_hi:[1,0]
    v_pk_mul_f32 v[70:71], v[70:71], v[84:85] op_sel:[0,0] op_sel_hi:[1,0]
    v_cvt_pk_bf16_f32 v50, v68, v69
    v_cvt_pk_bf16_f32 v51, v70, v71
    v_permlane16_swap_b32 v44, v46
    v_permlane16_swap_b32 v45, v47
    v_permlane16_swap_b32 v48, v50
    v_permlane16_swap_b32 v49, v51
    s_cmp_lg_u32 s42, 0
    s_cbranch_scc0 st_39_s
    buffer_store_dwordx4 v[44:47], v120, s[4:7], s75 offen
    buffer_store_dwordx4 v[48:51], v120, s[4:7], s74 offen
st_39:
    v_min3_f32 v4, v88, v92, v80
    v_max3_f32 v5, v88, v92, v80
    v_pk_mul_f32 v[6:7], v[72:73], 0 op_sel_hi:[1,0]
    v_pk_fma_f32 v[6:7], v[74:75], 0, v[6:7] op_sel_hi:[1,0,1]
    v_pk_fma_f32 v[6:7], v[76:77], 0, v[6:7] op_sel_hi:[1,0,1]
    v_pk_fma_f32 v[6:7], v[78:79], 0, v[6:7] op_sel_hi:[1,0,1]
    v_pk_fma_f32 v[6:7], v[64:65], 0, v[6:7] op_sel_hi:[1,0,1]
    v_pk_fma_f32 v[6:7], v[66:67], 0, v[6:7] op_sel_hi:[1,0,1]
    v_pk_fma_f32 v[6:7], v[68:69], 0, v[6:7] op_sel_hi:[1,0,1]
    v_pk_fma_f32 v[6:7], v[70:71], 0, v[6:7] op_sel_hi:[1,0,1]
    v_min_f32 v4, v4, v84
    v_max_f32 v5, v5, v84
    v_add_f32 v6, v6, v7
    v_add_f32 v6, v6, v4
    v_cmp_le_f32 vcc, s52, v6
    v_cmp_ge_f32 s[48:49], s53, v5
    s_nop 0
    s_and_b64 vcc, vcc, s[48:49]
    s_cmp_eq_u64 vcc, exec
    s_nop 0
    s_cbranch_scc0 ab_38_slow
ab_38_ok:
    v_bfe_u32 v5, v1, 3, 1
    v_bfe_u32 v6, v1, 4, 1
    v_lshl_or_b32 v5, v6, 1, v5
    v_xor_b32 v5, 0, v5
    v_lshlrev_b32 v5, 5, v5
    v_and_b32_e64 v6, 3, v1
    v_lshl_add_u32 v5, v6, 3, v5
    v_bfe_u32 v6, v1, 2, 2
    v_lshl_add_u32 v5, v6, 7, v5
    v_mul_u32_u24 v6, 1024, v3
    v_add_u32 v4, v5, v6
    v_add_u32 v4, 65536, v4
    v_xor_b32 v5, 32, v4
    v_xor_b32 v52, 64, v4
    v_xor_b32 v120, 96, v4
    v_lshrrev_b32 v6, 1, v3
    v_and_b32 v7, 1, v3
    v_lshlrev_b32 v122, 4, v2
    v_lshl_add_u32 v6, v7, 1, v6
    v_lshl_add_u32 v122, v6, 8, v122
    v_lshrrev_b32 v6, 5, v1
    v_lshl_add_u32 v7, v6, 9, v0
    s_mov_b32 s56, s83
    s_add_u32 s48, s43, 5
    v_mov_b32 v6, s48
    s_cmp_lg_u32 s42, 0
    s_mov_b64 exec, 1
    s_waitcnt vmcnt(0)
    s_cbranch_scc0 sig_41_s
    buffer_store_dword v6, off, s[4:7], s47
sig_41:
    s_mov_b64 exec, -1
    s_getpc_b64 s[50:51]
pc_42:
    s_lshr_b32 s48, s93, 3
    v_lshl_add_u32 v6, v1, 7, s48
    v_min_u32 v6, L_pfend-pc_42, v6
    s_mov_b64 exec, 0xf
    global_load_dword v123, v6, s[50:51]
    s_mov_b64 exec, -1
    s_barrier
    ds_read_b64_tr_b16 v[56:57], v4 offset:0
    ds_read_b64_tr_b16 v[58:59], v4 offset:512
    ds_read_b64_tr_b16 v[60:61], v5 offset:0
    ds_read_b64_tr_b16 v[62:63], v5 offset:512
    ds_read_b64_tr_b16 v[64:65], v52 offset:0
    ds_read_b64_tr_b16 v[66:67], v52 offset:512
    ds_read_b64_tr_b16 v[68:69], v120 offset:0
    ds_read_b64_tr_b16 v[70:71], v120 offset:512
    ds_read_b64_tr_b16 v[72:73], v4 offset:4096
    ds_read_b64_tr_b16 v[74:75], v4 offset:4608
    ds_read_b64_tr_b16 v[76:77], v5 offset:4096
    ds_read_b64_tr_b16 v[78:79], v5 offset:4608
    ds_read_b64_tr_b16 v[80:81], v52 offset:4096
    ds_read_b64_tr_b16 v[82:83], v52 offset:4608
    ds_read_b64_tr_b16 v[84:85], v120 offset:4096
    ds_read_b64_tr_b16 v[86:87], v120 offset:4608
    s_mov_b32 exec_hi, 0
    buffer_load_dword v126, v124, s[4:7], 0 offen sc1
    s_mov_b32 exec_hi, -1
    s_waitcnt vmcnt(2)
    v_lshlrev_b32 v104, 16, v26
    v_and_b32 v105, 0xffff0000, v26
    v_lshlrev_b32 v106, 16, v27
    v_and_b32 v107, 0xffff0000, v27
    v_lshlrev_b32 v108, 16, v30
    v_and_b32 v109, 0xffff0000, v30
    v_lshlrev_b32 v110, 16, v31
    v_and_b32 v111, 0xffff0000, v31
    v_lshlrev_b32 v112, 16, v34
    v_and_b32 v113, 0xffff0000, v34
    v_lshlrev_b32 v114, 16, v35
    v_and_b32 v115, 0xffff0000, v35
    v_lshlrev_b32 v116, 16, v38
    v_and_b32 v117, 0xffff0000, v38
    v_lshlrev_b32 v118, 16, v39
    v_and_b32 v119, 0xffff0000, v39
    s_mov_b32 s50, 0xffffffff
    s_mov_b32 s51, 0x0
    s_add_i32 s48, s43, 5
    s_mov_b32 s49, s44
    s_mov_b64 exec, s[50:51]
poll_43:
    buffer_load_dword v127, v124, s[4:7], 0 offen sc1
    s_waitcnt vmcnt(1)
    v_subrev_u32 v126, s48, v126
    v_cmp_gt_u32 vcc, 16, v126
    s_nop 0
    s_cmp_eq_u64 vcc, s[50:51]
    s_nop 1
    s_cbranch_scc1 poll_43_ok
    buffer_load_dword v126, v124, s[4:7], 0 offen sc1
    s_waitcnt vmcnt(1)
    v_subrev_u32 v127, s48, v127
    v_cmp_gt_u32 vcc, 16, v127
    s_nop 0
    s_cmp_eq_u64 vcc, s[50:51]
    s_nop 1
    s_cbranch_scc1 poll_43_ok
    s_add_u32 s49, s49, 1
    s_cmp_lt_u32 s49, 2000000
    s_cbranch_scc1 poll_43
    s_mov_b32 s44, 2000000
poll_43_ok:
    s_mov_b64 exec, -1
    buffer_load_dwordx4 v[8:11], v7, s[4:7], s56 offen offset:0 sc1
    buffer_load_dwordx4 v[12:15], v7, s[4:7], s56 offen offset:2048 sc1
    s_xor_b32 s56, s83, 4096
    buffer_load_dwordx4 v[16:19], v7, s[4:7], s56 offen offset:0 sc1
    buffer_load_dwordx4 v[20:23], v7, s[4:7], s56 offen offset:2048 sc1
    s_xor_b32 s56, s83, 8192
    buffer_load_dwordx4 v[24:27], v7, s[4:7], s56 offen offset:0 sc1
    buffer_load_dwordx4 v[28:31], v7, s[4:7], s56 offen offset:2048 sc1
    s_waitcnt vmcnt(5) lgkmcnt(8)
    v_mfma_f32_16x16x32_bf16 v[104:107], v[56:59], v[8:11], v[104:107]
    s_xor_b32 s56, s83, 12288
    buffer_load_dwordx4 v[32:35], v7, s[4:7], s56 offen offset:0 sc1
    ds_read_b64_tr_b16 v[88:89], v4 offset:8192
    v_mfma_f32_16x16x32_bf16 v[108:111], v[60:63], v[8:11], v[108:111]
    ds_read_b64_tr_b16 v[90:91], v4 offset:8704
    ds_read_b64_tr_b16 v[92:93], v5 offset:8192
    v_mfma_f32_16x16x32_bf16 v[112:115], v[64:67], v[8:11], v[112:115]
    ds_read_b64_tr_b16 v[94:95], v5 offset:8704
    ds_read_b64_tr_b16 v[96:97], v52 offset:8192
    ds_read_b64_tr_b16 v[98:99], v52 offset:8704
    v_mfma_f32_16x16x32_bf16 v[116:119], v[68:71], v[8:11], v[116:119]
    ds_read_b64_tr_b16 v[100:101], v120 offset:8192
    ds_read_b64_tr_b16 v[102:103], v120 offset:8704
    s_waitcnt vmcnt(5) lgkmcnt(8)
    v_mfma_f32_16x16x32_bf16 v[104:107], v[72:75], v[12:15], v[104:107]
    buffer_load_dwordx4 v[36:39], v7, s[4:7], s56 offen offset:2048 sc1
    ds_read_b64_tr_b16 v[56:57], v4 offset:12288
    ds_read_b64_tr_b16 v[58:59], v4 offset:12800
    v_mfma_f32_16x16x32_bf16 v[108:111], v[76:79], v[12:15], v[108:111]
    ds_read_b64_tr_b16 v[60:61], v5 offset:12288
    ds_read_b64_tr_b16 v[62:63], v5 offset:12800
    v_mfma_f32_16x16x32_bf16 v[112:115], v[80:83], v[12:15], v[112:115]
    ds_read_b64_tr_b16 v[64:65], v52 offset:12288
    ds_read_b64_tr_b16 v[66:67], v52 offset:12800
    v_mfma_f32_16x16x32_bf16 v[116:119], v[84:87], v[12:15], v[116:119]
    ds_read_b64_tr_b16 v[68:69], v120 offset:12288
    ds_read_b64_tr_b16 v[70:71], v120 offset:12800
    s_waitcnt vmcnt(5) lgkmcnt(8)
    v_mfma_f32_16x16x32_bf16 v[104:107], v[88:91], v[16:19], v[104:107]
    s_xor_b32 s56, s83, 16384
    buffer_load_dwordx4 v[40:43], v7, s[4:7], s56 offen offset:0 sc1
    ds_read_b64_tr_b16 v[72:73], v4 offset:16384
    v_mfma_f32_16x16x32_bf16 v[108:111], v[92:95], v[16:19], v[108:111]
    ds_read_b64_tr_b16 v[74:75], v4 offset:16896
    ds_read_b64_tr_b16 v[76:77], v5 offset:16384
    v_mfma_f32_16x16x32_bf16 v[112:115], v[96:99], v[16:19], v[112:115]
    ds_read_b64_tr_b16 v[78:79], v5 offset:16896
    ds_read_b64_tr_b16 v[80:81], v52 offset:16384
    ds_read_b64_tr_b16 v[82:83], v52 offset:16896
    v_mfma_f32_16x16x32_bf16 v[116:119], v[100:103], v[16:19], v[116:119]
    ds_read_b64_tr_b16 v[84:85], v120 offset:16384
    ds_read_b64_tr_b16 v[86:87], v120 offset:16896
    s_waitcnt vmcnt(5) lgkmcnt(8)
    v_mfma_f32_16x16x32_bf16 v[104:107], v[56:59], v[20:23], v[104:107]
    buffer_load_dwordx4 v[44:47], v7, s[4:7], s56 offen offset:2048 sc1
    ds_read_b64_tr_b16 v[88:89], v4 offset:20480
    ds_read_b64_tr_b16 v[90:91], v4 offset:20992
    v_mfma_f32_16x16x32_bf16 v[108:111], v[60:63], v[20:23], v[108:111]
    ds_read_b64_tr_b16 v[92:93], v5 offset:20480
    ds_read_b64_tr_b16 v[94:95], v5 offset:20992
    v_mfma_f32_16x16x32_bf16 v[112:115], v[64:67], v[20:23], v[112:115]
    ds_read_b64_tr_b16 v[96:97], v52 offset:20480
    ds_read_b64_tr_b16 v[98:99], v52 offset:20992
    v_mfma_f32_16x16x32_bf16 v[116:119], v[68:71], v[20:23], v[116:119]
    ds_read_b64_tr_b16 v[100:101], v120 offset:20480
    ds_read_b64_tr_b16 v[102:103], v120 offset:20992
    s_waitcnt vmcnt(5) lgkmcnt(8)
    v_mfma_f32_16x16x32_bf16 v[104:107], v[72:75], v[24:27], v[104:107]
    s_xor_b32 s56, s83, 20480
    buffer_load_dwordx4 v[48:51], v7, s[4:7], s56 offen offset:0 sc1
    ds_read_b64_tr_b16 v[56:57], v4 offset:24576
    v_mfma_f32_16x16x32_bf16 v[108:111], v[76:79], v[24:27], v[108:111]
    ds_read_b64_tr_b16 v[58:59], v4 offset:25088
    ds_read_b64_tr_b16 v[60:61], v5 offset:24576
    v_mfma_f32_16x16x32_bf16 v[112:115], v[80:83], v[24:27], v[112:115]
    ds_read_b64_tr_b16 v[62:63], v5 offset:25088
    ds_read_b64_tr_b16 v[64:65], v52 offset:24576
    ds_read_b64_tr_b16 v[66:67], v52 offset:25088
    v_mfma_f32_16x16x32_bf16 v[116:119], v[84:87], v[24:27], v[116:119]
    ds_read_b64_tr_b16 v[68:69], v120 offset:24576
    ds_read_b64_tr_b16 v[70:71], v120 offset:25088
    s_waitcnt vmcnt(5) lgkmcnt(8)
    v_mfma_f32_16x16x32_bf16 v[104:107], v[88:91], v[28:31], v[104:107]
    buffer_load_dwordx4 v[8:11], v7, s[4:7], s56 offen offset:2048 sc1
    ds_read_b64_tr_b16 v[72:73], v4 offset:28672
    ds_read_b64_tr_b16 v[74:75], v4 offset:29184
    v_mfma_f32_16x16x32_bf16 v[108:111], v[92:95], v[28:31], v[108:111]
    ds_read_b64_tr_b16 v[76:77], v5 offset:28672
    ds_read_b64_tr_b16 v[78:79], v5 offset:29184
    v_mfma_f32_16x16x32_bf16 v[112:115], v[96:99], v[28:31], v[112:115]
    ds_read_b64_tr_b16 v[80:81], v52 offset:28672
    ds_read_b64_tr_b16 v[82:83], v52 offset:29184
    v_mfma_f32_16x16x32_bf16 v[116:119], v[100:103], v[28:31], v[116:119]
    ds_read_b64_tr_b16 v[84:85], v120 offset:28672
    ds_read_b64_tr_b16 v[86:87], v120 offset:29184
    s_waitcnt vmcnt(5) lgkmcnt(8)
    v_mfma_f32_16x16x32_bf16 v[104:107], v[56:59], v[32:35], v[104:107]
    s_xor_b32 s56, s83, 24576
    buffer_load_dwordx4 v[12:15], v7, s[4:7], s56 offen offset:0 sc1
    ds_read_b64_tr_b16 v[88:89], v4 offset:32768
    v_mfma_f32_16x16x32_bf16 v[108:111], v[60:63], v[32:35], v[108:111]
    ds_read_b64_tr_b16 v[90:91], v4 offset:33280
    ds_read_b64_tr_b16 v[92:93], v5 offset:32768
    v_mfma_f32_16x16x32_bf16 v[112:115], v[64:67], v[32:35], v[112:115]
    ds_read_b64_tr_b16 v[94:95], v5 offset:33280
    ds_read_b64_tr_b16 v[96:97], v52 offset:32768
    ds_read_b64_tr_b16 v[98:99], v52 offset:33280
    v_mfma_f32_16x16x32_bf16 v[116:119], v[68:71], v[32:35], v[116:119]
    ds_read_b64_tr_b16 v[100:101], v120 offset:32768
    ds_read_b64_tr_b16 v[102:103], v120 offset:33280
    s_waitcnt vmcnt(5) lgkmcnt(8)
    v_mfma_f32_16x16x32_bf16 v[104:107], v[72:75], v[36:39], v[104:107]
    buffer_load_dwordx4 v[16:19], v7, s[4:7], s56 offen offset:2048 sc1
    ds_read_b64_tr_b16 v[56:57], v4 offset:36864
    ds_read_b64_tr_b16 v[58:59], v4 offset:37376
    v_mfma_f32_16x16x32_bf16 v[108:111], v[76:79], v[36:39], v[108:111]
    ds_read_b64_tr_b16 v[60:61], v5 offset:36864
    ds_read_b64_tr_b16 v[62:63], v5 offset:37376
    v_mfma_f32_16x16x32_bf16 v[112:115], v[80:83], v[36:39], v[112:115]
    ds_read_b64_tr_b16 v[64:65], v52 offset:36864
    ds_read_b64_tr_b16 v[66:67], v52 offset:37376
    v_mfma_f32_16x16x32_bf16 v[116:119], v[84:87], v[36:39], v[116:119]
    ds_read_b64_tr_b16 v[68:69], v120 offset:36864
    ds_read_b64_tr_b16 v[70:71], v120 offset:37376
    s_waitcnt vmcnt(5) lgkmcnt(8)
    v_mfma_f32_16x16x32_bf16 v[104:107], v[88:91], v[40:43], v[104:107]
    s_xor_b32 s56, s83, 28672
    buffer_load_dwordx4 v[20:23], v7, s[4:7], s56 offen offset:0 sc1
    ds_read_b64_tr_b16 v[72:73], v4 offset:40960
    v_mfma_f32_16x16x32_bf16 v[108:111], v[92:95], v[40:43], v[108:111]
    ds_read_b64_tr_b16 v[74:75], v4 offset:41472
    ds_read_b64_tr_b16 v[76:77], v5 offset:40960
    v_mfma_f32_16x16x32_bf16 v[112:115], v[96:99], v[40:43], v[112:115]
    ds_read_b64_tr_b16 v[78:79], v5 offset:41472
    ds_read_b64_tr_b16 v[80:81], v52 offset:40960
    ds_read_b64_tr_b16 v[82:83], v52 offset:41472
    v_mfma_f32_16x16x32_bf16 v[116:119], v[100:103], v[40:43], v[116:119]
    ds_read_b64_tr_b16 v[84:85], v120 offset:40960
    ds_read_b64_tr_b16 v[86:87], v120 offset:41472
    s_waitcnt vmcnt(5) lgkmcnt(8)
    v_mfma_f32_16x16x32_bf16 v[104:107], v[56:59], v[44:47], v[104:107]
    buffer_load_dwordx4 v[24:27], v7, s[4:7], s56 offen offset:2048 sc1
    ds_read_b64_tr_b16 v[88:89], v4 offset:45056
    ds_read_b64_tr_b16 v[90:91], v4 offset:45568
    v_mfma_f32_16x16x32_bf16 v[108:111], v[60:63], v[44:47], v[108:111]
    ds_read_b64_tr_b16 v[92:93], v5 offset:45056
    ds_read_b64_tr_b16 v[94:95], v5 offset:45568
    v_mfma_f32_16x16x32_bf16 v[112:115], v[64:67], v[44:47], v[112:115]
    ds_read_b64_tr_b16 v[96:97], v52 offset:45056
    ds_read_b64_tr_b16 v[98:99], v52 offset:45568
    v_mfma_f32_16x16x32_bf16 v[116:119], v[68:71], v[44:47], v[116:119]
    ds_read_b64_tr_b16 v[100:101], v120 offset:45056
    ds_read_b64_tr_b16 v[102:103], v120 offset:45568
    s_waitcnt vmcnt(5) lgkmcnt(8)
    v_mfma_f32_16x16x32_bf16 v[104:107], v[72:75], v[48:51], v[104:107]
    ds_read_b64_tr_b16 v[56:57], v4 offset:49152
    ds_read_b64_tr_b16 v[58:59], v4 offset:49664
    v_mfma_f32_16x16x32_bf16 v[108:111], v[76:79], v[48:51], v[108:111]
    ds_read_b64_tr_b16 v[60:61], v5 offset:49152
    ds_read_b64_tr_b16 v[62:63], v5 offset:49664
    v_mfma_f32_16x16x32_bf16 v[112:115], v[80:83], v[48:51], v[112:115]
    ds_read_b64_tr_b16 v[64:65], v52 offset:49152
    ds_read_b64_tr_b16 v[66:67], v52 offset:49664
    v_mfma_f32_16x16x32_bf16 v[116:119], v[84:87], v[48:51], v[116:119]
    ds_read_b64_tr_b16 v[68:69], v120 offset:49152
    ds_read_b64_tr_b16 v[70:71], v120 offset:49664
    s_waitcnt vmcnt(4) lgkmcnt(8)
    v_mfma_f32_16x16x32_bf16 v[104:107], v[88:91], v[8:11], v[104:107]
    ds_read_b64_tr_b16 v[72:73], v4 offset:53248
    ds_read_b64_tr_b16 v[74:75], v4 offset:53760
    v_mfma_f32_16x16x32_bf16 v[108:111], v[92:95], v[8:11], v[108:111]
    ds_read_b64_tr_b16 v[76:77], v5 offset:53248
    ds_read_b64_tr_b16 v[78:79], v5 offset:53760
    v_mfma_f32_16x16x32_bf16 v[112:115], v[96:99], v[8:11], v[112:115]
    ds_read_b64_tr_b16 v[80:81], v52 offset:53248
    ds_read_b64_tr_b16 v[82:83], v52 offset:53760
    v_mfma_f32_16x16x32_bf16 v[116:119], v[100:103], v[8:11], v[116:119]
    ds_read_b64_tr_b16 v[84:85], v120 offset:53248
    ds_read_b64_tr_b16 v[86:87], v120 offset:53760
    s_waitcnt vmcnt(3) lgkmcnt(8)
    v_mfma_f32_16x16x32_bf16 v[104:107], v[56:59], v[12:15], v[104:107]
    ds_read_b64_tr_b16 v[88:89], v4 offset:57344
    ds_read_b64_tr_b16 v[90:91], v4 offset:57856
    v_mfma_f32_16x16x32_bf16 v[108:111], v[60:63], v[12:15], v[108:111]
    ds_read_b64_tr_b16 v[92:93], v5 offset:57344
    ds_read_b64_tr_b16 v[94:95], v5 offset:57856
    v_mfma_f32_16x16x32_bf16 v[112:115], v[64:67], v[12:15], v[112:115]
    ds_read_b64_tr_b16 v[96:97], v52 offset:57344
    ds_read_b64_tr_b16 v[98:99], v52 offset:57856
    v_mfma_f32_16x16x32_bf16 v[116:119], v[68:71], v[12:15], v[116:119]
    ds_read_b64_tr_b16 v[100:101], v120 offset:57344
    ds_read_b64_tr_b16 v[102:103], v120 offset:57856
    s_waitcnt vmcnt(2) lgkmcnt(8)
    v_mfma_f32_16x16x32_bf16 v[104:107], v[72:75], v[16:19], v[104:107]
    ds_read_b64_tr_b16 v[56:57], v4 offset:61440
    ds_read_b64_tr_b16 v[58:59], v4 offset:61952
    v_mfma_f32_16x16x32_bf16 v[108:111], v[76:79], v[16:19], v[108:111]
    ds_read_b64_tr_b16 v[60:61], v5 offset:61440
    ds_read_b64_tr_b16 v[62:63], v5 offset:61952
    v_mfma_f32_16x16x32_bf16 v[112:115], v[80:83], v[16:19], v[112:115]
    ds_read_b64_tr_b16 v[64:65], v52 offset:61440
    ds_read_b64_tr_b16 v[66:67], v52 offset:61952
    v_mfma_f32_16x16x32_bf16 v[116:119], v[84:87], v[16:19], v[116:119]
    ds_read_b64_tr_b16 v[68:69], v120 offset:61440
    ds_read_b64_tr_b16 v[70:71], v120 offset:61952
    s_waitcnt vmcnt(1) lgkmcnt(8)
    v_mfma_f32_16x16x32_bf16 v[104:107], v[88:91], v[20:23], v[104:107]
    v_mfma_f32_16x16x32_bf16 v[108:111], v[92:95], v[20:23], v[108:111]
    s_waitcnt vmcnt(0) lgkmcnt(0)
    v_mfma_f32_16x16x32_bf16 v[104:107], v[56:59], v[24:27], v[104:107]
    v_mfma_f32_16x16x32_bf16 v[108:111], v[60:63], v[24:27], v[108:111]
    v_mfma_f32_16x16x32_bf16 v[112:115], v[96:99], v[20:23], v[112:115]
    v_mfma_f32_16x16x32_bf16 v[116:119], v[100:103], v[20:23], v[116:119]
    s_nop 4
    v_cvt_pk_bf16_f32 v40, v104, v105
    v_cvt_pk_bf16_f32 v41, v106, v107
    v_cvt_pk_bf16_f32 v42, v108, v109
    v_mfma_f32_16x16x32_bf16 v[112:115], v[64:67], v[24:27], v[112:115]
    v_cvt_pk_bf16_f32 v43, v110, v111
    v_permlane16_swap_b32 v40, v42
    v_mfma_f32_16x16x32_bf16 v[116:119], v[68:71], v[24:27], v[116:119]
    v_permlane16_swap_b32 v41, v43
    s_cmp_lg_u32 s42, 0
    s_cbranch_scc0 st_44_s
    buffer_store_dwordx4 v[40:43], v122, s[12:15], s76 offen offset:0
st_44:
    v_add_u32_e64 v48, s78, v122
    v_cvt_pk_bf16_f32 v60, v112, v113
    v_cvt_pk_bf16_f32 v61, v114, v115
    s_nop 0
    v_cvt_pk_bf16_f32 v62, v116, v117
    v_cvt_pk_bf16_f32 v63, v118, v119
    s_nop 0
    v_permlane16_swap_b32 v60, v62
    v_permlane16_swap_b32 v61, v63
    s_cmp_lg_u32 s42, 0
    s_cbranch_scc0 st_45_s
    buffer_store_dwordx4 v[60:63], v122, s[12:15], s76 offen offset:1024
st_45:
    ds_write_b128 v48, v[40:43]
    ds_write_b128 v48, v[60:63] offset:1024
    v_pk_mul_f32 v[46:47], v[104:105], v[104:105]
    v_pk_add_f32 v[44:45], v[104:105], v[106:107]
    v_pk_fma_f32 v[46:47], v[106:107], v[106:107], v[46:47]
    v_pk_fma_f32 v[46:47], v[108:109], v[108:109], v[46:47]
    v_pk_add_f32 v[44:45], v[44:45], v[108:109]
    v_pk_fma_f32 v[46:47], v[110:111], v[110:111], v[46:47]
    v_pk_add_f32 v[44:45], v[44:45], v[110:111]
    v_pk_fma_f32 v[46:47], v[112:113], v[112:113], v[46:47]
    v_pk_add_f32 v[44:45], v[44:45], v[112:113]
    v_pk_fma_f32 v[46:47], v[114:115], v[114:115], v[46:47]
    v_pk_add_f32 v[44:45], v[44:45], v[114:115]
    v_pk_fma_f32 v[46:47], v[116:117], v[116:117], v[46:47]
    v_pk_add_f32 v[44:45], v[44:45], v[116:117]
    v_pk_fma_f32 v[46:47], v[118:119], v[118:119], v[46:47]
    v_pk_add_f32 v[44:45], v[44:45], v[118:119]
    v_add_f32 v112, v44, v45
    v_add_f32 v113, v46, v47
    v_lshlrev_b32 v114, 6, v2
    s_nop 0
    v_permlane32_swap_b32 v112, v113
    v_add_f32 v112, v112, v113
    v_mov_b32 v113, v112
    s_nop 1
    v_permlane16_swap_b32 v112, v113
    v_add_f32 v112, v112, v113
    v_mov_b32_e64 v113, v112
    s_nop 1
    v_permlane32_swap_b32 v112, v113
    s_add_u32 s43, s43, 7
    s_add_u32 s101, s101, 7
    s_add_u32 s73, s73, 4194304
    s_add_u32 s87, s87, 524288
    s_add_u32 s89, s89, 524288
    s_add_u32 s88, s88, 65536
    s_add_u32 s90, s90, 65536
    s_mov_b32 s41, 1
    s_xor_b32 s48, s76, s85
    s_lshr_b32 s48, s48, 4
    s_xor_b32 s84, s84, s48
    s_add_u32 s48, s43, -1
    v_mov_b32 v6, s48
    s_cmp_lg_u32 s42, 0
    s_mov_b64 exec, 1
    s_waitcnt vmcnt(0)
    s_cbranch_scc0 sig_46_s
    buffer_store_dword v6, off, s[4:7], s47
sig_46:
    s_mov_b64 exec, -1
    s_cmp_lg_u32 s42, 0
    s_cbranch_scc0 st_47_s
    s_mov_b64 exec, 0xffff
    buffer_store_dwordx2 v[112:113], v114, s[4:7], s86 offen
    s_mov_b64 exec, -1
st_47:
L_round:
    v_add_u32 v120, 131072, v0
    s_lshl_b32 s61, s45, 14
    v_lshlrev_b32 v121, 6, v2
    v_lshl_add_u32 v121, v3, 4, v121
    s_bfe_u32 s58, s80, 0x30000
    s_add_u32 m0, s78, 2048
    s_lshl_b32 s58, s58, 11
    s_add_u32 s58, s58, s61
    s_lshl_b32 s50, 0x11111111, s3
    s_mov_b32 s51, 0
    s_waitcnt lgkmcnt(0)
    s_barrier
    ds_read_b128 v[64:67], v120 offset:0
    ds_read_b128 v[68:71], v120 offset:6144
    ds_read_b128 v[72:75], v120 offset:12288
    ds_read_b128 v[76:79], v120 offset:18432
    s_add_i32 s48, s43, -1
    s_mov_b32 s49, s44
    s_mov_b64 exec, s[50:51]
    buffer_load_dword v126, v124, s[4:7], 0 offen sc1
    s_nop 7
    s_nop 7
poll_48:
    buffer_load_dword v127, v124, s[4:7], 0 offen sc1
    s_waitcnt vmcnt(1)
    v_subrev_u32 v126, s48, v126
    v_cmp_gt_u32 vcc, 16, v126
    s_nop 0
    s_cmp_eq_u64 vcc, s[50:51]
    s_nop 1
    s_cbranch_scc1 poll_48_ok
    buffer_load_dword v126, v124, s[4:7], 0 offen sc1
    s_waitcnt vmcnt(1)
    v_subrev_u32 v127, s48, v127
    v_cmp_gt_u32 vcc, 16, v127
    s_nop 0
    s_cmp_eq_u64 vcc, s[50:51]
    s_nop 1
    s_cbranch_scc1 poll_48_ok
    s_add_u32 s49, s49, 1
    s_cmp_lt_u32 s49, 2000000
    s_cbranch_scc1 poll_48
    s_mov_b32 s44, 2000000
poll_48_ok:
    s_mov_b64 exec, -1
    buffer_load_dwordx4 v0, s[12:15], s58 offen sc1 lds
    buffer_load_dwordx4 v0, s[12:15], s58 offen offset:1024 sc1 lds
    s_add_u32 s48, s43, 0
    v_mov_b32 v6, s48
    s_cmp_lg_u32 s42, 0
    s_mov_b64 exec, 1
    s_cbranch_scc0 sig_49_s
    buffer_store_dword v6, off, s[4:7], s47
sig_49:
    s_mov_b64 exec, -1
    s_waitcnt lgkmcnt(0)
    v_mfma_f32_16x16x32_bf16 v[24:27], a[120:123], v[64:67], 0
    ds_read_b128 v[80:83], v120 offset:1024
    v_mfma_f32_16x16x32_bf16 v[8:11], a[56:59], v[64:67], 0
    s_bfe_u32 s58, s80, 0x30004
    s_add_u32 m0, s78, 4096
    v_mfma_f32_16x16x32_bf16 v[28:31], a[120:123], v[68:71], 0
    s_lshl_b32 s58, s58, 11
    s_add_u32 s58, s58, s61
    v_mfma_f32_16x16x32_bf16 v[12:15], a[56:59], v[68:71], 0
    buffer_load_dwordx4 v0, s[12:15], s58 offen sc1 lds
    v_mfma_f32_16x16x32_bf16 v[32:35], a[120:123], v[72:75], 0
    ds_read_b128 v[84:87], v120 offset:7168
    v_mfma_f32_16x16x32_bf16 v[16:19], a[56:59], v[72:75], 0
    ds_read_b128 v[88:91], v120 offset:13312
    v_mfma_f32_16x16x32_bf16 v[36:39], a[120:123], v[76:79], 0
    ds_read_b128 v[92:95], v120 offset:19456
    v_mfma_f32_16x16x32_bf16 v[20:23], a[56:59], v[76:79], 0
    s_mul_i32 s59, s3, 192
    v_mfma_f32_16x16x32_bf16 v[44:47], v[64:67], a[184:187], 0
    s_add_u32 s59, s59, 156672
    v_mfma_f32_16x16x32_bf16 v[48:51], v[68:71], a[184:187], 0
    buffer_load_dwordx4 v0, s[12:15], s58 offen offset:1024 sc1 lds
    v_mfma_f32_16x16x32_bf16 v[52:55], v[72:75], a[184:187], 0
    v_lshl_add_u32 v6, v3, 4, s59
    v_mfma_f32_16x16x32_bf16 v[56:59], v[76:79], a[184:187], 0
    s_waitcnt lgkmcnt(0)
    v_mfma_f32_16x16x32_bf16 v[24:27], a[124:127], v[80:83], v[24:27]
    v_lshl_add_u32 v7, v2, 2, s59
    v_mfma_f32_16x16x32_bf16 v[8:11], a[60:63], v[80:83], v[8:11]
    ds_read_b128 v[100:103], v6
    v_mfma_f32_16x16x32_bf16 v[28:31], a[124:127], v[84:87], v[28:31]
    ds_read_b128 v[104:107], v6 offset:64
    v_mfma_f32_16x16x32_bf16 v[12:15], a[60:63], v[84:87], v[12:15]
    ds_read_b32 v108, v7 offset:128
    v_mfma_f32_16x16x32_bf16 v[32:35], a[124:127], v[88:91], v[32:35]
    s_add_u32 s57, s43, 0
    v_mfma_f32_16x16x32_bf16 v[16:19], a[60:63], v[88:91], v[16:19]
    s_waitcnt vmcnt(3)
    s_barrier
    v_mfma_f32_16x16x32_bf16 v[36:39], a[124:127], v[92:95], v[36:39]
    ds_read_b128 v[96:99], v120 offset:2048
    s_bfe_u32 s58, s80, 0x30008
    v_mfma_f32_16x16x32_bf16 v[20:23], a[60:63], v[92:95], v[20:23]
    ds_read_b128 v[60:63], v120 offset:8192
    s_add_u32 m0, s78, 0
    v_mfma_f32_16x16x32_bf16 v[44:47], v[80:83], a[188:191], v[44:47]
    ds_read_b128 a[56:59], v120 offset:14336
    s_lshl_b32 s58, s58, 11
    v_mfma_f32_16x16x32_bf16 v[48:51], v[84:87], a[188:191], v[48:51]
    ds_read_b128 a[120:123], v120 offset:20480
    s_add_u32 s58, s58, s61
    v_mfma_f32_16x16x32_bf16 v[52:55], v[88:91], a[188:191], v[52:55]
    buffer_load_dwordx4 v0, s[12:15], s58 offen sc1 lds
    v_mfma_f32_16x16x32_bf16 v[56:59], v[92:95], a[188:191], v[56:59]
    buffer_load_dwordx4 v0, s[12:15], s58 offen offset:1024 sc1 lds
    s_waitcnt lgkmcnt(0)
    v_mfma_f32_16x16x32_bf16 v[24:27], a[64:67], v[96:99], v[24:27]
    ds_read_b128 a[184:187], v120 offset:3072
    v_mfma_f32_16x16x32_bf16 v[28:31], a[64:67], v[60:63], v[28:31]
    ds_read_b128 a[60:63], v120 offset:9216
    v_mfma_f32_16x16x32_bf16 v[32:35], a[64:67], a[56:59], v[32:35]
    ds_read_b128 a[124:127], v120 offset:15360
    v_mfma_f32_16x16x32_bf16 v[36:39], a[64:67], a[120:123], v[36:39]
    ds_read_b128 a[188:191], v120 offset:21504
    v_mfma_f32_16x16x32_bf16 v[44:47], v[96:99], a[128:131], v[44:47]
    s_mov_b32 exec_hi, 0
    buffer_load_dword v126, v124, s[4:7], 0 offen sc1
    s_mov_b32 exec_hi, -1
    v_mfma_f32_16x16x32_bf16 v[48:51], v[60:63], a[128:131], v[48:51]
    s_lshl_b32 s60, 0x11111111, s3
    v_mfma_f32_16x16x32_bf16 v[52:55], a[56:59], a[128:131], v[52:55]
    v_mfma_f32_16x16x32_bf16 v[56:59], a[120:123], a[128:131], v[56:59]
    s_waitcnt vmcnt(3) lgkmcnt(0)
    s_barrier
    v_mfma_f32_16x16x32_bf16 v[24:27], a[68:71], a[184:187], v[24:27]
    ds_read_b128 v[64:67], v120 offset:4096
    s_bfe_u32 s58, s80, 0x3000c
    v_mfma_f32_16x16x32_bf16 v[28:31], a[68:71], a[60:63], v[28:31]
    ds_read_b128 v[68:71], v120 offset:10240
    s_add_u32 m0, s78, 2048
    v_mfma_f32_16x16x32_bf16 v[32:35], a[68:71], a[124:127], v[32:35]
    ds_read_b128 v[72:75], v120 offset:16384
    s_lshl_b32 s58, s58, 11
    v_mfma_f32_16x16x32_bf16 v[36:39], a[68:71], a[188:191], v[36:39]
    ds_read_b128 v[76:79], v120 offset:22528
    s_add_u32 s58, s58, s61
    v_mfma_f32_16x16x32_bf16 v[44:47], a[184:187], a[132:135], v[44:47]
    buffer_load_dwordx4 v0, s[12:15], s58 offen sc1 lds
    v_mfma_f32_16x16x32_bf16 v[48:51], a[60:63], a[132:135], v[48:51]
    v_mfma_f32_16x16x32_bf16 v[52:55], a[124:127], a[132:135], v[52:55]
    buffer_load_dwordx4 v0, s[12:15], s58 offen offset:1024 sc1 lds
    v_mfma_f32_16x16x32_bf16 v[56:59], a[188:191], a[132:135], v[56:59]
    s_waitcnt lgkmcnt(0)
    v_mfma_f32_16x16x32_bf16 v[24:27], a[72:75], v[64:67], v[24:27]
    ds_read_b128 a[64:67], v120 offset:5120
    v_mfma_f32_16x16x32_bf16 v[8:11], a[8:11], v[64:67], v[8:11]
    ds_read_b128 a[128:131], v120 offset:11264
    v_mfma_f32_16x16x32_bf16 v[28:31], a[72:75], v[68:71], v[28:31]
    ds_read_b128 a[68:71], v120 offset:17408
    v_mfma_f32_16x16x32_bf16 v[12:15], a[8:11], v[68:71], v[12:15]
    ds_read_b128 a[132:135], v120 offset:23552
    v_mfma_f32_16x16x32_bf16 v[32:35], a[72:75], v[72:75], v[32:35]
    s_waitcnt vmcnt(2)
    v_subrev_u32 v126, s57, v126
    v_cmp_le_u32_e64 vcc, 16, v126
    s_nop 0
    s_and_b32 s48, vcc_lo, s60
    s_cbranch_scc1 sq_50_c
sq_50:
    buffer_load_dwordx4 v[40:43], v121, s[4:7], s77 offen sc1
    v_mfma_f32_16x16x32_bf16 v[16:19], a[8:11], v[72:75], v[16:19]
    v_mfma_f32_16x16x32_bf16 v[36:39], a[72:75], v[76:79], v[36:39]
    v_mfma_f32_16x16x32_bf16 v[20:23], a[8:11], v[76:79], v[20:23]
    v_mfma_f32_16x16x32_bf16 v[44:47], v[64:67], a[136:139], v[44:47]
    v_mfma_f32_16x16x32_bf16 v[48:51], v[68:71], a[136:139], v[48:51]
    v_mfma_f32_16x16x32_bf16 v[52:55], v[72:75], a[136:139], v[52:55]
    v_mfma_f32_16x16x32_bf16 v[56:59], v[76:79], a[136:139], v[56:59]
    s_waitcnt vmcnt(4) lgkmcnt(0)
    s_barrier
    v_mfma_f32_16x16x32_bf16 v[24:27], a[76:79], a[64:67], v[24:27]
    ds_read_b128 v[64:67], v120 offset:0
    s_bfe_u32 s58, s80, 0x30010
    v_mfma_f32_16x16x32_bf16 v[28:31], a[76:79], a[128:131], v[28:31]
    ds_read_b128 v[68:71], v120 offset:6144
    s_add_u32 m0, s78, 4096
    v_mfma_f32_16x16x32_bf16 v[32:35], a[76:79], a[68:71], v[32:35]
    ds_read_b128 v[72:75], v120 offset:12288
    s_lshl_b32 s58, s58, 11
    v_mfma_f32_16x16x32_bf16 v[36:39], a[76:79], a[132:135], v[36:39]
    ds_read_b128 v[76:79], v120 offset:18432
    s_add_u32 s58, s58, s61
    v_mfma_f32_16x16x32_bf16 v[44:47], a[64:67], a[140:143], v[44:47]
    buffer_load_dwordx4 v0, s[12:15], s58 offen sc1 lds
    v_mfma_f32_16x16x32_bf16 v[48:51], a[128:131], a[140:143], v[48:51]
    v_mfma_f32_16x16x32_bf16 v[52:55], a[68:71], a[140:143], v[52:55]
    buffer_load_dwordx4 v0, s[12:15], s58 offen offset:1024 sc1 lds
    v_mfma_f32_16x16x32_bf16 v[56:59], a[132:135], a[140:143], v[56:59]
    s_waitcnt lgkmcnt(0)
    v_mfma_f32_16x16x32_bf16 v[24:27], a[80:83], v[64:67], v[24:27]
    ds_read_b128 a[8:11], v120 offset:1024
    v_mfma_f32_16x16x32_bf16 v[8:11], a[16:19], v[64:67], v[8:11]
    ds_read_b128 a[72:75], v120 offset:7168
    v_mfma_f32_16x16x32_bf16 v[28:31], a[80:83], v[68:71], v[28:31]
    ds_read_b128 a[136:139], v120 offset:13312
    v_mfma_f32_16x16x32_bf16 v[12:15], a[16:19], v[68:71], v[12:15]
    ds_read_b128 a[76:79], v120 offset:19456
    v_mfma_f32_16x16x32_bf16 v[32:35], a[80:83], v[72:75], v[32:35]
    v_mfma_f32_16x16x32_bf16 v[16:19], a[16:19], v[72:75], v[16:19]
    v_mfma_f32_16x16x32_bf16 v[36:39], a[80:83], v[76:79], v[36:39]
    v_mfma_f32_16x16x32_bf16 v[20:23], a[16:19], v[76:79], v[20:23]
    v_mfma_f32_16x16x32_bf16 v[44:47], v[64:67], a[144:147], v[44:47]
    v_mfma_f32_16x16x32_bf16 v[48:51], v[68:71], a[144:147], v[48:51]
    v_mfma_f32_16x16x32_bf16 v[52:55], v[72:75], a[144:147], v[52:55]
    v_mfma_f32_16x16x32_bf16 v[56:59], v[76:79], a[144:147], v[56:59]
    s_waitcnt vmcnt(3) lgkmcnt(0)
    s_barrier
    v_mfma_f32_16x16x32_bf16 v[24:27], a[84:87], a[8:11], v[24:27]
    ds_read_b128 a[140:143], v120 offset:2048
    s_bfe_u32 s58, s80, 0x30014
    s_waitcnt vmcnt(2)
    v_add_f32_e64 v112, v40, v42
    v_mfma_f32_16x16x32_bf16 v[28:31], a[84:87], a[72:75], v[28:31]
    ds_read_b128 a[16:19], v120 offset:8192
    s_add_u32 m0, s78, 0
    v_add_f32 v113, v41, v43
    v_mfma_f32_16x16x32_bf16 v[32:35], a[84:87], a[136:139], v[32:35]
    ds_read_b128 a[80:83], v120 offset:14336
    s_lshl_b32 s58, s58, 11
    v_permlane32_swap_b32 v112, v113
    v_mfma_f32_16x16x32_bf16 v[36:39], a[84:87], a[76:79], v[36:39]
    ds_read_b128 a[144:147], v120 offset:20480
    s_add_u32 s58, s58, s61
    v_add_f32 v112, v112, v113
    v_mov_b32_e64 v113, v112
    v_mfma_f32_16x16x32_bf16 v[44:47], a[8:11], a[148:151], v[44:47]
    buffer_load_dwordx4 v0, s[12:15], s58 offen sc1 lds
    v_permlane16_swap_b32 v112, v113
    v_mfma_f32_16x16x32_bf16 v[48:51], a[72:75], a[148:151], v[48:51]
    v_add_f32 v112, v112, v113
    v_mfma_f32_16x16x32_bf16 v[52:55], a[136:139], a[148:151], v[52:55]
    buffer_load_dwordx4 v0, s[12:15], s58 offen offset:1024 sc1 lds
    v_mfma_f32_16x16x32_bf16 v[56:59], a[76:79], a[148:151], v[56:59]
    s_waitcnt lgkmcnt(0)
    v_mfma_f32_16x16x32_bf16 v[24:27], a[88:91], a[140:143], v[24:27]
    ds_read_b128 v[80:83], v120 offset:3072
    v_mov_b32 v113, v112
    v_mfma_f32_16x16x32_bf16 v[28:31], a[88:91], a[16:19], v[28:31]
    ds_read_b128 v[84:87], v120 offset:9216
    v_permlane32_swap_b32 v112, v113
    v_mfma_f32_16x16x32_bf16 v[32:35], a[88:91], a[80:83], v[32:35]
    ds_read_b128 v[88:91], v120 offset:15360
    v_mul_f32 v112, 0x3b000000, v112
    v_mul_f32 v113, 0x3b000000, v113
    v_mfma_f32_16x16x32_bf16 v[36:39], a[88:91], a[144:147], v[36:39]
    ds_read_b128 v[92:95], v120 offset:21504
    v_fma_f32 v113, -v112, v112, v113
    v_max_f32 v113, 0, v113
    v_mfma_f32_16x16x32_bf16 v[44:47], a[140:143], a[152:155], v[44:47]
    v_cvt_pk_bf16_f32 v6, v112, v113
    v_lshlrev_b32_e64 v112, 16, v6
    v_mfma_f32_16x16x32_bf16 v[48:51], a[16:19], a[152:155], v[48:51]
    v_mfma_f32_16x16x32_bf16 v[52:55], a[80:83], a[152:155], v[52:55]
    v_mfma_f32_16x16x32_bf16 v[56:59], a[144:147], a[152:155], v[56:59]
    s_waitcnt vmcnt(2) lgkmcnt(0)
    s_barrier
    v_mfma_f32_16x16x32_bf16 v[24:27], a[92:95], v[80:83], v[24:27]
    ds_read_b128 a[84:87], v120 offset:4096
    v_and_b32 v113, 0xffff0000, v6
    v_mfma_f32_16x16x32_bf16 v[8:11], a[28:31], v[80:83], v[8:11]
    s_bfe_u32 s58, s80, 0x30018
    s_add_u32 m0, s78, 2048
    v_mfma_f32_16x16x32_bf16 v[28:31], a[92:95], v[84:87], v[28:31]
    s_lshl_b32 s58, s58, 11
    s_add_u32 s58, s58, s61
    v_mfma_f32_16x16x32_bf16 v[12:15], a[28:31], v[84:87], v[12:15]
    buffer_load_dwordx4 v0, s[12:15], s58 offen sc1 lds
    v_mfma_f32_16x16x32_bf16 v[32:35], a[92:95], v[88:91], v[32:35]
    ds_read_b128 a[148:151], v120 offset:10240
    v_add_f32 v113, 0x3727c5ac, v113
    v_mfma_f32_16x16x32_bf16 v[16:19], a[28:31], v[88:91], v[16:19]
    ds_read_b128 a[88:91], v120 offset:16384
    v_cvt_pk_bf16_f32 v6, v113, v113
    v_mfma_f32_16x16x32_bf16 v[36:39], a[92:95], v[92:95], v[36:39]
    ds_read_b128 a[152:155], v120 offset:22528
    v_and_b32 v113, 0xffff0000, v6
    v_mfma_f32_16x16x32_bf16 v[20:23], a[28:31], v[92:95], v[20:23]
    v_sqrt_f32_e64 v113, v113
    v_mfma_f32_16x16x32_bf16 v[44:47], v[80:83], a[156:159], v[44:47]
    v_cvt_pk_bf16_f32 v6, v113, v113
    v_and_b32 v113, 0xffff0000, v6
    v_mfma_f32_16x16x32_bf16 v[48:51], v[84:87], a[156:159], v[48:51]
    buffer_load_dwordx4 v0, s[12:15], s58 offen offset:1024 sc1 lds
    v_mfma_f32_16x16x32_bf16 v[52:55], v[88:91], a[156:159], v[52:55]
    v_rcp_f32 v113, v113
    v_mfma_f32_16x16x32_bf16 v[56:59], v[92:95], a[156:159], v[56:59]
    s_waitcnt lgkmcnt(0)
    v_mfma_f32_16x16x32_bf16 v[24:27], a[96:99], a[84:87], v[24:27]
    ds_read_b128 v[80:83], v120 offset:5120
    s_lshl_b32 s59, s3, 7
    v_mfma_f32_16x16x32_bf16 v[28:31], a[96:99], a[148:151], v[28:31]
    ds_read_b128 v[84:87], v120 offset:11264
    v_lshl_add_u32 v7, v2, 3, s59
    v_mfma_f32_16x16x32_bf16 v[32:35], a[96:99], a[88:91], v[32:35]
    ds_read_b128 v[88:91], v120 offset:17408
    v_add_u32 v6, 155648, v7
    v_mfma_f32_16x16x32_bf16 v[36:39], a[96:99], a[152:155], v[36:39]
    ds_read_b128 v[92:95], v120 offset:23552
    ds_write_b64 v6, v[112:113]
    v_mfma_f32_16x16x32_bf16 v[44:47], a[84:87], a[160:163], v[44:47]
    v_lshrrev_b32 v7, 1, v7
    v_add_u32 v7, 156160, v7
    v_mfma_f32_16x16x32_bf16 v[48:51], a[148:151], a[160:163], v[48:51]
    ds_write2_b32 v7, v112, v113 offset0:0 offset1:64
    v_mfma_f32_16x16x32_bf16 v[52:55], a[88:91], a[160:163], v[52:55]
    v_mfma_f32_16x16x32_bf16 v[56:59], a[152:155], a[160:163], v[56:59]
    s_waitcnt vmcnt(2) lgkmcnt(2)
    s_barrier
    v_mfma_f32_16x16x32_bf16 v[24:27], a[100:103], v[80:83], v[24:27]
    ds_read_b128 a[28:31], v120 offset:0
    v_and_b32_e64 v6, 3, v1
    v_mfma_f32_16x16x32_bf16 v[28:31], a[100:103], v[84:87], v[28:31]
    ds_read_b128 a[92:95], v120 offset:6144
    v_mov_b32_e64 v122, s101
    v_mfma_f32_16x16x32_bf16 v[32:35], a[100:103], v[88:91], v[32:35]
    ds_read_b128 a[156:159], v120 offset:12288
    v_mov_b32_e64 v7, s43
    v_mfma_f32_16x16x32_bf16 v[36:39], a[100:103], v[92:95], v[36:39]
    ds_read_b128 a[96:99], v120 offset:18432
    v_cmp_gt_u32 s[48:49], s38, v6
    v_mfma_f32_16x16x32_bf16 v[44:47], v[80:83], a[164:167], v[44:47]
    v_mfma_f32_16x16x32_bf16 v[48:51], v[84:87], a[164:167], v[48:51]
    v_mfma_f32_16x16x32_bf16 v[52:55], v[88:91], a[164:167], v[52:55]
    v_mfma_f32_16x16x32_bf16 v[56:59], v[92:95], a[164:167], v[56:59]
    s_waitcnt lgkmcnt(0)
    v_mfma_f32_16x16x32_bf16 v[24:27], a[104:107], a[28:31], v[24:27]
    ds_read_b128 v[80:83], v120 offset:1024
    v_mfma_f32_16x16x32_bf16 v[28:31], a[104:107], a[92:95], v[28:31]
    ds_read_b128 v[84:87], v120 offset:7168
    v_mfma_f32_16x16x32_bf16 v[32:35], a[104:107], a[156:159], v[32:35]
    ds_read_b128 v[88:91], v120 offset:13312
    v_mfma_f32_16x16x32_bf16 v[36:39], a[104:107], a[96:99], v[36:39]
    ds_read_b128 v[92:95], v120 offset:19456
    v_mfma_f32_16x16x32_bf16 v[44:47], a[28:31], a[168:171], v[44:47]
    v_cndmask_b32 v122, v122, v7, s[48:49]
    v_mfma_f32_16x16x32_bf16 v[48:51], a[92:95], a[168:171], v[48:51]
    v_add_u32 v122, 1, v122
    v_mfma_f32_16x16x32_bf16 v[52:55], a[156:159], a[168:171], v[52:55]
    s_mov_b32 s81, s82
    v_mfma_f32_16x16x32_bf16 v[56:59], a[96:99], a[168:171], v[56:59]
    s_waitcnt vmcnt(0) lgkmcnt(0)
    s_barrier
    v_mfma_f32_16x16x32_bf16 v[24:27], a[108:111], v[80:83], v[24:27]
    ds_read_b128 a[160:163], v120 offset:2048
    v_mfma_f32_16x16x32_bf16 v[28:31], a[108:111], v[84:87], v[28:31]
    ds_read_b128 a[100:103], v120 offset:8192
    v_mfma_f32_16x16x32_bf16 v[32:35], a[108:111], v[88:91], v[32:35]
    ds_read_b128 a[164:167], v120 offset:14336
    v_mfma_f32_16x16x32_bf16 v[36:39], a[108:111], v[92:95], v[36:39]
    ds_read_b128 a[104:107], v120 offset:20480
    v_mfma_f32_16x16x32_bf16 v[44:47], v[80:83], a[172:175], v[44:47]
    v_lshlrev_b32 v6, 3, v2
    v_mfma_f32_16x16x32_bf16 v[48:51], v[84:87], a[172:175], v[48:51]
    v_add_u32 v6, 155648, v6
    v_mfma_f32_16x16x32_bf16 v[52:55], v[88:91], a[172:175], v[52:55]
    ds_read2_b64 v[112:115], v6 offset0:0 offset1:16
    v_mfma_f32_16x16x32_bf16 v[56:59], v[92:95], a[172:175], v[56:59]
    s_waitcnt lgkmcnt(1)
    v_mfma_f32_16x16x32_bf16 v[24:27], a[112:115], a[160:163], v[24:27]
    ds_read_b128 v[80:83], v120 offset:3072
    ds_read2_b64 v[116:119], v6 offset0:32 offset1:48
    v_mfma_f32_16x16x32_bf16 v[28:31], a[112:115], a[100:103], v[28:31]
    ds_read_b128 v[84:87], v120 offset:9216
    v_lshlrev_b32 v121, 4, v3
    v_mfma_f32_16x16x32_bf16 v[32:35], a[112:115], a[164:167], v[32:35]
    ds_read_b128 v[88:91], v120 offset:15360
    v_add_u32 v121, 156160, v121
    v_mfma_f32_16x16x32_bf16 v[36:39], a[112:115], a[104:107], v[36:39]
    ds_read_b128 v[92:95], v120 offset:21504
    v_mfma_f32_16x16x32_bf16 v[44:47], a[160:163], a[176:179], v[44:47]
    buffer_load_dword v126, v125, s[4:7], 0 offen sc1
    v_mfma_f32_16x16x32_bf16 v[48:51], a[100:103], a[176:179], v[48:51]
    v_mfma_f32_16x16x32_bf16 v[52:55], a[164:167], a[176:179], v[52:55]
    v_mfma_f32_16x16x32_bf16 v[56:59], a[104:107], a[176:179], v[56:59]
    s_waitcnt lgkmcnt(0)
    v_mfma_f32_16x16x32_bf16 v[24:27], a[116:119], v[80:83], v[24:27]
    ds_read_b128 v[64:67], v121 offset:0
    ds_read_b128 v[68:71], v121 offset:256
    v_mfma_f32_16x16x32_bf16 v[28:31], a[116:119], v[84:87], v[28:31]
    ds_read_b128 v[72:75], v121 offset:64
    ds_read_b128 v[76:79], v121 offset:320
    v_mfma_f32_16x16x32_bf16 v[32:35], a[116:119], v[88:91], v[32:35]
    v_mfma_f32_16x16x32_bf16 v[36:39], a[116:119], v[92:95], v[36:39]
    v_mfma_f32_16x16x32_bf16 v[44:47], v[80:83], a[180:183], v[44:47]
    v_mfma_f32_16x16x32_bf16 v[48:51], v[84:87], a[180:183], v[48:51]
    v_mfma_f32_16x16x32_bf16 v[52:55], v[88:91], a[180:183], v[52:55]
    v_mfma_f32_16x16x32_bf16 v[56:59], v[92:95], a[180:183], v[56:59]
    ds_read_b128 v[80:83], v121 offset:128
    ds_read_b128 v[84:87], v121 offset:384
    ds_read_b128 v[88:91], v121 offset:192
    ds_read_b128 v[92:95], v121 offset:448
    s_waitcnt lgkmcnt(11)
    s_mov_b32 s63, 0
    v_pk_fma_f32 v[24:25], v[104:105], v[112:113], v[24:25] op_sel:[0,0,0] op_sel_hi:[1,0,1] neg_lo:[0,1,0] neg_hi:[0,1,0]
    v_pk_fma_f32 v[26:27], v[106:107], v[112:113], v[26:27] op_sel:[0,0,0] op_sel_hi:[1,0,1] neg_lo:[0,1,0] neg_hi:[0,1,0]
    v_pk_mul_f32 v[24:25], v[24:25], v[112:113] op_sel:[0,1] op_sel_hi:[1,1]
    v_pk_mul_f32 v[26:27], v[26:27], v[112:113] op_sel:[0,1] op_sel_hi:[1,1]
    v_cvt_pk_bf16_f32 v24, v24, v25
    v_cvt_pk_bf16_f32 v25, v26, v27
    v_pk_fma_f32 v[28:29], v[104:105], v[114:115], v[28:29] op_sel:[0,0,0] op_sel_hi:[1,0,1] neg_lo:[0,1,0] neg_hi:[0,1,0]
    v_pk_fma_f32 v[30:31], v[106:107], v[114:115], v[30:31] op_sel:[0,0,0] op_sel_hi:[1,0,1] neg_lo:[0,1,0] neg_hi:[0,1,0]
    v_pk_mul_f32 v[28:29], v[28:29], v[114:115] op_sel:[0,1] op_sel_hi:[1,1]
    v_pk_mul_f32 v[30:31], v[30:31], v[114:115] op_sel:[0,1] op_sel_hi:[1,1]
    v_cvt_pk_bf16_f32 v26, v28, v29
    v_cvt_pk_bf16_f32 v27, v30, v31
    v_pk_fma_f32 v[32:33], v[104:105], v[116:117], v[32:33] op_sel:[0,0,0] op_sel_hi:[1,0,1] neg_lo:[0,1,0] neg_hi:[0,1,0]
    v_pk_fma_f32 v[34:35], v[106:107], v[116:117], v[34:35] op_sel:[0,0,0] op_sel_hi:[1,0,1] neg_lo:[0,1,0] neg_hi:[0,1,0]
    v_pk_mul_f32 v[32:33], v[32:33], v[116:117] op_sel:[0,1] op_sel_hi:[1,1]
    v_pk_mul_f32 v[34:35], v[34:35], v[116:117] op_sel:[0,1] op_sel_hi:[1,1]
    v_cvt_pk_bf16_f32 v32, v32, v33
    v_cvt_pk_bf16_f32 v33, v34, v35
    v_pk_fma_f32 v[36:37], v[104:105], v[118:119], v[36:37] op_sel:[0,0,0] op_sel_hi:[1,0,1] neg_lo:[0,1,0] neg_hi:[0,1,0]
    v_pk_fma_f32 v[38:39], v[106:107], v[118:119], v[38:39] op_sel:[0,0,0] op_sel_hi:[1,0,1] neg_lo:[0,1,0] neg_hi:[0,1,0]
    v_pk_mul_f32 v[36:37], v[36:37], v[118:119] op_sel:[0,1] op_sel_hi:[1,1]
    v_pk_mul_f32 v[38:39], v[38:39], v[118:119] op_sel:[0,1] op_sel_hi:[1,1]
    v_cvt_pk_bf16_f32 v34, v36, v37
    v_cvt_pk_bf16_f32 v35, v38, v39
    v_permlane16_swap_b32 v24, v26
    v_permlane16_swap_b32 v25, v27
    v_permlane16_swap_b32 v32, v34
    v_permlane16_swap_b32 v33, v35
    s_waitcnt lgkmcnt(0)
    v_pk_fma_f32 v[44:45], v[64:65], v[108:109], v[44:45] op_sel:[0,0,0] op_sel_hi:[1,0,1] neg_lo:[1,0,0] neg_hi:[1,0,0]
    buffer_store_dwordx4 v[24:27], v0, s[4:7], s73 offen offset:0 sc1
    v_pk_fma_f32 v[46:47], v[66:67], v[108:109], v[46:47] op_sel:[0,0,0] op_sel_hi:[1,0,1] neg_lo:[1,0,0] neg_hi:[1,0,0]
    v_pk_mul_f32 v[44:45], v[44:45], v[68:69]
    v_pk_mul_f32 v[46:47], v[46:47], v[70:71]
    v_cvt_pk_bf16_f32 v44, v44, v45
    v_cvt_pk_bf16_f32 v45, v46, v47
    v_pk_fma_f32 v[48:49], v[72:73], v[108:109], v[48:49] op_sel:[0,0,0] op_sel_hi:[1,0,1] neg_lo:[1,0,0] neg_hi:[1,0,0]
    v_pk_fma_f32 v[50:51], v[74:75], v[108:109], v[50:51] op_sel:[0,0,0] op_sel_hi:[1,0,1] neg_lo:[1,0,0] neg_hi:[1,0,0]
    v_pk_mul_f32 v[48:49], v[48:49], v[76:77]
    buffer_store_dwordx4 v[32:35], v0, s[4:7], s73 offen offset:2048 sc1
    v_pk_mul_f32 v[50:51], v[50:51], v[78:79]
    v_cvt_pk_bf16_f32 v46, v48, v49
    v_cvt_pk_bf16_f32 v47, v50, v51
    v_pk_fma_f32 v[52:53], v[80:81], v[108:109], v[52:53] op_sel:[0,0,0] op_sel_hi:[1,0,1] neg_lo:[1,0,0] neg_hi:[1,0,0]
    v_pk_fma_f32 v[54:55], v[82:83], v[108:109], v[54:55] op_sel:[0,0,0] op_sel_hi:[1,0,1] neg_lo:[1,0,0] neg_hi:[1,0,0]
    v_pk_mul_f32 v[52:53], v[52:53], v[84:85]
    v_pk_mul_f32 v[54:55], v[54:55], v[86:87]
    v_cvt_pk_bf16_f32 v52, v52, v53
    v_cvt_pk_bf16_f32 v53, v54, v55
    v_pk_fma_f32 v[56:57], v[88:89], v[108:109], v[56:57] op_sel:[0,0,0] op_sel_hi:[1,0,1] neg_lo:[1,0,0] neg_hi:[1,0,0]
    v_pk_fma_f32 v[58:59], v[90:91], v[108:109], v[58:59] op_sel:[0,0,0] op_sel_hi:[1,0,1] neg_lo:[1,0,0] neg_hi:[1,0,0]
    v_pk_mul_f32 v[56:57], v[56:57], v[92:93]
    v_pk_mul_f32 v[58:59], v[58:59], v[94:95]
    v_cvt_pk_bf16_f32 v54, v56, v57
    v_cvt_pk_bf16_f32 v55, v58, v59
    v_permlane16_swap_b32 v44, v46
    v_permlane16_swap_b32 v45, v47
    v_permlane16_swap_b32 v52, v54
    v_permlane16_swap_b32 v53, v55
    v_permlane32_swap_b32 v44, v46
    v_permlane32_swap_b32 v45, v47
    v_permlane32_swap_b32 v52, v54
    v_permlane32_swap_b32 v53, v55
    buffer_store_dwordx4 v[44:47], v0, s[4:7], s73 offen offset:1024 sc1
    buffer_store_dwordx4 v[52:55], v0, s[4:7], s73 offen offset:3072 sc1
    v_mfma_f32_16x16x32_bf16 v[8:11], a[0:3], v[96:99], v[8:11]
    ds_read_b128 a[168:171], v120 offset:5120
    v_mfma_f32_16x16x32_bf16 v[12:15], a[0:3], v[60:63], v[12:15]
    ds_read_b128 a[108:111], v120 offset:11264
    v_mfma_f32_16x16x32_bf16 v[16:19], a[0:3], a[56:59], v[16:19]
    ds_read_b128 a[172:175], v120 offset:17408
    v_mfma_f32_16x16x32_bf16 v[20:23], a[0:3], a[120:123], v[20:23]
    ds_read_b128 a[112:115], v120 offset:23552
    v_mfma_f32_16x16x32_bf16 v[8:11], a[4:7], a[184:187], v[8:11]
    ds_read_b128 a[176:179], v120 offset:1024
    v_mfma_f32_16x16x32_bf16 v[12:15], a[4:7], a[60:63], v[12:15]
    ds_read_b128 a[116:119], v120 offset:7168
    v_mfma_f32_16x16x32_bf16 v[16:19], a[4:7], a[124:127], v[16:19]
    ds_read_b128 a[180:183], v120 offset:13312
    v_mfma_f32_16x16x32_bf16 v[20:23], a[4:7], a[188:191], v[20:23]
    ds_read_b128 v[64:67], v120 offset:19456
    v_mfma_f32_16x16x32_bf16 v[8:11], a[12:15], a[64:67], v[8:11]
    ds_read_b128 v[68:71], v120 offset:3072
    v_mfma_f32_16x16x32_bf16 v[12:15], a[12:15], a[128:131], v[12:15]
    ds_read_b128 v[72:75], v120 offset:9216
    v_mfma_f32_16x16x32_bf16 v[16:19], a[12:15], a[68:71], v[16:19]
    ds_read_b128 v[76:79], v120 offset:15360
    v_mfma_f32_16x16x32_bf16 v[20:23], a[12:15], a[132:135], v[20:23]
    ds_read_b128 v[80:83], v120 offset:21504
    v_mfma_f32_16x16x32_bf16 v[8:11], a[20:23], a[8:11], v[8:11]
    v_mov_b32 v48, 0x3f803f80
    v_mfma_f32_16x16x32_bf16 v[12:15], a[20:23], a[72:75], v[12:15]
    v_mov_b32 v49, 0x3f803f80
    v_mfma_f32_16x16x32_bf16 v[16:19], a[20:23], a[136:139], v[16:19]
    v_mov_b32 v50, 0x3f803f80
    v_mfma_f32_16x16x32_bf16 v[20:23], a[20:23], a[76:79], v[20:23]
    v_mov_b32 v51, 0x3f803f80
    v_mfma_f32_16x16x32_bf16 v[8:11], a[24:27], a[140:143], v[8:11]
    v_mov_b32 v56, 0x3f803f80
    v_mfma_f32_16x16x32_bf16 v[12:15], a[24:27], a[16:19], v[12:15]
    v_mov_b32 v57, 0x3f803f80
    v_mfma_f32_16x16x32_bf16 v[16:19], a[24:27], a[80:83], v[16:19]
    v_mov_b32 v58, 0x3f803f80
    v_mfma_f32_16x16x32_bf16 v[20:23], a[24:27], a[144:147], v[20:23]
    v_mov_b32 v59, 0x3f803f80
    s_waitcnt lgkmcnt(0)
    s_barrier
    v_mfma_f32_16x16x32_bf16 v[8:11], a[32:35], a[84:87], v[8:11]
    v_permlane16_swap_b32 v44, v48
    v_mfma_f32_16x16x32_bf16 v[12:15], a[32:35], a[148:151], v[12:15]
    v_permlane16_swap_b32 v45, v49
    v_mfma_f32_16x16x32_bf16 v[16:19], a[32:35], a[88:91], v[16:19]
    v_permlane16_swap_b32 v46, v50
    v_mfma_f32_16x16x32_bf16 v[20:23], a[32:35], a[152:155], v[20:23]
    v_permlane16_swap_b32 v47, v51
    v_mfma_f32_16x16x32_bf16 v[8:11], a[40:43], a[28:31], v[8:11]
    v_permlane16_swap_b32 v52, v56
    v_mfma_f32_16x16x32_bf16 v[12:15], a[40:43], a[92:95], v[12:15]
    v_permlane16_swap_b32 v53, v57
    v_mfma_f32_16x16x32_bf16 v[16:19], a[40:43], a[156:159], v[16:19]
    v_permlane16_swap_b32 v54, v58
    v_mfma_f32_16x16x32_bf16 v[20:23], a[40:43], a[96:99], v[20:23]
    v_permlane16_swap_b32 v55, v59
    v_mfma_f32_16x16x32_bf16 v[8:11], a[48:51], a[160:163], v[8:11]
    v_mfma_f32_16x16x32_bf16 v[12:15], a[48:51], a[100:103], v[12:15]
    v_mfma_f32_16x16x32_bf16 v[16:19], a[48:51], a[164:167], v[16:19]
    v_mfma_f32_16x16x32_bf16 v[20:23], a[48:51], a[104:107], v[20:23]
    s_waitcnt vmcnt(4)
    v_sub_u32 v126, v126, v122
    v_cmp_gt_u32 vcc, 16, v126
    s_nop 0
    s_or_b32 s81, s81, vcc_lo
    s_bitcmp1_b32 s81, 0
    s_nop 0
    s_cbranch_scc0 L_tp_n
    s_add_u32 m0, s78, -2048
    s_sub_u32 s58, s73, 4096
    s_cmp_gt_u32 s40, 0
    s_cselect_b32 s58, s58, 2147418112
    buffer_load_dwordx4 v0, s[4:7], s58 offen offset:2048 sc1 lds
    buffer_load_dwordx4 v0, s[4:7], s58 offen offset:3072 sc1 lds
    s_add_u32 m0, s78, 2048
    s_mov_b32 s63, 1
    buffer_load_dwordx4 v0, s[4:7], s58 offen offset:0 sc1 lds
    buffer_load_dwordx4 v0, s[4:7], s58 offen offset:1024 sc1 lds
    s_waitcnt vmcnt(4)
    s_branch L_tp_e
L_tp_n:
    s_waitcnt vmcnt(0)
L_tp_e:
    s_add_u32 s48, s43, 1
    v_mov_b32 v6, s48
    s_cmp_lg_u32 s42, 0
    s_mov_b64 exec, 1
    s_cbranch_scc0 sig_51_s
    buffer_store_dword v6, off, s[4:7], s47
sig_51:
    buffer_store_dword v6, off, s[4:7], s47 offset:128 sc1
    s_mov_b64 exec, -1
    v_mfma_f32_16x16x32_bf16 v[8:11], a[36:39], a[168:171], v[8:11]
    v_mfma_f32_16x16x32_bf16 v[12:15], a[36:39], a[108:111], v[12:15]
    v_mfma_f32_16x16x32_bf16 v[16:19], a[36:39], a[172:175], v[16:19]
    v_mfma_f32_16x16x32_bf16 v[20:23], a[36:39], a[112:115], v[20:23]
    v_mfma_f32_16x16x32_bf16 v[8:11], a[44:47], a[176:179], v[8:11]
    v_mfma_f32_16x16x32_bf16 v[12:15], a[44:47], a[116:119], v[12:15]
    v_mfma_f32_16x16x32_bf16 v[16:19], a[44:47], a[180:183], v[16:19]
    v_mfma_f32_16x16x32_bf16 v[20:23], a[44:47], v[64:67], v[20:23]
    v_mfma_f32_16x16x32_bf16 v[8:11], a[52:55], v[68:71], v[8:11]
    v_mfma_f32_16x16x32_bf16 v[12:15], a[52:55], v[72:75], v[12:15]
    v_mfma_f32_16x16x32_bf16 v[16:19], a[52:55], v[76:79], v[16:19]
    v_mfma_f32_16x16x32_bf16 v[20:23], a[52:55], v[80:83], v[20:23]
    s_nop 6
    s_branch L_qepi
L_div:
    v_exp_f32 v68, v68
    v_exp_f32 v69, v69
    v_exp_f32 v70, v70
    s_add_u32 m0, s78, 0
    v_exp_f32 v71, v71
    s_waitcnt lgkmcnt(0)
    v_mfma_f32_32x32x16_bf16 v[84:99], v[12:15], v[8:11], 0
    v_exp_f32 v72, v72
    buffer_load_dwordx4 v0, s[4:7], s61 offen offset:3072 sc1 lds
    v_exp_f32 v73, v73
    v_exp_f32 v74, v74
    s_add_u32 m0, s78, 4096
    v_exp_f32 v75, v75
    v_exp_f32 v76, v76
    v_mfma_f32_32x32x16_bf16 v[52:67], v[44:47], v[108:111], v[52:67]
    buffer_load_dwordx4 v0, s[4:7], s61 offen offset:0 sc1 lds
    v_exp_f32 v77, v77
    v_exp_f32 v78, v78
    v_exp_f32 v79, v79
    v_exp_f32 v80, v80
    v_exp_f32 v81, v81
    v_mfma_f32_32x32x16_bf16 v[52:67], v[48:51], v[112:115], v[52:67]
    v_exp_f32 v82, v82
    v_exp_f32_e64 v83, v83
    v_cvt_pk_bf16_f32 v100, v68, v69
    v_cvt_pk_bf16_f32 v101, v70, v71
    v_cvt_pk_bf16_f32 v102, v72, v73
    v_cvt_pk_bf16_f32 v103, v74, v75
    v_cvt_pk_bf16_f32 v104, v76, v77
    v_cvt_pk_bf16_f32 v105, v78, v79
    v_cvt_pk_bf16_f32 v106, v80, v81
    v_cvt_pk_bf16_f32 v107, v82, v83
    v_mfma_f32_32x32x16_bf16 v[68:83], v[12:15], v[16:19], 0
    v_exp_f32 v84, v84
    v_exp_f32 v85, v85
    v_exp_f32 v86, v86
    v_exp_f32 v87, v87
    v_exp_f32 v88, v88
    v_mfma_f32_32x32x16_bf16 v[24:39], v[44:47], v[100:103], v[24:39]
    v_exp_f32 v89, v89
    v_exp_f32 v90, v90
    v_exp_f32 v91, v91
    v_exp_f32 v92, v92
    v_exp_f32 v93, v93
    v_mfma_f32_32x32x16_bf16 v[24:39], v[48:51], v[104:107], v[24:39]
    v_exp_f32 v94, v94
    s_cmp_eq_u32 s40, 1
    s_cbranch_scc1 z_13
z_13_b:
    s_waitcnt vmcnt(5)
    ds_read_b128 v[44:47], v22
    ds_read_b128 v[48:51], v22 offset:256
    ds_read_b128 v[12:15], v120 offset:0
    v_exp_f32 v95, v95
    v_exp_f32 v96, v96
    v_exp_f32 v97, v97
    v_exp_f32 v98, v98
    v_exp_f32_e64 v99, v99
    v_cvt_pk_bf16_f32 v108, v84, v85
    v_cvt_pk_bf16_f32 v109, v86, v87
    v_cvt_pk_bf16_f32 v110, v88, v89
    v_cvt_pk_bf16_f32 v111, v90, v91
    v_cvt_pk_bf16_f32 v112, v92, v93
    v_cvt_pk_bf16_f32 v113, v94, v95
    v_cvt_pk_bf16_f32 v114, v96, v97
    v_cvt_pk_bf16_f32 v115, v98, v99
    s_bitcmp1_b32 s81, 3
    s_cbranch_scc1 aq_14
    s_waitcnt vmcnt(2)
    v_sub_u32 v126, v126, v122
    v_cmp_gt_u32 vcc, 16, v126
    s_nop 0
    s_or_b32 s81, s81, vcc_lo
    s_bitcmp1_b32 s81, 3
    s_nop 0
    s_cbranch_scc1 aq_14
    s_mov_b32 s49, s44
    s_mov_b64 exec, 15
    buffer_load_dword v126, v125, s[4:7], 0 offen sc1
    s_nop 7
    s_nop 7
kp_15:
    buffer_load_dword v127, v125, s[4:7], 0 offen sc1
    s_waitcnt vmcnt(1)
    v_sub_u32 v126, v126, v122
    v_cmp_gt_u32 vcc, 16, v126
    s_nop 0
    s_or_b32 s81, s81, vcc_lo
    s_and_b32 s48, s81, 8
    s_cmp_eq_u32 s48, 8
    s_cbranch_scc1 kp_15_ok
    buffer_load_dword v126, v125, s[4:7], 0 offen sc1
    s_waitcnt vmcnt(1)
    v_sub_u32 v127, v127, v122
    v_cmp_gt_u32 vcc, 16, v127
    s_nop 0
    s_or_b32 s81, s81, vcc_lo
    s_and_b32 s48, s81, 8
    s_cmp_eq_u32 s48, 8
    s_cbranch_scc1 kp_15_ok
    s_add_u32 s49, s49, 1
    s_cmp_lt_u32 s49, 2000000
    s_cbranch_scc1 kp_15
    s_mov_b32 s44, 2000000
kp_15_ok:
    s_mov_b64 exec, -1
aq_14:
    v_exp_f32 v68, v68
    v_exp_f32 v69, v69
    v_exp_f32 v70, v70
    s_add_u32 m0, s78, 4096
    v_exp_f32 v71, v71
    s_waitcnt lgkmcnt(0)
    v_mfma_f32_32x32x16_bf16 v[84:99], v[12:15], v[8:11], 0
    v_exp_f32 v72, v72
    buffer_load_dwordx4 v0, s[4:7], s61 offen offset:1024 sc1 lds
    v_exp_f32 v73, v73
    v_exp_f32 v74, v74
    s_add_u32 m0, s78, -2048
    v_exp_f32 v75, v75
    v_exp_f32_e64 v76, v76
    v_mfma_f32_32x32x16_bf16 v[52:67], v[44:47], v[108:111], v[52:67]
    buffer_load_dwordx4 v0, s[4:7], s62 offen offset:2048 sc1 lds
    v_exp_f32 v77, v77
    v_exp_f32 v78, v78
    v_exp_f32 v79, v79
    v_exp_f32 v80, v80
    v_exp_f32 v81, v81
    v_mfma_f32_32x32x16_bf16 v[52:67], v[48:51], v[112:115], v[52:67]
    v_exp_f32 v82, v82
    v_exp_f32_e64 v83, v83
    v_cvt_pk_bf16_f32 v100, v68, v69
    v_cvt_pk_bf16_f32 v101, v70, v71
    v_cvt_pk_bf16_f32 v102, v72, v73
    v_cvt_pk_bf16_f32 v103, v74, v75
    v_cvt_pk_bf16_f32 v104, v76, v77
    v_cvt_pk_bf16_f32 v105, v78, v79
    v_cvt_pk_bf16_f32 v106, v80, v81
    v_cvt_pk_bf16_f32 v107, v82, v83
    v_mfma_f32_32x32x16_bf16 v[68:83], v[12:15], v[16:19], 0
    v_exp_f32 v84, v84
    v_exp_f32 v85, v85
    v_exp_f32 v86, v86
    v_exp_f32 v87, v87
    v_exp_f32 v88, v88
    v_mfma_f32_32x32x16_bf16 v[24:39], v[44:47], v[100:103], v[24:39]
    v_exp_f32 v89, v89
    v_exp_f32 v90, v90
    v_exp_f32 v91, v91
    v_exp_f32 v92, v92
    v_exp_f32 v93, v93
    v_mfma_f32_32x32x16_bf16 v[24:39], v[48:51], v[104:107], v[24:39]
    v_exp_f32 v94, v94
    s_waitcnt vmcnt(5)
    ds_read_b128 v[44:47], v20
    ds_read_b128 v[48:51], v20 offset:256
    ds_read_b128 v[12:15], v120 offset:2048
    v_exp_f32 v95, v95
    v_exp_f32 v96, v96
    v_exp_f32 v97, v97
    v_exp_f32 v98, v98
    v_exp_f32_e64 v99, v99
    v_cvt_pk_bf16_f32 v108, v84, v85
    v_cvt_pk_bf16_f32 v109, v86, v87
    v_cvt_pk_bf16_f32 v110, v88, v89
    v_cvt_pk_bf16_f32 v111, v90, v91
    v_cvt_pk_bf16_f32 v112, v92, v93
    v_cvt_pk_bf16_f32 v113, v94, v95
    v_cvt_pk_bf16_f32 v114, v96, v97
    v_cvt_pk_bf16_f32 v115, v98, v99
    v_exp_f32 v68, v68
    v_exp_f32 v69, v69
    v_exp_f32 v70, v70
    s_add_u32 m0, s78, -2048
    v_exp_f32 v71, v71
    s_waitcnt lgkmcnt(0)
    v_mfma_f32_32x32x16_bf16 v[84:99], v[12:15], v[8:11], 0
    v_exp_f32 v72, v72
    buffer_load_dwordx4 v0, s[4:7], s62 offen offset:3072 sc1 lds
    v_exp_f32 v73, v73
    v_exp_f32 v74, v74
    s_add_u32 m0, s78, 2048
    v_exp_f32 v75, v75
    v_exp_f32 v76, v76
    v_mfma_f32_32x32x16_bf16 v[52:67], v[44:47], v[108:111], v[52:67]
    buffer_load_dwordx4 v0, s[4:7], s62 offen offset:0 sc1 lds
    v_exp_f32 v77, v77
    v_exp_f32 v78, v78
    v_exp_f32 v79, v79
    v_exp_f32 v80, v80
    v_exp_f32 v81, v81
    v_mfma_f32_32x32x16_bf16 v[52:67], v[48:51], v[112:115], v[52:67]
    v_exp_f32 v82, v82
    v_exp_f32_e64 v83, v83
    v_cvt_pk_bf16_f32 v100, v68, v69
    v_cvt_pk_bf16_f32 v101, v70, v71
    v_cvt_pk_bf16_f32 v102, v72, v73
    v_cvt_pk_bf16_f32 v103, v74, v75
    v_cvt_pk_bf16_f32 v104, v76, v77
    v_cvt_pk_bf16_f32 v105, v78, v79
    v_cvt_pk_bf16_f32 v106, v80, v81
    v_cvt_pk_bf16_f32 v107, v82, v83
    v_mfma_f32_32x32x16_bf16 v[68:83], v[12:15], v[16:19], 0
    v_exp_f32 v84, v84
    v_exp_f32 v85, v85
    v_exp_f32 v86, v86
    v_exp_f32 v87, v87
    v_exp_f32 v88, v88
    v_mfma_f32_32x32x16_bf16 v[24:39], v[44:47], v[100:103], v[24:39]
    v_exp_f32 v89, v89
    v_exp_f32 v90, v90
    v_exp_f32 v91, v91
    v_exp_f32 v92, v92
    v_exp_f32 v93, v93
    v_mfma_f32_32x32x16_bf16 v[24:39], v[48:51], v[104:107], v[24:39]
    v_exp_f32 v94, v94
    s_cmp_eq_u32 s40, 2
    s_cbranch_scc1 z_16
z_16_b:
    s_waitcnt vmcnt(4)
    ds_read_b128 v[44:47], v21
    ds_read_b128 v[48:51], v21 offset:256
    ds_read_b128 v[12:15], v120 offset:4096
    v_exp_f32 v95, v95
    v_exp_f32 v96, v96
    v_exp_f32 v97, v97
    v_exp_f32 v98, v98
    v_exp_f32_e64 v99, v99
    v_cvt_pk_bf16_f32 v108, v84, v85
    v_cvt_pk_bf16_f32 v109, v86, v87
    v_cvt_pk_bf16_f32 v110, v88, v89
    v_cvt_pk_bf16_f32 v111, v90, v91
    v_cvt_pk_bf16_f32 v112, v92, v93
    v_cvt_pk_bf16_f32 v113, v94, v95
    v_cvt_pk_bf16_f32 v114, v96, v97
    v_cvt_pk_bf16_f32 v115, v98, v99
    v_exp_f32 v68, v68
    v_exp_f32 v69, v69
    v_exp_f32 v70, v70
    s_add_u32 m0, s78, 2048
    v_exp_f32 v71, v71
    s_waitcnt lgkmcnt(0)
    v_mfma_f32_32x32x16_bf16 v[84:99], v[12:15], v[8:11], 0
    v_exp_f32 v72, v72
    buffer_load_dwordx4 v0, s[4:7], s62 offen offset:1024 sc1 lds
    v_exp_f32 v73, v73
    v_exp_f32 v74, v74
    v_exp_f32 v75, v75
    v_exp_f32 v76, v76
    v_mfma_f32_32x32x16_bf16 v[52:67], v[44:47], v[108:111], v[52:67]
    v_exp_f32 v77, v77
    v_exp_f32 v78, v78
    v_exp_f32 v79, v79
    v_exp_f32 v80, v80
    v_exp_f32 v81, v81
    v_mfma_f32_32x32x16_bf16 v[52:67], v[48:51], v[112:115], v[52:67]
    v_exp_f32 v82, v82
    v_exp_f32_e64 v83, v83
    v_cvt_pk_bf16_f32 v100, v68, v69
    v_cvt_pk_bf16_f32 v101, v70, v71
    v_cvt_pk_bf16_f32 v102, v72, v73
    v_cvt_pk_bf16_f32 v103, v74, v75
    v_cvt_pk_bf16_f32 v104, v76, v77
    v_cvt_pk_bf16_f32 v105, v78, v79
    v_cvt_pk_bf16_f32 v106, v80, v81
    v_cvt_pk_bf16_f32 v107, v82, v83
    v_mfma_f32_32x32x16_bf16 v[68:83], v[12:15], v[16:19], 0
    v_exp_f32 v84, v84
    v_exp_f32 v85, v85
    v_exp_f32 v86, v86
    v_exp_f32 v87, v87
    v_exp_f32 v88, v88
    v_mfma_f32_32x32x16_bf16 v[24:39], v[44:47], v[100:103], v[24:39]
    v_exp_f32 v89, v89
    v_exp_f32 v90, v90
    v_exp_f32 v91, v91
    v_exp_f32 v92, v92
    v_exp_f32 v93, v93
    v_mfma_f32_32x32x16_bf16 v[24:39], v[48:51], v[104:107], v[24:39]
    v_exp_f32 v94, v94
    s_waitcnt vmcnt(3)
    ds_read_b128 v[44:47], v22
    ds_read_b128 v[48:51], v22 offset:256
    ds_read_b128 v[12:15], v120 offset:0
    v_exp_f32 v95, v95
    v_exp_f32 v96, v96
    v_exp_f32 v97, v97
    v_exp_f32 v98, v98
    v_exp_f32_e64 v99, v99
    v_cvt_pk_bf16_f32 v108, v84, v85
    v_cvt_pk_bf16_f32 v109, v86, v87
    v_cvt_pk_bf16_f32 v110, v88, v89
    v_cvt_pk_bf16_f32 v111, v90, v91
    v_cvt_pk_bf16_f32 v112, v92, v93
    v_cvt_pk_bf16_f32 v113, v94, v95
    v_cvt_pk_bf16_f32 v114, v96, v97
    v_cvt_pk_bf16_f32 v115, v98, v99
    v_exp_f32 v68, v68
    v_exp_f32 v69, v69
    v_exp_f32 v70, v70
    v_exp_f32 v71, v71
    s_waitcnt lgkmcnt(0)
    v_mfma_f32_32x32x16_bf16 v[84:99], v[12:15], v[8:11], 0
    v_exp_f32 v72, v72
    v_exp_f32 v73, v73
    v_exp_f32 v74, v74
    v_exp_f32 v75, v75
    v_exp_f32 v76, v76
    v_mfma_f32_32x32x16_bf16 v[52:67], v[44:47], v[108:111], v[52:67]
    v_exp_f32 v77, v77
    v_exp_f32 v78, v78
    v_exp_f32 v79, v79
    v_exp_f32 v80, v80
    v_exp_f32 v81, v81
    v_mfma_f32_32x32x16_bf16 v[52:67], v[48:51], v[112:115], v[52:67]
    v_exp_f32 v82, v82
    v_exp_f32_e64 v83, v83
    v_cvt_pk_bf16_f32 v100, v68, v69
    v_cvt_pk_bf16_f32 v101, v70, v71
    v_cvt_pk_bf16_f32 v102, v72, v73
    v_cvt_pk_bf16_f32 v103, v74, v75
    v_cvt_pk_bf16_f32 v104, v76, v77
    v_cvt_pk_bf16_f32 v105, v78, v79
    v_cvt_pk_bf16_f32 v106, v80, v81
    v_cvt_pk_bf16_f32 v107, v82, v83
    v_mfma_f32_32x32x16_bf16 v[68:83], v[12:15], v[16:19], 0
    v_exp_f32 v84, v84
    v_exp_f32 v85, v85
    v_exp_f32 v86, v86
    v_exp_f32 v87, v87
    v_exp_f32 v88, v88
    v_mfma_f32_32x32x16_bf16 v[24:39], v[44:47], v[100:103], v[24:39]
    v_exp_f32 v89, v89
    v_exp_f32 v90, v90
    v_exp_f32 v91, v91
    v_exp_f32 v92, v92
    v_exp_f32 v93, v93
    v_mfma_f32_32x32x16_bf16 v[24:39], v[48:51], v[104:107], v[24:39]
    v_exp_f32 v94, v94
    s_cmp_eq_u32 s40, 3
    s_cbranch_scc1 z_17
z_17_b:
    s_waitcnt vmcnt(1)
    ds_read_b128 v[44:47], v20
    ds_read_b128 v[48:51], v20 offset:256
    ds_read_b128 v[12:15], v120 offset:2048
    v_exp_f32 v95, v95
    v_exp_f32 v96, v96
    v_exp_f32 v97, v97
    v_exp_f32 v98, v98
    v_exp_f32_e64 v99, v99
    v_cvt_pk_bf16_f32 v108, v84, v85
    v_cvt_pk_bf16_f32 v109, v86, v87
    v_cvt_pk_bf16_f32 v110, v88, v89
    v_cvt_pk_bf16_f32 v111, v90, v91
    v_cvt_pk_bf16_f32 v112, v92, v93
    v_cvt_pk_bf16_f32 v113, v94, v95
    v_cvt_pk_bf16_f32 v114, v96, v97
    v_cvt_pk_bf16_f32 v115, v98, v99
    v_exp_f32 v68, v68
    v_exp_f32 v69, v69
    v_exp_f32 v70, v70
    v_exp_f32 v71, v71
    s_waitcnt lgkmcnt(0)
    v_mfma_f32_32x32x16_bf16 v[84:99], v[12:15], v[8:11], 0
    v_exp_f32 v72, v72
    v_exp_f32 v73, v73
    v_exp_f32 v74, v74
    v_exp_f32 v75, v75
    v_exp_f32 v76, v76
    v_mfma_f32_32x32x16_bf16 v[52:67], v[44:47], v[108:111], v[52:67]
    v_exp_f32 v77, v77
    v_exp_f32 v78, v78
    v_exp_f32 v79, v79
    v_exp_f32 v80, v80
    v_exp_f32 v81, v81
    v_mfma_f32_32x32x16_bf16 v[52:67], v[48:51], v[112:115], v[52:67]
    v_exp_f32 v82, v82
    v_exp_f32_e64 v83, v83
    v_cvt_pk_bf16_f32 v100, v68, v69
    v_cvt_pk_bf16_f32 v101, v70, v71
    v_cvt_pk_bf16_f32 v102, v72, v73
    v_cvt_pk_bf16_f32 v103, v74, v75
    v_cvt_pk_bf16_f32 v104, v76, v77
    v_cvt_pk_bf16_f32 v105, v78, v79
    v_cvt_pk_bf16_f32 v106, v80, v81
    v_cvt_pk_bf16_f32 v107, v82, v83
    v_bfi_b32 v100, v40, 0, v100
    v_bfi_b32 v101, v41, 0, v101
    v_bfi_b32 v102, v42, 0, v102
    v_bfi_b32 v103, v43, 0, v103
    v_bfi_b32 v104, v116, 0, v104
    v_bfi_b32 v105, v117, 0, v105
    v_bfi_b32 v106, v118, 0, v106
    v_bfi_b32 v107, v119, 0, v107
    v_exp_f32 v84, v84
    v_exp_f32 v85, v85
    v_exp_f32 v86, v86
    v_exp_f32 v87, v87
    v_exp_f32 v88, v88
    v_mfma_f32_32x32x16_bf16 v[24:39], v[44:47], v[100:103], v[24:39]
    v_exp_f32 v89, v89
    v_exp_f32 v90, v90
    v_exp_f32 v91, v91
    v_exp_f32 v92, v92
    v_exp_f32 v93, v93
    v_mfma_f32_32x32x16_bf16 v[24:39], v[48:51], v[104:107], v[24:39]
    v_exp_f32 v94, v94
    s_waitcnt vmcnt(0)
    ds_read_b128 v[44:47], v21
    ds_read_b128 v[48:51], v21 offset:256
    v_exp_f32 v95, v95
    v_exp_f32 v96, v96
    v_exp_f32 v97, v97
    v_exp_f32 v98, v98
    v_exp_f32_e64 v99, v99
    v_cvt_pk_bf16_f32 v108, v84, v85
    v_cvt_pk_bf16_f32 v109, v86, v87
    v_cvt_pk_bf16_f32 v110, v88, v89
    v_cvt_pk_bf16_f32 v111, v90, v91
    v_cvt_pk_bf16_f32 v112, v92, v93
    v_cvt_pk_bf16_f32 v113, v94, v95
    v_cvt_pk_bf16_f32 v114, v96, v97
    v_cvt_pk_bf16_f32 v115, v98, v99
    v_bfi_b32 v108, v40, 0, v108
    v_bfi_b32 v109, v41, 0, v109
    v_bfi_b32 v110, v42, 0, v110
    v_bfi_b32 v111, v43, 0, v111
    v_bfi_b32 v112, v116, 0, v112
    v_bfi_b32 v113, v117, 0, v113
    v_bfi_b32 v114, v118, 0, v114
    v_bfi_b32 v115, v119, 0, v115
    s_waitcnt lgkmcnt(0)
    s_branch L_div_e
L_oa_r:
    v_lshrrev_b32 v6, 1, v3
    v_lshlrev_b32 v7, 4, v2
    v_lshl_add_u32 v7, v6, 8, v7
    v_and_b32_e64 v6, 1, v3
    v_lshl_add_u32 v7, v6, 3, v7
    buffer_load_dwordx2 v[88:89], v7, s[12:15], s85 offen offset:0 sc1
    buffer_load_dwordx2 v[90:91], v7, s[12:15], s85 offen offset:512 sc1
    buffer_load_dwordx2 v[92:93], v7, s[12:15], s85 offen offset:1024 sc1
    buffer_load_dwordx2 v[94:95], v7, s[12:15], s85 offen offset:1536 sc1
    v_bfe_u32 v5, v1, 3, 1
    v_bfe_u32 v6, v1, 4, 1
    v_lshl_or_b32 v5, v6, 1, v5
    v_xor_b32 v5, 0, v5
    v_lshlrev_b32 v5, 5, v5
    v_and_b32_e64 v6, 3, v1
    v_lshl_add_u32 v5, v6, 3, v5
    v_bfe_u32 v6, v1, 2, 2
    v_lshl_add_u32 v5, v6, 7, v5
    v_mul_u32_u24 v6, 1024, v3
    v_add_u32 v4, v5, v6
    v_xor_b32 v5, 32, v4
    v_xor_b32 v52, 64, v4
    v_xor_b32 v120, 96, v4
    s_add_u32 s48, s43, 2
    v_mov_b32 v6, s48
    s_cmp_lg_u32 s42, 0
    s_mov_b64 exec, 1
    s_waitcnt vmcnt(4)
    s_cbranch_scc0 sig_53_s
    buffer_store_dword v6, off, s[4:7], s47
sig_53:
    s_mov_b64 exec, -1
    v_lshrrev_b32 v6, 1, v3
    v_and_b32 v7, 1, v3
    v_lshlrev_b32_e64 v122, 4, v2
    v_lshl_add_u32 v6, v7, 1, v6
    v_lshl_add_u32 v122, v6, 8, v122
    v_lshrrev_b32 v6, 5, v1
    v_lshl_add_u32 v7, v6, 9, v0
    s_mov_b32 s56, s83
    ds_read_b64_tr_b16 v[56:57], v4 offset:0
    ds_read_b64_tr_b16 v[58:59], v4 offset:512
    ds_read_b64_tr_b16 v[60:61], v5 offset:0
    ds_read_b64_tr_b16 v[62:63], v5 offset:512
    ds_read_b64_tr_b16 v[64:65], v52 offset:0
    ds_read_b64_tr_b16 v[66:67], v52 offset:512
    ds_read_b64_tr_b16 v[68:69], v120 offset:0
    ds_read_b64_tr_b16 v[70:71], v120 offset:512
    ds_read_b64_tr_b16 v[72:73], v4 offset:4096
    ds_read_b64_tr_b16 v[74:75], v4 offset:4608
    ds_read_b64_tr_b16 v[76:77], v5 offset:4096
    ds_read_b64_tr_b16 v[78:79], v5 offset:4608
    ds_read_b64_tr_b16 v[80:81], v52 offset:4096
    ds_read_b64_tr_b16 v[82:83], v52 offset:4608
    ds_read_b64_tr_b16 v[84:85], v120 offset:4096
    ds_read_b64_tr_b16 v[86:87], v120 offset:4608
    ds_read_b64_tr_b16 a[0:1], v4 offset:8192
    ds_read_b64_tr_b16 a[2:3], v4 offset:8704
    ds_read_b64_tr_b16 a[4:5], v5 offset:8192
    ds_read_b64_tr_b16 a[6:7], v5 offset:8704
    ds_read_b64_tr_b16 a[8:9], v52 offset:8192
    ds_read_b64_tr_b16 a[10:11], v52 offset:8704
    ds_read_b64_tr_b16 a[12:13], v120 offset:8192
    ds_read_b64_tr_b16 a[14:15], v120 offset:8704
    ds_read_b64_tr_b16 a[16:17], v4 offset:12288
    ds_read_b64_tr_b16 a[18:19], v4 offset:12800
    ds_read_b64_tr_b16 a[20:21], v5 offset:12288
    ds_read_b64_tr_b16 a[22:23], v5 offset:12800
    ds_read_b64_tr_b16 a[24:25], v52 offset:12288
    ds_read_b64_tr_b16 a[26:27], v52 offset:12800
    ds_read_b64_tr_b16 a[28:29], v120 offset:12288
    ds_read_b64_tr_b16 a[30:31], v120 offset:12800
    ds_read_b64_tr_b16 a[32:33], v4 offset:16384
    ds_read_b64_tr_b16 a[34:35], v4 offset:16896
    ds_read_b64_tr_b16 a[36:37], v5 offset:16384
    ds_read_b64_tr_b16 a[38:39], v5 offset:16896
    ds_read_b64_tr_b16 a[40:41], v52 offset:16384
    ds_read_b64_tr_b16 a[42:43], v52 offset:16896
    ds_read_b64_tr_b16 a[44:45], v120 offset:16384
    ds_read_b64_tr_b16 a[46:47], v120 offset:16896
    s_mov_b32 exec_hi, 0
    buffer_load_dword v126, v124, s[4:7], 0 offen sc1
    s_mov_b32 exec_hi, -1
    ds_read_b64_tr_b16 a[48:49], v4 offset:20480
    ds_read_b64_tr_b16 a[50:51], v4 offset:20992
    ds_read_b64_tr_b16 a[52:53], v5 offset:20480
    ds_read_b64_tr_b16 a[54:55], v5 offset:20992
    ds_read_b64_tr_b16 a[56:57], v52 offset:20480
    ds_read_b64_tr_b16 a[58:59], v52 offset:20992
    ds_read_b64_tr_b16 a[60:61], v120 offset:20480
    ds_read_b64_tr_b16 a[62:63], v120 offset:20992
    ds_read_b64_tr_b16 a[64:65], v4 offset:24576
    ds_read_b64_tr_b16 a[66:67], v4 offset:25088
    ds_read_b64_tr_b16 a[68:69], v5 offset:24576
    ds_read_b64_tr_b16 a[70:71], v5 offset:25088
    ds_read_b64_tr_b16 a[72:73], v52 offset:24576
    ds_read_b64_tr_b16 a[74:75], v52 offset:25088
    ds_read_b64_tr_b16 a[76:77], v120 offset:24576
    ds_read_b64_tr_b16 a[78:79], v120 offset:25088
    ds_read_b64_tr_b16 a[80:81], v4 offset:28672
    ds_read_b64_tr_b16 a[82:83], v4 offset:29184
    ds_read_b64_tr_b16 a[84:85], v5 offset:28672
    ds_read_b64_tr_b16 a[86:87], v5 offset:29184
    ds_read_b64_tr_b16 a[88:89], v52 offset:28672
    ds_read_b64_tr_b16 a[90:91], v52 offset:29184
    ds_read_b64_tr_b16 a[92:93], v120 offset:28672
    ds_read_b64_tr_b16 a[94:95], v120 offset:29184
    ds_read_b64_tr_b16 a[96:97], v4 offset:32768
    ds_read_b64_tr_b16 a[98:99], v4 offset:33280
    ds_read_b64_tr_b16 a[100:101], v5 offset:32768
    ds_read_b64_tr_b16 a[102:103], v5 offset:33280
    ds_read_b64_tr_b16 a[104:105], v52 offset:32768
    ds_read_b64_tr_b16 a[106:107], v52 offset:33280
    ds_read_b64_tr_b16 a[108:109], v120 offset:32768
    ds_read_b64_tr_b16 a[110:111], v120 offset:33280
    s_waitcnt vmcnt(2)
    v_lshlrev_b32 v104, 16, v88
    v_and_b32 v105, 0xffff0000, v88
    v_lshlrev_b32 v106, 16, v89
    v_and_b32 v107, 0xffff0000, v89
    v_lshlrev_b32 v108, 16, v90
    v_and_b32 v109, 0xffff0000, v90
    v_lshlrev_b32 v110, 16, v91
    v_and_b32 v111, 0xffff0000, v91
    v_lshlrev_b32 v112, 16, v92
    v_and_b32 v113, 0xffff0000, v92
    v_lshlrev_b32 v114, 16, v93
    v_and_b32 v115, 0xffff0000, v93
    v_lshlrev_b32 v116, 16, v94
    v_and_b32 v117, 0xffff0000, v94
    v_lshlrev_b32 v118, 16, v95
    v_and_b32 v119, 0xffff0000, v95
    s_mov_b32 s50, 0xffffffff
    s_mov_b32 s51, 0x0
    s_add_i32 s48, s43, 2
    s_mov_b32 s49, s44
    s_mov_b64 exec, s[50:51]
poll_54:
    buffer_load_dword v127, v124, s[4:7], 0 offen sc1
    s_waitcnt vmcnt(1)
    v_subrev_u32 v126, s48, v126
    v_cmp_gt_u32 vcc, 16, v126
    s_nop 0
    s_cmp_eq_u64 vcc, s[50:51]
    s_nop 1
    s_cbranch_scc1 poll_54_ok
    buffer_load_dword v126, v124, s[4:7], 0 offen sc1
    s_waitcnt vmcnt(1)
    v_subrev_u32 v127, s48, v127
    v_cmp_gt_u32 vcc, 16, v127
    s_nop 0
    s_cmp_eq_u64 vcc, s[50:51]
    s_nop 1
    s_cbranch_scc1 poll_54_ok
    s_add_u32 s49, s49, 1
    s_cmp_lt_u32 s49, 2000000
    s_cbranch_scc1 poll_54
    s_mov_b32 s44, 2000000
poll_54_ok:
    s_mov_b64 exec, -1
    buffer_load_dwordx4 v[8:11], v7, s[4:7], s56 offen offset:0 sc1
    buffer_load_dwordx4 v[12:15], v7, s[4:7], s56 offen offset:2048 sc1
    s_xor_b32 s56, s83, 4096
    buffer_load_dwordx4 v[16:19], v7, s[4:7], s56 offen offset:0 sc1
    buffer_load_dwordx4 v[20:23], v7, s[4:7], s56 offen offset:2048 sc1
    s_xor_b32 s56, s83, 8192
    buffer_load_dwordx4 v[24:27], v7, s[4:7], s56 offen offset:0 sc1
    buffer_load_dwordx4 v[28:31], v7, s[4:7], s56 offen offset:2048 sc1
    ds_read_b64_tr_b16 a[112:113], v4 offset:36864
    ds_read_b64_tr_b16 a[114:115], v4 offset:37376
    ds_read_b64_tr_b16 a[116:117], v5 offset:36864
    ds_read_b64_tr_b16 a[118:119], v5 offset:37376
    ds_read_b64_tr_b16 a[120:121], v52 offset:36864
    ds_read_b64_tr_b16 a[122:123], v52 offset:37376
    ds_read_b64_tr_b16 a[124:125], v120 offset:36864
    ds_read_b64_tr_b16 a[126:127], v120 offset:37376
    ds_read_b64_tr_b16 a[128:129], v4 offset:40960
    ds_read_b64_tr_b16 a[130:131], v4 offset:41472
    ds_read_b64_tr_b16 a[132:133], v5 offset:40960
    ds_read_b64_tr_b16 a[134:135], v5 offset:41472
    ds_read_b64_tr_b16 a[136:137], v52 offset:40960
    ds_read_b64_tr_b16 a[138:139], v52 offset:41472
    ds_read_b64_tr_b16 a[140:141], v120 offset:40960
    ds_read_b64_tr_b16 a[142:143], v120 offset:41472
    s_waitcnt vmcnt(5) lgkmcnt(15)
    v_mfma_f32_16x16x32_bf16 v[104:107], v[56:59], v[8:11], v[104:107]
    s_xor_b32 s56, s83, 12288
    buffer_load_dwordx4 v[32:35], v7, s[4:7], s56 offen offset:0 sc1
    ds_read_b64_tr_b16 v[88:89], v4 offset:45056
    v_mfma_f32_16x16x32_bf16 v[108:111], v[60:63], v[8:11], v[108:111]
    ds_read_b64_tr_b16 v[90:91], v4 offset:45568
    ds_read_b64_tr_b16 v[92:93], v5 offset:45056
    v_mfma_f32_16x16x32_bf16 v[112:115], v[64:67], v[8:11], v[112:115]
    ds_read_b64_tr_b16 v[94:95], v5 offset:45568
    ds_read_b64_tr_b16 v[96:97], v52 offset:45056
    ds_read_b64_tr_b16 v[98:99], v52 offset:45568
    v_mfma_f32_16x16x32_bf16 v[116:119], v[68:71], v[8:11], v[116:119]
    ds_read_b64_tr_b16 v[100:101], v120 offset:45056
    ds_read_b64_tr_b16 v[102:103], v120 offset:45568
    s_waitcnt vmcnt(5) lgkmcnt(15)
    v_mfma_f32_16x16x32_bf16 v[104:107], v[72:75], v[12:15], v[104:107]
    buffer_load_dwordx4 v[36:39], v7, s[4:7], s56 offen offset:2048 sc1
    ds_read_b64_tr_b16 v[56:57], v4 offset:49152
    ds_read_b64_tr_b16 v[58:59], v4 offset:49664
    v_mfma_f32_16x16x32_bf16 v[108:111], v[76:79], v[12:15], v[108:111]
    ds_read_b64_tr_b16 v[60:61], v5 offset:49152
    ds_read_b64_tr_b16 v[62:63], v5 offset:49664
    v_mfma_f32_16x16x32_bf16 v[112:115], v[80:83], v[12:15], v[112:115]
    ds_read_b64_tr_b16 v[64:65], v52 offset:49152
    ds_read_b64_tr_b16 v[66:67], v52 offset:49664
    v_mfma_f32_16x16x32_bf16 v[116:119], v[84:87], v[12:15], v[116:119]
    ds_read_b64_tr_b16 v[68:69], v120 offset:49152
    ds_read_b64_tr_b16 v[70:71], v120 offset:49664
    s_waitcnt vmcnt(5) lgkmcnt(15)
    v_mfma_f32_16x16x32_bf16 v[104:107], a[0:3], v[16:19], v[104:107]
    s_xor_b32 s56, s83, 16384
    buffer_load_dwordx4 v[40:43], v7, s[4:7], s56 offen offset:0 sc1
    ds_read_b64_tr_b16 v[72:73], v4 offset:53248
    v_mfma_f32_16x16x32_bf16 v[108:111], a[4:7], v[16:19], v[108:111]
    ds_read_b64_tr_b16 v[74:75], v4 offset:53760
    ds_read_b64_tr_b16 v[76:77], v5 offset:53248
    v_mfma_f32_16x16x32_bf16 v[112:115], a[8:11], v[16:19], v[112:115]
    ds_read_b64_tr_b16 v[78:79], v5 offset:53760
    ds_read_b64_tr_b16 v[80:81], v52 offset:53248
    ds_read_b64_tr_b16 v[82:83], v52 offset:53760
    v_mfma_f32_16x16x32_bf16 v[116:119], a[12:15], v[16:19], v[116:119]
    ds_read_b64_tr_b16 v[84:85], v120 offset:53248
    ds_read_b64_tr_b16 v[86:87], v120 offset:53760
    s_waitcnt vmcnt(5) lgkmcnt(15)
    v_mfma_f32_16x16x32_bf16 v[104:107], a[16:19], v[20:23], v[104:107]
    buffer_load_dwordx4 v[44:47], v7, s[4:7], s56 offen offset:2048 sc1
    ds_read_b64_tr_b16 a[0:1], v4 offset:57344
    ds_read_b64_tr_b16 a[2:3], v4 offset:57856
    v_mfma_f32_16x16x32_bf16 v[108:111], a[20:23], v[20:23], v[108:111]
    ds_read_b64_tr_b16 a[4:5], v5 offset:57344
    ds_read_b64_tr_b16 a[6:7], v5 offset:57856
    v_mfma_f32_16x16x32_bf16 v[112:115], a[24:27], v[20:23], v[112:115]
    ds_read_b64_tr_b16 a[8:9], v52 offset:57344
    ds_read_b64_tr_b16 a[10:11], v52 offset:57856
    v_mfma_f32_16x16x32_bf16 v[116:119], a[28:31], v[20:23], v[116:119]
    ds_read_b64_tr_b16 a[12:13], v120 offset:57344
    ds_read_b64_tr_b16 a[14:15], v120 offset:57856
    s_waitcnt vmcnt(5) lgkmcnt(15)
    v_mfma_f32_16x16x32_bf16 v[104:107], a[32:35], v[24:27], v[104:107]
    s_xor_b32 s56, s83, 20480
    buffer_load_dwordx4 v[48:51], v7, s[4:7], s56 offen offset:0 sc1
    ds_read_b64_tr_b16 a[16:17], v4 offset:61440
    v_mfma_f32_16x16x32_bf16 v[108:111], a[36:39], v[24:27], v[108:111]
    ds_read_b64_tr_b16 a[18:19], v4 offset:61952
    ds_read_b64_tr_b16 a[20:21], v5 offset:61440
    v_mfma_f32_16x16x32_bf16 v[112:115], a[40:43], v[24:27], v[112:115]
    ds_read_b64_tr_b16 a[22:23], v5 offset:61952
    ds_read_b64_tr_b16 a[24:25], v52 offset:61440
    ds_read_b64_tr_b16 a[26:27], v52 offset:61952
    v_mfma_f32_16x16x32_bf16 v[116:119], a[44:47], v[24:27], v[116:119]
    ds_read_b64_tr_b16 a[28:29], v120 offset:61440
    ds_read_b64_tr_b16 a[30:31], v120 offset:61952
    s_waitcnt vmcnt(5) lgkmcnt(15)
    v_mfma_f32_16x16x32_bf16 v[104:107], a[48:51], v[28:31], v[104:107]
    buffer_load_dwordx4 v[8:11], v7, s[4:7], s56 offen offset:2048 sc1
    v_mfma_f32_16x16x32_bf16 v[108:111], a[52:55], v[28:31], v[108:111]
    v_mfma_f32_16x16x32_bf16 v[112:115], a[56:59], v[28:31], v[112:115]
    v_mfma_f32_16x16x32_bf16 v[116:119], a[60:63], v[28:31], v[116:119]
    s_waitcnt vmcnt(5) lgkmcnt(15)
    v_mfma_f32_16x16x32_bf16 v[104:107], a[64:67], v[32:35], v[104:107]
    s_xor_b32 s56, s83, 24576
    v_mfma_f32_16x16x32_bf16 v[108:111], a[68:71], v[32:35], v[108:111]
    v_mfma_f32_16x16x32_bf16 v[112:115], a[72:75], v[32:35], v[112:115]
    buffer_load_dwordx4 v[12:15], v7, s[4:7], s56 offen offset:0 sc1
    v_mfma_f32_16x16x32_bf16 v[116:119], a[76:79], v[32:35], v[116:119]
    s_waitcnt vmcnt(5) lgkmcnt(15)
    v_mfma_f32_16x16x32_bf16 v[104:107], a[80:83], v[36:39], v[104:107]
    buffer_load_dwordx4 v[16:19], v7, s[4:7], s56 offen offset:2048 sc1
    v_mfma_f32_16x16x32_bf16 v[108:111], a[84:87], v[36:39], v[108:111]
    v_mfma_f32_16x16x32_bf16 v[112:115], a[88:91], v[36:39], v[112:115]
    v_mfma_f32_16x16x32_bf16 v[116:119], a[92:95], v[36:39], v[116:119]
    s_waitcnt vmcnt(5) lgkmcnt(15)
    v_mfma_f32_16x16x32_bf16 v[104:107], a[96:99], v[40:43], v[104:107]
    s_xor_b32 s56, s83, 28672
    v_mfma_f32_16x16x32_bf16 v[108:111], a[100:103], v[40:43], v[108:111]
    v_mfma_f32_16x16x32_bf16 v[112:115], a[104:107], v[40:43], v[112:115]
    buffer_load_dwordx4 v[20:23], v7, s[4:7], s56 offen offset:0 sc1
    v_mfma_f32_16x16x32_bf16 v[116:119], a[108:111], v[40:43], v[116:119]
    s_waitcnt vmcnt(5) lgkmcnt(15)
    v_mfma_f32_16x16x32_bf16 v[104:107], a[112:115], v[44:47], v[104:107]
    buffer_load_dwordx4 v[24:27], v7, s[4:7], s56 offen offset:2048 sc1
    v_mfma_f32_16x16x32_bf16 v[108:111], a[116:119], v[44:47], v[108:111]
    v_mfma_f32_16x16x32_bf16 v[112:115], a[120:123], v[44:47], v[112:115]
    v_mfma_f32_16x16x32_bf16 v[116:119], a[124:127], v[44:47], v[116:119]
    s_waitcnt vmcnt(5) lgkmcnt(15)
    v_mfma_f32_16x16x32_bf16 v[104:107], a[128:131], v[48:51], v[104:107]
    v_mfma_f32_16x16x32_bf16 v[108:111], a[132:135], v[48:51], v[108:111]
    v_mfma_f32_16x16x32_bf16 v[112:115], a[136:139], v[48:51], v[112:115]
    v_mfma_f32_16x16x32_bf16 v[116:119], a[140:143], v[48:51], v[116:119]
    s_waitcnt vmcnt(4) lgkmcnt(15)
    v_mfma_f32_16x16x32_bf16 v[104:107], v[88:91], v[8:11], v[104:107]
    v_mfma_f32_16x16x32_bf16 v[108:111], v[92:95], v[8:11], v[108:111]
    v_mfma_f32_16x16x32_bf16 v[112:115], v[96:99], v[8:11], v[112:115]
    v_mfma_f32_16x16x32_bf16 v[116:119], v[100:103], v[8:11], v[116:119]
    s_waitcnt vmcnt(3) lgkmcnt(15)
    v_mfma_f32_16x16x32_bf16 v[104:107], v[56:59], v[12:15], v[104:107]
    v_mfma_f32_16x16x32_bf16 v[108:111], v[60:63], v[12:15], v[108:111]
    v_mfma_f32_16x16x32_bf16 v[112:115], v[64:67], v[12:15], v[112:115]
    v_mfma_f32_16x16x32_bf16 v[116:119], v[68:71], v[12:15], v[116:119]
    s_waitcnt vmcnt(2) lgkmcnt(15)
    v_mfma_f32_16x16x32_bf16 v[104:107], v[72:75], v[16:19], v[104:107]
    v_mfma_f32_16x16x32_bf16 v[108:111], v[76:79], v[16:19], v[108:111]
    s_waitcnt vmcnt(1) lgkmcnt(8)
    v_mfma_f32_16x16x32_bf16 v[104:107], a[0:3], v[20:23], v[104:107]
    v_mfma_f32_16x16x32_bf16 v[108:111], a[4:7], v[20:23], v[108:111]
    s_waitcnt vmcnt(0) lgkmcnt(0)
    v_mfma_f32_16x16x32_bf16 v[104:107], a[16:19], v[24:27], v[104:107]
    v_mfma_f32_16x16x32_bf16 v[108:111], a[20:23], v[24:27], v[108:111]
    v_mfma_f32_16x16x32_bf16 v[112:115], v[80:83], v[16:19], v[112:115]
    v_mfma_f32_16x16x32_bf16 v[116:119], v[84:87], v[16:19], v[116:119]
    s_nop 4
    v_cvt_pk_bf16_f32 v40, v104, v105
    v_cvt_pk_bf16_f32 v41, v106, v107
    v_mfma_f32_16x16x32_bf16 v[112:115], a[8:11], v[20:23], v[112:115]
    v_cvt_pk_bf16_f32 v42, v108, v109
    v_mfma_f32_16x16x32_bf16 v[116:119], a[12:15], v[20:23], v[116:119]
    v_cvt_pk_bf16_f32 v43, v110, v111
    v_permlane16_swap_b32 v40, v42
    v_mfma_f32_16x16x32_bf16 v[112:115], a[24:27], v[24:27], v[112:115]
    v_permlane16_swap_b32 v41, v43
    v_mfma_f32_16x16x32_bf16 v[116:119], a[28:31], v[24:27], v[116:119]
    s_cmp_lg_u32 s42, 0
    s_cbranch_scc0 st_55_s
    buffer_store_dwordx4 v[40:43], v122, s[12:15], s85 offen offset:0
st_55:
    v_add_u32 v48, s78, v122
    s_nop 1
    v_cvt_pk_bf16_f32 v60, v112, v113
    v_cvt_pk_bf16_f32 v61, v114, v115
    v_cvt_pk_bf16_f32 v62, v116, v117
    v_cvt_pk_bf16_f32 v63, v118, v119
    s_nop 0
    v_permlane16_swap_b32 v60, v62
    v_permlane16_swap_b32 v61, v63
    s_cmp_lg_u32 s42, 0
    s_cbranch_scc0 st_56_s
    buffer_store_dwordx4 v[60:63], v122, s[12:15], s85 offen offset:1024
st_56:
    ds_write_b128 v48, v[40:43]
    ds_write_b128 v48, v[60:63] offset:1024
    v_pk_mul_f32 v[46:47], v[104:105], v[104:105]
    v_pk_add_f32 v[44:45], v[104:105], v[106:107]
    v_pk_fma_f32 v[46:47], v[106:107], v[106:107], v[46:47]
    v_pk_fma_f32 v[46:47], v[108:109], v[108:109], v[46:47]
    v_pk_add_f32 v[44:45], v[44:45], v[108:109]
    v_pk_fma_f32 v[46:47], v[110:111], v[110:111], v[46:47]
    v_pk_add_f32 v[44:45], v[44:45], v[110:111]
    v_pk_fma_f32 v[46:47], v[112:113], v[112:113], v[46:47]
    v_pk_add_f32 v[44:45], v[44:45], v[112:113]
    v_pk_fma_f32 v[46:47], v[114:115], v[114:115], v[46:47]
    v_pk_add_f32 v[44:45], v[44:45], v[114:115]
    v_pk_fma_f32 v[46:47], v[116:117], v[116:117], v[46:47]
    v_pk_add_f32 v[44:45], v[44:45], v[116:117]
    v_pk_fma_f32 v[46:47], v[118:119], v[118:119], v[46:47]
    v_pk_add_f32 v[44:45], v[44:45], v[118:119]
    v_add_f32 v112, v44, v45
    v_add_f32 v113, v46, v47
    v_lshlrev_b32 v114, 6, v2
    s_nop 0
    v_permlane32_swap_b32 v112, v113
    v_add_f32 v112, v112, v113
    v_mov_b32 v113, v112
    s_nop 1
    v_permlane16_swap_b32 v112, v113
    v_add_f32 v112, v112, v113
    v_mov_b32 v113, v112
    s_nop 1
    v_permlane32_swap_b32 v112, v113
    s_add_u32 s48, s43, 3
    v_mov_b32 v6, s48
    s_cmp_lg_u32 s42, 0
    s_mov_b64 exec, 1
    s_waitcnt vmcnt(0)
    s_cbranch_scc0 sig_57_s
    buffer_store_dword v6, off, s[4:7], s47
sig_57:
    s_mov_b64 exec, -1
    s_cmp_lg_u32 s42, 0
    s_cbranch_scc0 st_58_s
    s_mov_b64 exec, 0xffff
    buffer_store_dwordx2 v[112:113], v114, s[4:7], s86 offen
    s_mov_b64 exec, -1
st_58:
    s_cmp_eq_u32 s38, 3
    s_cselect_b32 s54, s3, 0
    s_cselect_b32 s48, 0, s3
    s_lshr_b32 s54, s54, 1
    s_cmp_lt_u32 s48, 2
    s_cbranch_scc1 op_52_nohalo
    s_cmp_lg_u32 s42, 0
    s_cbranch_scc0 st_59_s
    s_mov_b32 exec_lo, 0xff00ff00
    s_mov_b32 exec_hi, 0xff00ff00
    buffer_store_dwordx4 v[40:43], v122, s[4:7], s87 offen
    buffer_store_dwordx4 v[60:63], v122, s[4:7], s87 offen offset:1024
    s_mov_b64 exec, 0xff00
    buffer_store_dwordx2 v[112:113], v114, s[4:7], s88 offen
    s_mov_b64 exec, -1
st_59:
op_52_nohalo:
    v_add_u32 v120, 131072, v0
    v_lshlrev_b32 v121, 6, v2
    v_lshl_add_u32 v121, v3, 4, v121
    s_cmp_eq_u32 s40, 0
    s_cselect_b32 s62, 2147418112, s89
    s_cselect_b32 s63, 2147418112, s90
    s_add_u32 m0, s78, 2048
    s_xor_b32 s58, s85, 2048
    s_lshl_b32 s50, 0x11111111, s3
    s_mov_b32 s51, 0
    s_waitcnt lgkmcnt(0)
    s_barrier
    ds_read_b128 v[64:67], v120 offset:0
    ds_read_b128 v[68:71], v120 offset:6144
    ds_read_b128 v[72:75], v120 offset:12288
    ds_read_b128 v[76:79], v120 offset:18432
    s_add_i32 s48, s43, 3
    s_mov_b32 s49, s44
    s_mov_b64 exec, s[50:51]
    buffer_load_dword v126, v124, s[4:7], 0 offen sc1
    s_nop 7
    s_nop 7
poll_60:
    buffer_load_dword v127, v124, s[4:7], 0 offen sc1
    s_waitcnt vmcnt(1)
    v_subrev_u32 v126, s48, v126
    v_cmp_gt_u32 vcc, 16, v126
    s_nop 0
    s_cmp_eq_u64 vcc, s[50:51]
    s_nop 1
    s_cbranch_scc1 poll_60_ok
    buffer_load_dword v126, v124, s[4:7], 0 offen sc1
    s_waitcnt vmcnt(1)
    v_subrev_u32 v127, s48, v127
    v_cmp_gt_u32 vcc, 16, v127
    s_nop 0
    s_cmp_eq_u64 vcc, s[50:51]
    s_nop 1
    s_cbranch_scc1 poll_60_ok
    s_add_u32 s49, s49, 1
    s_cmp_lt_u32 s49, 2000000
    s_cbranch_scc1 poll_60
    s_mov_b32 s44, 2000000
poll_60_ok:
    s_mov_b64 exec, -1
    buffer_load_dwordx4 v0, s[12:15], s58 offen sc1 lds
    buffer_load_dwordx4 v0, s[12:15], s58 offen offset:1024 sc1 lds
    s_add_u32 s48, s43, 4
    v_mov_b32 v6, s48
    s_cmp_lg_u32 s42, 0
    s_mov_b64 exec, 1
    s_cbranch_scc0 sig_61_s
    buffer_store_dword v6, off, s[4:7], s47
sig_61:
    s_mov_b64 exec, -1
    s_cmp_eq_u32 s54, 0
    s_cselect_b32 s52, 2147418112, s87
    s_cselect_b32 s53, 2147418112, s88
    s_waitcnt lgkmcnt(0)
    v_mfma_f32_16x16x32_bf16 v[24:27], v[128:131], v[64:67], 0
    s_add_u32 m0, s78, 4096
    s_xor_b32 s58, s85, 4096
    v_mfma_f32_16x16x32_bf16 v[8:11], a[192:195], v[64:67], 0
    buffer_load_dwordx4 v0, s[12:15], s58 offen sc1 lds
    v_mfma_f32_16x16x32_bf16 v[28:31], v[128:131], v[68:71], 0
    ds_read_b128 v[80:83], v120 offset:1024
    s_mul_i32 s59, s3, 192
    v_mfma_f32_16x16x32_bf16 v[12:15], a[192:195], v[68:71], 0
    buffer_load_dwordx4 v0, s[12:15], s58 offen offset:1024 sc1 lds
    v_mfma_f32_16x16x32_bf16 v[32:35], v[128:131], v[72:75], 0
    ds_read_b128 v[84:87], v120 offset:7168
    s_add_u32 s59, s59, 157440
    v_mfma_f32_16x16x32_bf16 v[16:19], a[192:195], v[72:75], 0
    ds_read_b128 v[88:91], v120 offset:13312
    v_lshl_add_u32 v6, v3, 4, s59
    v_mfma_f32_16x16x32_bf16 v[36:39], v[128:131], v[76:79], 0
    s_mov_b32 exec_lo, 0xff00ff00
    s_mov_b32 exec_hi, 0xff00ff00
    buffer_store_dwordx4 v[40:43], v122, s[4:7], s52 offen sc1
    s_mov_b64 exec, -1
    v_mfma_f32_16x16x32_bf16 v[20:23], a[192:195], v[76:79], 0
    ds_read_b128 v[92:95], v120 offset:19456
    v_mfma_f32_16x16x32_bf16 v[44:47], v[64:67], v[192:195], 0
    s_mov_b32 exec_lo, 0xff00ff00
    s_mov_b32 exec_hi, 0xff00ff00
    buffer_store_dwordx4 v[60:63], v122, s[4:7], s52 offen offset:1024 sc1
    s_mov_b64 exec, -1
    v_mfma_f32_16x16x32_bf16 v[48:51], v[68:71], v[192:195], 0
    v_mfma_f32_16x16x32_bf16 v[52:55], v[72:75], v[192:195], 0
    s_mov_b64 exec, 0xff00
    buffer_store_dwordx2 v[112:113], v114, s[4:7], s53 offen sc1
    s_mov_b64 exec, -1
    v_mfma_f32_16x16x32_bf16 v[56:59], v[76:79], v[192:195], 0
    s_waitcnt lgkmcnt(0)
    v_mfma_f32_16x16x32_bf16 v[24:27], v[132:135], v[80:83], v[24:27]
    v_lshl_add_u32 v7, v2, 2, s59
    v_mfma_f32_16x16x32_bf16 v[8:11], a[196:199], v[80:83], v[8:11]
    ds_read_b128 v[100:103], v6
    v_mfma_f32_16x16x32_bf16 v[28:31], v[132:135], v[84:87], v[28:31]
    ds_read_b128 v[104:107], v6 offset:64
    v_mfma_f32_16x16x32_bf16 v[12:15], a[196:199], v[84:87], v[12:15]
    ds_read_b32 v108, v7 offset:128
    v_mfma_f32_16x16x32_bf16 v[32:35], v[132:135], v[88:91], v[32:35]
    s_add_u32 s57, s43, 4
    v_mfma_f32_16x16x32_bf16 v[16:19], a[196:199], v[88:91], v[16:19]
    s_waitcnt vmcnt(6)
    s_barrier
    v_mfma_f32_16x16x32_bf16 v[36:39], v[132:135], v[92:95], v[36:39]
    ds_read_b128 v[64:67], v120 offset:2048
    v_mfma_f32_16x16x32_bf16 v[20:23], a[196:199], v[92:95], v[20:23]
    ds_read_b128 v[68:71], v120 offset:8192
    v_mfma_f32_16x16x32_bf16 v[44:47], v[80:83], v[196:199], v[44:47]
    ds_read_b128 v[72:75], v120 offset:14336
    s_add_u32 m0, s78, 0
    v_mfma_f32_16x16x32_bf16 v[48:51], v[84:87], v[196:199], v[48:51]
    ds_read_b128 v[76:79], v120 offset:20480
    s_xor_b32 s58, s85, 6144
    v_mfma_f32_16x16x32_bf16 v[52:55], v[88:91], v[196:199], v[52:55]
    buffer_load_dwordx4 v0, s[12:15], s58 offen sc1 lds
    v_mfma_f32_16x16x32_bf16 v[56:59], v[92:95], v[196:199], v[56:59]
    buffer_load_dwordx4 v0, s[12:15], s58 offen offset:1024 sc1 lds
    s_waitcnt lgkmcnt(0)
    v_mfma_f32_16x16x32_bf16 v[24:27], v[136:139], v[64:67], v[24:27]
    ds_read_b128 v[80:83], v120 offset:3072
    v_mfma_f32_16x16x32_bf16 v[8:11], a[200:203], v[64:67], v[8:11]
    ds_read_b128 v[84:87], v120 offset:9216
    v_mfma_f32_16x16x32_bf16 v[28:31], v[136:139], v[68:71], v[28:31]
    ds_read_b128 v[88:91], v120 offset:15360
    v_mfma_f32_16x16x32_bf16 v[12:15], a[200:203], v[68:71], v[12:15]
    ds_read_b128 v[92:95], v120 offset:21504
    v_mfma_f32_16x16x32_bf16 v[32:35], v[136:139], v[72:75], v[32:35]
    s_lshl_b32 s60, 0x11111111, s3
    v_mfma_f32_16x16x32_bf16 v[16:19], a[200:203], v[72:75], v[16:19]
    v_mfma_f32_16x16x32_bf16 v[36:39], v[136:139], v[76:79], v[36:39]
    s_mov_b32 exec_hi, 0
    buffer_load_dword v126, v124, s[4:7], 0 offen sc1
    s_mov_b32 exec_hi, -1
    v_mfma_f32_16x16x32_bf16 v[20:23], a[200:203], v[76:79], v[20:23]
    v_mfma_f32_16x16x32_bf16 v[44:47], v[64:67], v[200:203], v[44:47]
    v_mfma_f32_16x16x32_bf16 v[48:51], v[68:71], v[200:203], v[48:51]
    v_mfma_f32_16x16x32_bf16 v[52:55], v[72:75], v[200:203], v[52:55]
    v_mfma_f32_16x16x32_bf16 v[56:59], v[76:79], v[200:203], v[56:59]
    s_waitcnt vmcnt(6) lgkmcnt(0)
    s_barrier
    v_mfma_f32_16x16x32_bf16 v[24:27], v[140:143], v[80:83], v[24:27]
    ds_read_b128 v[64:67], v120 offset:4096
    v_mfma_f32_16x16x32_bf16 v[8:11], a[204:207], v[80:83], v[8:11]
    ds_read_b128 v[68:71], v120 offset:10240
    v_mfma_f32_16x16x32_bf16 v[28:31], v[140:143], v[84:87], v[28:31]
    s_add_u32 m0, s78, 2048
    s_xor_b32 s58, s85, 8192
    v_mfma_f32_16x16x32_bf16 v[12:15], a[204:207], v[84:87], v[12:15]
    buffer_load_dwordx4 v0, s[12:15], s58 offen sc1 lds
    v_mfma_f32_16x16x32_bf16 v[32:35], v[140:143], v[88:91], v[32:35]
    ds_read_b128 v[72:75], v120 offset:16384
    v_mfma_f32_16x16x32_bf16 v[16:19], a[204:207], v[88:91], v[16:19]
    ds_read_b128 v[76:79], v120 offset:22528
    v_mfma_f32_16x16x32_bf16 v[36:39], v[140:143], v[92:95], v[36:39]
    v_mfma_f32_16x16x32_bf16 v[20:23], a[204:207], v[92:95], v[20:23]
    v_mfma_f32_16x16x32_bf16 v[44:47], v[80:83], v[204:207], v[44:47]
    v_mfma_f32_16x16x32_bf16 v[48:51], v[84:87], v[204:207], v[48:51]
    buffer_load_dwordx4 v0, s[12:15], s58 offen offset:1024 sc1 lds
    v_mfma_f32_16x16x32_bf16 v[52:55], v[88:91], v[204:207], v[52:55]
    v_mfma_f32_16x16x32_bf16 v[56:59], v[92:95], v[204:207], v[56:59]
    s_waitcnt lgkmcnt(0)
    v_mfma_f32_16x16x32_bf16 v[24:27], v[144:147], v[64:67], v[24:27]
    ds_read_b128 v[80:83], v120 offset:5120
    v_mfma_f32_16x16x32_bf16 v[8:11], a[208:211], v[64:67], v[8:11]
    ds_read_b128 v[84:87], v120 offset:11264
    v_mfma_f32_16x16x32_bf16 v[28:31], v[144:147], v[68:71], v[28:31]
    ds_read_b128 v[88:91], v120 offset:17408
    v_mfma_f32_16x16x32_bf16 v[12:15], a[208:211], v[68:71], v[12:15]
    ds_read_b128 v[92:95], v120 offset:23552
    v_mfma_f32_16x16x32_bf16 v[32:35], v[144:147], v[72:75], v[32:35]
    s_waitcnt vmcnt(2)
    v_subrev_u32 v126, s57, v126
    v_cmp_le_u32 vcc, 16, v126
    s_nop 0
    s_and_b32 s48, vcc_lo, s60
    s_cbranch_scc1 sq_62_c
sq_62:
    buffer_load_dwordx4 v[40:43], v121, s[4:7], s77 offen sc1
    v_mfma_f32_16x16x32_bf16 v[16:19], a[208:211], v[72:75], v[16:19]
    s_cmp_eq_u32 s54, 0
    s_cselect_b32 s48, 2147418112, s47
    v_mfma_f32_16x16x32_bf16 v[36:39], v[144:147], v[76:79], v[36:39]
    v_mov_b32 v6, s57
    v_mfma_f32_16x16x32_bf16 v[20:23], a[208:211], v[76:79], v[20:23]
    s_mov_b64 exec, 1
    buffer_store_dword v6, off, s[4:7], s48 offset:128 sc1
    s_mov_b64 exec, -1
    v_mfma_f32_16x16x32_bf16 v[44:47], v[64:67], v[208:211], v[44:47]
    v_mfma_f32_16x16x32_bf16 v[48:51], v[68:71], v[208:211], v[48:51]
    v_mfma_f32_16x16x32_bf16 v[52:55], v[72:75], v[208:211], v[52:55]
    v_mfma_f32_16x16x32_bf16 v[56:59], v[76:79], v[208:211], v[56:59]
    s_waitcnt vmcnt(5) lgkmcnt(0)
    s_barrier
    v_mfma_f32_16x16x32_bf16 v[24:27], v[148:151], v[80:83], v[24:27]
    ds_read_b128 v[64:67], v120 offset:0
    v_mfma_f32_16x16x32_bf16 v[8:11], a[212:215], v[80:83], v[8:11]
    ds_read_b128 v[68:71], v120 offset:6144
    v_mfma_f32_16x16x32_bf16 v[28:31], v[148:151], v[84:87], v[28:31]
    s_add_u32 m0, s78, 4096
    s_xor_b32 s58, s85, 10240
    v_mfma_f32_16x16x32_bf16 v[12:15], a[212:215], v[84:87], v[12:15]
    buffer_load_dwordx4 v0, s[12:15], s58 offen sc1 lds
    v_mfma_f32_16x16x32_bf16 v[32:35], v[148:151], v[88:91], v[32:35]
    ds_read_b128 v[72:75], v120 offset:12288
    v_mfma_f32_16x16x32_bf16 v[16:19], a[212:215], v[88:91], v[16:19]
    ds_read_b128 v[76:79], v120 offset:18432
    v_mfma_f32_16x16x32_bf16 v[36:39], v[148:151], v[92:95], v[36:39]
    v_mfma_f32_16x16x32_bf16 v[20:23], a[212:215], v[92:95], v[20:23]
    v_mfma_f32_16x16x32_bf16 v[44:47], v[80:83], v[212:215], v[44:47]
    v_mfma_f32_16x16x32_bf16 v[48:51], v[84:87], v[212:215], v[48:51]
    buffer_load_dwordx4 v0, s[12:15], s58 offen offset:1024 sc1 lds
    v_mfma_f32_16x16x32_bf16 v[52:55], v[88:91], v[212:215], v[52:55]
    v_mfma_f32_16x16x32_bf16 v[56:59], v[92:95], v[212:215], v[56:59]
    s_waitcnt lgkmcnt(0)
    v_mfma_f32_16x16x32_bf16 v[24:27], v[152:155], v[64:67], v[24:27]
    ds_read_b128 v[80:83], v120 offset:1024
    s_waitcnt vmcnt(3)
    v_mfma_f32_16x16x32_bf16 v[8:11], a[216:219], v[64:67], v[8:11]
    ds_read_b128 v[84:87], v120 offset:7168
    v_add_f32_e64 v112, v40, v42
    v_mfma_f32_16x16x32_bf16 v[28:31], v[152:155], v[68:71], v[28:31]
    ds_read_b128 v[88:91], v120 offset:13312
    v_add_f32_e64 v113, v41, v43
    v_mfma_f32_16x16x32_bf16 v[12:15], a[216:219], v[68:71], v[12:15]
    ds_read_b128 v[92:95], v120 offset:19456
    v_mfma_f32_16x16x32_bf16 v[32:35], v[152:155], v[72:75], v[32:35]
    v_permlane32_swap_b32 v112, v113
    v_mfma_f32_16x16x32_bf16 v[16:19], a[216:219], v[72:75], v[16:19]
    v_add_f32 v112, v112, v113
    v_mov_b32 v113, v112
    v_mfma_f32_16x16x32_bf16 v[36:39], v[152:155], v[76:79], v[36:39]
    s_nop 0
    v_permlane16_swap_b32 v112, v113
    v_mfma_f32_16x16x32_bf16 v[20:23], a[216:219], v[76:79], v[20:23]
    v_add_f32 v112, v112, v113
    v_mfma_f32_16x16x32_bf16 v[44:47], v[64:67], v[216:219], v[44:47]
    v_mfma_f32_16x16x32_bf16 v[48:51], v[68:71], v[216:219], v[48:51]
    v_mfma_f32_16x16x32_bf16 v[52:55], v[72:75], v[216:219], v[52:55]
    v_mfma_f32_16x16x32_bf16 v[56:59], v[76:79], v[216:219], v[56:59]
    s_waitcnt vmcnt(4) lgkmcnt(0)
    s_barrier
    v_mfma_f32_16x16x32_bf16 v[24:27], v[156:159], v[80:83], v[24:27]
    ds_read_b128 v[64:67], v120 offset:2048
    v_mov_b32_e64 v113, v112
    v_mfma_f32_16x16x32_bf16 v[8:11], a[220:223], v[80:83], v[8:11]
    ds_read_b128 v[68:71], v120 offset:8192
    v_mfma_f32_16x16x32_bf16 v[28:31], v[156:159], v[84:87], v[28:31]
    s_add_u32 m0, s78, 0
    s_xor_b32 s58, s85, 12288
    v_mfma_f32_16x16x32_bf16 v[12:15], a[220:223], v[84:87], v[12:15]
    buffer_load_dwordx4 v0, s[12:15], s58 offen sc1 lds
    v_mfma_f32_16x16x32_bf16 v[32:35], v[156:159], v[88:91], v[32:35]
    ds_read_b128 v[72:75], v120 offset:14336
    v_mfma_f32_16x16x32_bf16 v[16:19], a[220:223], v[88:91], v[16:19]
    ds_read_b128 v[76:79], v120 offset:20480
    v_mfma_f32_16x16x32_bf16 v[36:39], v[156:159], v[92:95], v[36:39]
    v_permlane32_swap_b32 v112, v113
    v_mfma_f32_16x16x32_bf16 v[20:23], a[220:223], v[92:95], v[20:23]
    v_mul_f32 v112, 0x3b000000, v112
    v_mul_f32 v113, 0x3b000000, v113
    v_mfma_f32_16x16x32_bf16 v[44:47], v[80:83], v[220:223], v[44:47]
    v_fma_f32 v113, -v112, v112, v113
    v_max_f32_e64 v113, 0, v113
    v_mfma_f32_16x16x32_bf16 v[48:51], v[84:87], v[220:223], v[48:51]
    buffer_load_dwordx4 v0, s[12:15], s58 offen offset:1024 sc1 lds
    v_mfma_f32_16x16x32_bf16 v[52:55], v[88:91], v[220:223], v[52:55]
    v_cvt_pk_bf16_f32 v6, v112, v113
    v_lshlrev_b32 v112, 16, v6
    v_mfma_f32_16x16x32_bf16 v[56:59], v[92:95], v[220:223], v[56:59]
    s_waitcnt lgkmcnt(0)
    v_mfma_f32_16x16x32_bf16 v[24:27], v[160:163], v[64:67], v[24:27]
    ds_read_b128 v[80:83], v120 offset:3072
    v_and_b32 v113, 0xffff0000, v6
    v_mfma_f32_16x16x32_bf16 v[8:11], a[224:227], v[64:67], v[8:11]
    ds_read_b128 v[84:87], v120 offset:9216
    v_add_f32 v113, 0x3727c5ac, v113
    v_mfma_f32_16x16x32_bf16 v[28:31], v[160:163], v[68:71], v[28:31]
    ds_read_b128 v[88:91], v120 offset:15360
    v_cvt_pk_bf16_f32 v6, v113, v113
    v_mfma_f32_16x16x32_bf16 v[12:15], a[224:227], v[68:71], v[12:15]
    ds_read_b128 v[92:95], v120 offset:21504
    v_and_b32 v113, 0xffff0000, v6
    v_mfma_f32_16x16x32_bf16 v[32:35], v[160:163], v[72:75], v[32:35]
    v_sqrt_f32_e64 v113, v113
    v_mfma_f32_16x16x32_bf16 v[16:19], a[224:227], v[72:75], v[16:19]
    v_cvt_pk_bf16_f32 v6, v113, v113
    v_and_b32 v113, 0xffff0000, v6
    v_mfma_f32_16x16x32_bf16 v[36:39], v[160:163], v[76:79], v[36:39]
    v_rcp_f32_e64 v113, v113
    v_mfma_f32_16x16x32_bf16 v[20:23], a[224:227], v[76:79], v[20:23]
    v_mfma_f32_16x16x32_bf16 v[44:47], v[64:67], v[224:227], v[44:47]
    v_mfma_f32_16x16x32_bf16 v[48:51], v[68:71], v[224:227], v[48:51]
    v_mfma_f32_16x16x32_bf16 v[52:55], v[72:75], v[224:227], v[52:55]
    v_mfma_f32_16x16x32_bf16 v[56:59], v[76:79], v[224:227], v[56:59]
    s_waitcnt vmcnt(2) lgkmcnt(0)
    s_barrier
    v_mfma_f32_16x16x32_bf16 v[24:27], v[164:167], v[80:83], v[24:27]
    ds_read_b128 v[64:67], v120 offset:4096
    s_lshl_b32 s59, s3, 7
    v_mfma_f32_16x16x32_bf16 v[8:11], a[228:231], v[80:83], v[8:11]
    s_add_u32 m0, s78, 2048
    s_xor_b32 s58, s85, 14336
    v_mfma_f32_16x16x32_bf16 v[28:31], v[164:167], v[84:87], v[28:31]
    buffer_load_dwordx4 v0, s[12:15], s58 offen sc1 lds
    v_mfma_f32_16x16x32_bf16 v[12:15], a[228:231], v[84:87], v[12:15]
    ds_read_b128 v[68:71], v120 offset:10240
    v_lshl_add_u32 v7, v2, 3, s59
    v_mfma_f32_16x16x32_bf16 v[32:35], v[164:167], v[88:91], v[32:35]
    ds_read_b128 v[72:75], v120 offset:16384
    v_add_u32 v6, 155648, v7
    v_mfma_f32_16x16x32_bf16 v[16:19], a[228:231], v[88:91], v[16:19]
    ds_read_b128 v[76:79], v120 offset:22528
    ds_write_b64 v6, v[112:113]
    v_mfma_f32_16x16x32_bf16 v[36:39], v[164:167], v[92:95], v[36:39]
    buffer_load_dwordx4 v0, s[12:15], s58 offen offset:1024 sc1 lds
    v_mfma_f32_16x16x32_bf16 v[20:23], a[228:231], v[92:95], v[20:23]
    v_lshrrev_b32 v7, 1, v7
    v_add_u32 v7, 156160, v7
    v_mfma_f32_16x16x32_bf16 v[44:47], v[80:83], v[228:231], v[44:47]
    ds_write2_b32 v7, v112, v113 offset0:0 offset1:64
    v_mfma_f32_16x16x32_bf16 v[48:51], v[84:87], v[228:231], v[48:51]
    v_mfma_f32_16x16x32_bf16 v[52:55], v[88:91], v[228:231], v[52:55]
    buffer_load_dword v126, v124, s[4:7], 0 offen sc1
    v_mfma_f32_16x16x32_bf16 v[56:59], v[92:95], v[228:231], v[56:59]
    s_waitcnt lgkmcnt(2)
    v_mfma_f32_16x16x32_bf16 v[24:27], v[168:171], v[64:67], v[24:27]
    ds_read_b128 v[80:83], v120 offset:5120
    v_mfma_f32_16x16x32_bf16 v[8:11], a[232:235], v[64:67], v[8:11]
    ds_read_b128 v[84:87], v120 offset:11264
    v_mfma_f32_16x16x32_bf16 v[28:31], v[168:171], v[68:71], v[28:31]
    ds_read_b128 v[88:91], v120 offset:17408
    v_mfma_f32_16x16x32_bf16 v[12:15], a[232:235], v[68:71], v[12:15]
    ds_read_b128 v[92:95], v120 offset:23552
    v_mfma_f32_16x16x32_bf16 v[32:35], v[168:171], v[72:75], v[32:35]
    s_cmp_eq_u32 s38, 0
    s_cselect_b32 s52, s101, s43
    v_mfma_f32_16x16x32_bf16 v[16:19], a[232:235], v[72:75], v[16:19]
    s_add_u32 s53, s52, 4
    v_mfma_f32_16x16x32_bf16 v[36:39], v[168:171], v[76:79], v[36:39]
    v_mfma_f32_16x16x32_bf16 v[20:23], a[232:235], v[76:79], v[20:23]
    v_mfma_f32_16x16x32_bf16 v[44:47], v[64:67], v[232:235], v[44:47]
    v_mfma_f32_16x16x32_bf16 v[48:51], v[68:71], v[232:235], v[48:51]
    v_mfma_f32_16x16x32_bf16 v[52:55], v[72:75], v[232:235], v[52:55]
    v_mfma_f32_16x16x32_bf16 v[56:59], v[76:79], v[232:235], v[56:59]
    s_waitcnt vmcnt(3) lgkmcnt(0)
    s_barrier
    v_mfma_f32_16x16x32_bf16 v[24:27], v[172:175], v[80:83], v[24:27]
    ds_read_b128 v[64:67], v120 offset:0
    v_mfma_f32_16x16x32_bf16 v[8:11], a[236:239], v[80:83], v[8:11]
    ds_read_b128 v[68:71], v120 offset:6144
    v_mfma_f32_16x16x32_bf16 v[28:31], v[172:175], v[84:87], v[28:31]
    s_waitcnt vmcnt(0)
    v_subrev_u32 v126, s53, v126
    v_cmp_le_u32 vcc, 16, v126
    s_nop 0
    s_and_b32 s48, vcc_hi, 0xcccccccc
    s_cselect_b32 s48, s40, 0
    s_cmp_eq_u32 s48, 0
    s_cbranch_scc1 hp_63
    s_mov_b32 s50, 0x0
    s_mov_b32 s51, 0xcccccccc
    s_add_i32 s48, s52, 4
    s_mov_b32 s49, s44
    s_mov_b64 exec, s[50:51]
    buffer_load_dword v126, v124, s[4:7], 0 offen sc1
    s_nop 7
    s_nop 7
poll_64:
    buffer_load_dword v127, v124, s[4:7], 0 offen sc1
    s_waitcnt vmcnt(1)
    v_subrev_u32 v126, s48, v126
    v_cmp_gt_u32 vcc, 16, v126
    s_nop 0
    s_cmp_eq_u64 vcc, s[50:51]
    s_nop 1
    s_cbranch_scc1 poll_64_ok
    buffer_load_dword v126, v124, s[4:7], 0 offen sc1
    s_waitcnt vmcnt(1)
    v_subrev_u32 v127, s48, v127
    v_cmp_gt_u32 vcc, 16, v127
    s_nop 0
    s_cmp_eq_u64 vcc, s[50:51]
    s_nop 1
    s_cbranch_scc1 poll_64_ok
    s_add_u32 s49, s49, 1
    s_cmp_lt_u32 s49, 2000000
    s_cbranch_scc1 poll_64
    s_mov_b32 s44, 2000000
poll_64_ok:
    s_mov_b64 exec, -1
hp_63:
    buffer_load_dwordx4 v[116:119], v121, s[4:7], s63 offen sc1
    v_mfma_f32_16x16x32_bf16 v[12:15], a[236:239], v[84:87], v[12:15]
    ds_read_b128 v[72:75], v120 offset:12288
    v_mfma_f32_16x16x32_bf16 v[32:35], v[172:175], v[88:91], v[32:35]
    ds_read_b128 v[76:79], v120 offset:18432
    v_mfma_f32_16x16x32_bf16 v[16:19], a[236:239], v[88:91], v[16:19]
    s_add_u32 m0, s78, 4096
    s_xor_b32 s58, s62, 0
    v_mfma_f32_16x16x32_bf16 v[36:39], v[172:175], v[92:95], v[36:39]
    buffer_load_dwordx4 v0, s[4:7], s58 offen sc1 lds
    v_mfma_f32_16x16x32_bf16 v[20:23], a[236:239], v[92:95], v[20:23]
    v_mfma_f32_16x16x32_bf16 v[44:47], v[80:83], v[236:239], v[44:47]
    v_mfma_f32_16x16x32_bf16 v[48:51], v[84:87], v[236:239], v[48:51]
    v_mfma_f32_16x16x32_bf16 v[52:55], v[88:91], v[236:239], v[52:55]
    buffer_load_dwordx4 v0, s[4:7], s58 offen offset:1024 sc1 lds
    v_mfma_f32_16x16x32_bf16 v[56:59], v[92:95], v[236:239], v[56:59]
    s_waitcnt lgkmcnt(0)
    v_mfma_f32_16x16x32_bf16 v[24:27], v[176:179], v[64:67], v[24:27]
    ds_read_b128 v[80:83], v120 offset:1024
    v_mfma_f32_16x16x32_bf16 v[8:11], a[240:243], v[64:67], v[8:11]
    ds_read_b128 v[84:87], v120 offset:7168
    v_mfma_f32_16x16x32_bf16 v[28:31], v[176:179], v[68:71], v[28:31]
    ds_read_b128 v[88:91], v120 offset:13312
    v_mfma_f32_16x16x32_bf16 v[12:15], a[240:243], v[68:71], v[12:15]
    ds_read_b128 v[92:95], v120 offset:19456
    v_mfma_f32_16x16x32_bf16 v[32:35], v[176:179], v[72:75], v[32:35]
    v_mfma_f32_16x16x32_bf16 v[16:19], a[240:243], v[72:75], v[16:19]
    v_mfma_f32_16x16x32_bf16 v[36:39], v[176:179], v[76:79], v[36:39]
    v_mfma_f32_16x16x32_bf16 v[20:23], a[240:243], v[76:79], v[20:23]
    v_mfma_f32_16x16x32_bf16 v[44:47], v[64:67], v[240:243], v[44:47]
    v_mfma_f32_16x16x32_bf16 v[48:51], v[68:71], v[240:243], v[48:51]
    v_mfma_f32_16x16x32_bf16 v[52:55], v[72:75], v[240:243], v[52:55]
    v_mfma_f32_16x16x32_bf16 v[56:59], v[76:79], v[240:243], v[56:59]
    s_waitcnt vmcnt(4) lgkmcnt(0)
    s_barrier
    v_mfma_f32_16x16x32_bf16 v[24:27], v[180:183], v[80:83], v[24:27]
    ds_read_b128 v[64:67], v120 offset:2048
    v_mfma_f32_16x16x32_bf16 v[8:11], a[244:247], v[80:83], v[8:11]
    ds_read_b128 v[68:71], v120 offset:8192
    v_mfma_f32_16x16x32_bf16 v[28:31], v[180:183], v[84:87], v[28:31]
    s_add_u32 m0, s78, 0
    s_xor_b32 s58, s62, 8192
    v_mfma_f32_16x16x32_bf16 v[12:15], a[244:247], v[84:87], v[12:15]
    buffer_load_dwordx4 v0, s[4:7], s58 offen sc1 lds
    v_mfma_f32_16x16x32_bf16 v[32:35], v[180:183], v[88:91], v[32:35]
    ds_read_b128 v[72:75], v120 offset:14336
    v_mfma_f32_16x16x32_bf16 v[16:19], a[244:247], v[88:91], v[16:19]
    ds_read_b128 v[76:79], v120 offset:20480
    v_mfma_f32_16x16x32_bf16 v[36:39], v[180:183], v[92:95], v[36:39]
    v_mfma_f32_16x16x32_bf16 v[20:23], a[244:247], v[92:95], v[20:23]
    v_mfma_f32_16x16x32_bf16 v[44:47], v[80:83], v[244:247], v[44:47]
    v_mfma_f32_16x16x32_bf16 v[48:51], v[84:87], v[244:247], v[48:51]
    buffer_load_dwordx4 v0, s[4:7], s58 offen offset:1024 sc1 lds
    v_mfma_f32_16x16x32_bf16 v[52:55], v[88:91], v[244:247], v[52:55]
    v_mfma_f32_16x16x32_bf16 v[56:59], v[92:95], v[244:247], v[56:59]
    s_waitcnt lgkmcnt(0)
    v_mfma_f32_16x16x32_bf16 v[24:27], v[184:187], v[64:67], v[24:27]
    ds_read_b128 v[80:83], v120 offset:3072
    v_lshlrev_b32_e64 v121, 4, v3
    v_add_u32 v121, 156160, v121
    v_mfma_f32_16x16x32_bf16 v[8:11], a[248:251], v[64:67], v[8:11]
    ds_read_b128 v[84:87], v120 offset:9216
    s_waitcnt vmcnt(4)
    v_add_f32 v114, v116, v118
    v_mfma_f32_16x16x32_bf16 v[28:31], v[184:187], v[68:71], v[28:31]
    ds_read_b128 v[88:91], v120 offset:15360
    v_add_f32_e64 v115, v117, v119
    v_mfma_f32_16x16x32_bf16 v[12:15], a[248:251], v[68:71], v[12:15]
    ds_read_b128 v[92:95], v120 offset:21504
    v_permlane32_swap_b32 v114, v115
    v_mfma_f32_16x16x32_bf16 v[32:35], v[184:187], v[72:75], v[32:35]
    v_add_f32 v114, v114, v115
    v_mov_b32 v115, v114
    v_mfma_f32_16x16x32_bf16 v[16:19], a[248:251], v[72:75], v[16:19]
    s_nop 0
    v_permlane16_swap_b32 v114, v115
    v_add_f32 v114, v114, v115
    v_mfma_f32_16x16x32_bf16 v[36:39], v[184:187], v[76:79], v[36:39]
    v_mov_b32_e64 v115, v114
    s_nop 1
    v_permlane32_swap_b32 v114, v115
    v_mfma_f32_16x16x32_bf16 v[20:23], a[248:251], v[76:79], v[20:23]
    v_mul_f32 v114, 0x3b000000, v114
    v_mul_f32 v115, 0x3b000000, v115
    v_fma_f32 v115, -v114, v114, v115
    v_mfma_f32_16x16x32_bf16 v[44:47], v[64:67], v[248:251], v[44:47]
    v_mfma_f32_16x16x32_bf16 v[48:51], v[68:71], v[248:251], v[48:51]
    v_mfma_f32_16x16x32_bf16 v[52:55], v[72:75], v[248:251], v[52:55]
    v_mfma_f32_16x16x32_bf16 v[56:59], v[76:79], v[248:251], v[56:59]
    s_waitcnt lgkmcnt(0)
    v_mfma_f32_16x16x32_bf16 v[24:27], v[188:191], v[80:83], v[24:27]
    v_max_f32 v115, 0, v115
    v_cvt_pk_bf16_f32 v6, v114, v115
    v_mfma_f32_16x16x32_bf16 v[8:11], a[252:255], v[80:83], v[8:11]
    v_lshlrev_b32_e64 v114, 16, v6
    v_and_b32 v115, 0xffff0000, v6
    v_mfma_f32_16x16x32_bf16 v[28:31], v[188:191], v[84:87], v[28:31]
    v_add_f32 v115, 0x3727c5ac, v115
    v_cvt_pk_bf16_f32 v6, v115, v115
    v_mfma_f32_16x16x32_bf16 v[12:15], a[252:255], v[84:87], v[12:15]
    v_and_b32 v115, 0xffff0000, v6
    v_mfma_f32_16x16x32_bf16 v[32:35], v[188:191], v[88:91], v[32:35]
    v_sqrt_f32_e64 v115, v115
    v_mfma_f32_16x16x32_bf16 v[16:19], a[252:255], v[88:91], v[16:19]
    v_cvt_pk_bf16_f32 v6, v115, v115
    v_and_b32 v115, 0xffff0000, v6
    v_mfma_f32_16x16x32_bf16 v[36:39], v[188:191], v[92:95], v[36:39]
    v_rcp_f32 v115, v115
    v_mfma_f32_16x16x32_bf16 v[20:23], a[252:255], v[92:95], v[20:23]
    s_lshl_b32 s59, s3, 8
    s_add_u32 s59, s59, 158720
    v_mfma_f32_16x16x32_bf16 v[44:47], v[80:83], v[252:255], v[44:47]
    v_lshl_add_u32 v6, v2, 2, s59
    ds_write2_b32 v6, v114, v115 offset0:0 offset1:16
    v_mfma_f32_16x16x32_bf16 v[48:51], v[84:87], v[252:255], v[48:51]
    v_mfma_f32_16x16x32_bf16 v[52:55], v[88:91], v[252:255], v[52:55]
    v_mfma_f32_16x16x32_bf16 v[56:59], v[92:95], v[252:255], v[56:59]
    s_waitcnt vmcnt(0) lgkmcnt(0)
    s_barrier
    v_lshlrev_b32_e64 v6, 3, v2
    v_add_u32 v6, 155648, v6
    ds_read2_b64 v[88:91], v6 offset0:0 offset1:16
    ds_read2_b64 v[92:95], v6 offset0:32 offset1:48
    ds_read_b128 v[64:67], v120 offset:4096
    ds_read_b128 v[68:71], v120 offset:5120
    ds_read_b128 v[72:75], v120 offset:10240
    ds_read_b128 v[76:79], v120 offset:11264
    v_lshrrev_b32 v6, 1, v3
    v_lshlrev_b32 v7, 4, v2
    v_lshl_add_u32 v7, v6, 8, v7
    v_and_b32 v6, 1, v3
    v_lshl_add_u32 v7, v6, 3, v7
    s_waitcnt lgkmcnt(2)
    v_mfma_f32_16x16x32_bf16 v[40:43], v[128:131], v[64:67], 0
    ds_read_b128 v[80:83], v120 offset:16384
    ds_read_b128 v[84:87], v120 offset:17408
    v_fma_f32 v24, -v104, v88, v24
    v_mfma_f32_16x16x32_bf16 v[60:63], v[64:67], v[192:195], 0
    v_fma_f32 v25, -v105, v88, v25
    v_fma_f32 v26, -v106, v88, v26
    v_fma_f32 v27, -v107, v88, v27
    v_mfma_f32_16x16x32_bf16 v[40:43], v[132:135], v[68:71], v[40:43]
    v_mul_f32 v24, v24, v89
    v_mul_f32 v25, v25, v89
    v_mul_f32 v26, v26, v89
    v_mfma_f32_16x16x32_bf16 v[60:63], v[68:71], v[196:199], v[60:63]
    v_mul_f32 v27, v27, v89
    v_cvt_pk_bf16_f32 v24, v24, v25
    v_cvt_pk_bf16_f32 v25, v26, v27
    s_waitcnt lgkmcnt(2)
    v_mfma_f32_16x16x32_bf16 v[40:43], v[136:139], v[72:75], v[40:43]
    ds_read_b128 v[64:67], v120 offset:22528
    ds_read_b128 v[68:71], v120 offset:23552
    v_fma_f32 v28, -v104, v90, v28
    v_mfma_f32_16x16x32_bf16 v[60:63], v[72:75], v[200:203], v[60:63]
    v_fma_f32 v29, -v105, v90, v29
    v_fma_f32 v30, -v106, v90, v30
    v_fma_f32 v31, -v107, v90, v31
    v_mfma_f32_16x16x32_bf16 v[40:43], v[140:143], v[76:79], v[40:43]
    v_mul_f32 v28, v28, v91
    v_mul_f32 v29, v29, v91
    v_mul_f32 v30, v30, v91
    v_mfma_f32_16x16x32_bf16 v[60:63], v[76:79], v[204:207], v[60:63]
    v_mul_f32_e64 v31, v31, v91
    v_cvt_pk_bf16_f32 v28, v28, v29
    v_cvt_pk_bf16_f32 v29, v30, v31
    s_waitcnt lgkmcnt(2)
    v_mfma_f32_16x16x32_bf16 v[40:43], v[144:147], v[80:83], v[40:43]
    ds_read_b128 v[72:75], v120 offset:0
    ds_read_b128 v[76:79], v120 offset:1024
    v_fma_f32 v32, -v104, v92, v32
    v_mfma_f32_16x16x32_bf16 v[60:63], v[80:83], v[208:211], v[60:63]
    v_fma_f32 v33, -v105, v92, v33
    v_fma_f32 v34, -v106, v92, v34
    v_fma_f32 v35, -v107, v92, v35
    v_mfma_f32_16x16x32_bf16 v[40:43], v[148:151], v[84:87], v[40:43]
    v_mul_f32 v32, v32, v93
    v_mul_f32 v33, v33, v93
    v_mul_f32 v34, v34, v93
    v_mfma_f32_16x16x32_bf16 v[60:63], v[84:87], v[212:215], v[60:63]
    v_mul_f32_e64 v35, v35, v93
    v_cvt_pk_bf16_f32 v32, v32, v33
    v_cvt_pk_bf16_f32 v33, v34, v35
    s_waitcnt lgkmcnt(2)
    v_mfma_f32_16x16x32_bf16 v[40:43], v[152:155], v[64:67], v[40:43]
    ds_read_b128 v[80:83], v120 offset:6144
    ds_read_b128 v[84:87], v120 offset:7168
    v_fma_f32 v36, -v104, v94, v36
    v_mfma_f32_16x16x32_bf16 v[60:63], v[64:67], v[216:219], v[60:63]
    v_fma_f32 v37, -v105, v94, v37
    v_fma_f32 v38, -v106, v94, v38
    v_fma_f32 v39, -v107, v94, v39
    v_mfma_f32_16x16x32_bf16 v[40:43], v[156:159], v[68:71], v[40:43]
    v_mul_f32 v36, v36, v95
    v_mul_f32 v37, v37, v95
    v_mul_f32 v38, v38, v95
    v_mfma_f32_16x16x32_bf16 v[60:63], v[68:71], v[220:223], v[60:63]
    v_mul_f32_e64 v39, v39, v95
    v_cvt_pk_bf16_f32 v36, v36, v37
    v_cvt_pk_bf16_f32 v37, v38, v39
    s_waitcnt lgkmcnt(2)
    v_mfma_f32_16x16x32_bf16 v[40:43], v[160:163], v[72:75], v[40:43]
    buffer_load_dwordx2 v[26:27], v7, s[12:15], s76 offen offset:0 sc1
    ds_read_b128 v[64:67], v120 offset:12288
    ds_read_b128 v[68:71], v120 offset:13312
    v_mul_f32 v93, s92, v93
    v_mfma_f32_16x16x32_bf16 v[60:63], v[72:75], v[224:227], v[60:63]
    v_fma_f32 v16, -v100, v92, v16
    v_fma_f32 v17, -v101, v92, v17
    v_fma_f32 v18, -v102, v92, v18
    v_mfma_f32_16x16x32_bf16 v[40:43], v[164:167], v[76:79], v[40:43]
    v_fma_f32 v19, -v103, v92, v19
    v_mul_f32 v16, v16, v93
    v_mul_f32 v17, v17, v93
    v_mfma_f32_16x16x32_bf16 v[60:63], v[76:79], v[228:231], v[60:63]
    v_mul_f32 v18, v18, v93
    v_mul_f32 v19, v19, v93
    v_cvt_pk_bf16_f32 v16, v16, v17
    s_waitcnt lgkmcnt(2)
    v_mfma_f32_16x16x32_bf16 v[40:43], v[168:171], v[80:83], v[40:43]
    buffer_load_dwordx2 v[30:31], v7, s[12:15], s76 offen offset:512 sc1
    ds_read_b128 v[72:75], v120 offset:18432
    ds_read_b128 v[76:79], v120 offset:19456
    v_cvt_pk_bf16_f32 v17, v18, v19
    v_mfma_f32_16x16x32_bf16 v[60:63], v[80:83], v[232:235], v[60:63]
    v_mul_f32 v95, s92, v95
    v_fma_f32 v20, -v100, v94, v20
    v_fma_f32 v21, -v101, v94, v21
    v_mfma_f32_16x16x32_bf16 v[40:43], v[172:175], v[84:87], v[40:43]
    v_fma_f32 v22, -v102, v94, v22
    v_fma_f32 v23, -v103, v94, v23
    v_mul_f32 v20, v20, v95
    v_mfma_f32_16x16x32_bf16 v[60:63], v[84:87], v[236:239], v[60:63]
    v_mul_f32 v21, v21, v95
    v_mul_f32 v22, v22, v95
    v_mul_f32_e64 v23, v23, v95
    s_waitcnt lgkmcnt(2)
    v_mfma_f32_16x16x32_bf16 v[40:43], v[176:179], v[64:67], v[40:43]
    buffer_load_dwordx2 v[34:35], v7, s[12:15], s76 offen offset:1024 sc1
    ds_read_b128 v[80:83], v121 offset:128
    ds_read_b128 v[84:87], v121 offset:384
    v_cvt_pk_bf16_f32 v20, v20, v21
    v_cvt_pk_bf16_f32 v21, v22, v23
    v_mfma_f32_16x16x32_bf16 v[60:63], v[64:67], v[240:243], v[60:63]
    v_mul_f32_e64 v89, s92, v89
    v_fma_f32 v8, -v100, v88, v8
    v_fma_f32 v9, -v101, v88, v9
    v_mfma_f32_16x16x32_bf16 v[40:43], v[180:183], v[68:71], v[40:43]
    v_fma_f32 v10, -v102, v88, v10
    v_fma_f32 v11, -v103, v88, v11
    v_mul_f32 v8, v8, v89
    v_mul_f32 v9, v9, v89
    v_mfma_f32_16x16x32_bf16 v[60:63], v[68:71], v[244:247], v[60:63]
    v_mul_f32 v10, v10, v89
    v_mul_f32 v11, v11, v89
    v_cvt_pk_bf16_f32 v8, v8, v9
    s_waitcnt lgkmcnt(2)
    v_mfma_f32_16x16x32_bf16 v[40:43], v[184:187], v[72:75], v[40:43]
    buffer_load_dwordx2 v[38:39], v7, s[12:15], s76 offen offset:1536 sc1
    v_cvt_pk_bf16_f32 v9, v10, v11
    v_mul_f32 v91, s92, v91
    v_fma_f32 v12, -v100, v90, v12
    v_mfma_f32_16x16x32_bf16 v[60:63], v[72:75], v[248:251], v[60:63]
    v_fma_f32 v13, -v101, v90, v13
    v_fma_f32 v14, -v102, v90, v14
    v_fma_f32 v15, -v103, v90, v15
    v_mfma_f32_16x16x32_bf16 v[40:43], v[188:191], v[76:79], v[40:43]
    v_mul_f32 v12, v12, v91
    v_mul_f32 v13, v13, v91
    v_mul_f32 v14, v14, v91
    v_mfma_f32_16x16x32_bf16 v[60:63], v[76:79], v[252:255], v[60:63]
    v_mul_f32 v15, v15, v91
    v_cvt_pk_bf16_f32 v12, v12, v13
    v_cvt_pk_bf16_f32 v13, v14, v15
    ds_read_b128 v[64:67], v121 offset:0
    ds_read_b128 v[68:71], v121 offset:256
    ds_read_b128 v[72:75], v121 offset:64
    ds_read_b128 v[76:79], v121 offset:320
    s_lshl_b32 s59, s3, 8
    s_add_u32 s59, s59, 158720
    v_lshl_add_u32 v6, v3, 4, s59
    ds_read_b128 v[88:91], v121 offset:192
    ds_read_b128 v[92:95], v121 offset:448
    s_waitcnt lgkmcnt(6)
    v_pk_fma_f32 v[52:53], v[80:81], v[108:109], v[52:53] op_sel:[0,0,0] op_sel_hi:[1,0,1] neg_lo:[1,0,0] neg_hi:[1,0,0]
    v_pk_fma_f32 v[54:55], v[82:83], v[108:109], v[54:55] op_sel:[0,0,0] op_sel_hi:[1,0,1] neg_lo:[1,0,0] neg_hi:[1,0,0]
    v_pk_mul_f32 v[52:53], v[52:53], v[84:85]
    v_pk_mul_f32 v[54:55], v[54:55], v[86:87]
    v_cvt_pk_bf16_f32 v96, v52, v53
    v_cvt_pk_bf16_f32 v97, v54, v55
    v_pk_fma_f32 v[40:41], v[104:105], v[114:115], v[40:41] op_sel:[0,0,0] op_sel_hi:[1,0,1] neg_lo:[0,1,0] neg_hi:[0,1,0]
    v_pk_fma_f32 v[42:43], v[106:107], v[114:115], v[42:43] op_sel:[0,0,0] op_sel_hi:[1,0,1] neg_lo:[0,1,0] neg_hi:[0,1,0]
    v_pk_mul_f32 v[40:41], v[40:41], v[114:115] op_sel:[0,1] op_sel_hi:[1,1]
    v_pk_mul_f32 v[42:43], v[42:43], v[114:115] op_sel:[0,1] op_sel_hi:[1,1]
    v_cvt_pk_bf16_f32 v40, v40, v41
    v_cvt_pk_bf16_f32 v41, v42, v43
    ds_read_b128 v[112:115], v6
    ds_read_b128 v[116:119], v6 offset:64
    v_add_u32 v6, 161792, v0
    s_waitcnt lgkmcnt(2)
    v_pk_fma_f32 v[44:45], v[64:65], v[108:109], v[44:45] op_sel:[0,0,0] op_sel_hi:[1,0,1] neg_lo:[1,0,0] neg_hi:[1,0,0]
    v_pk_fma_f32 v[46:47], v[66:67], v[108:109], v[46:47] op_sel:[0,0,0] op_sel_hi:[1,0,1] neg_lo:[1,0,0] neg_hi:[1,0,0]
    v_pk_mul_f32 v[44:45], v[44:45], v[68:69]
    v_pk_mul_f32 v[46:47], v[46:47], v[70:71]
    v_cvt_pk_bf16_f32 v98, v44, v45
    v_cvt_pk_bf16_f32 v99, v46, v47
    v_pk_fma_f32 v[48:49], v[72:73], v[108:109], v[48:49] op_sel:[0,0,0] op_sel_hi:[1,0,1] neg_lo:[1,0,0] neg_hi:[1,0,0]
    v_pk_fma_f32 v[50:51], v[74:75], v[108:109], v[50:51] op_sel:[0,0,0] op_sel_hi:[1,0,1] neg_lo:[1,0,0] neg_hi:[1,0,0]
    v_pk_mul_f32 v[48:49], v[48:49], v[76:77]
    v_pk_mul_f32 v[50:51], v[50:51], v[78:79]
    v_cvt_pk_bf16_f32 v104, v48, v49
    v_cvt_pk_bf16_f32 v105, v50, v51
    s_waitcnt lgkmcnt(0)
    v_pk_fma_f32 v[56:57], v[88:89], v[108:109], v[56:57] op_sel:[0,0,0] op_sel_hi:[1,0,1] neg_lo:[1,0,0] neg_hi:[1,0,0]
    v_pk_fma_f32 v[58:59], v[90:91], v[108:109], v[58:59] op_sel:[0,0,0] op_sel_hi:[1,0,1] neg_lo:[1,0,0] neg_hi:[1,0,0]
    v_pk_mul_f32 v[56:57], v[56:57], v[92:93]
    v_pk_mul_f32 v[58:59], v[58:59], v[94:95]
    v_cvt_pk_bf16_f32 v102, v56, v57
    v_cvt_pk_bf16_f32 v103, v58, v59
    v_pk_fma_f32 v[60:61], v[112:113], v[108:109], v[60:61] op_sel:[0,0,0] op_sel_hi:[1,0,1] neg_lo:[1,0,0] neg_hi:[1,0,0]
    v_pk_fma_f32 v[62:63], v[114:115], v[108:109], v[62:63] op_sel:[0,0,0] op_sel_hi:[1,0,1] neg_lo:[1,0,0] neg_hi:[1,0,0]
    v_pk_mul_f32 v[60:61], v[60:61], v[116:117]
    v_pk_mul_f32 v[62:63], v[62:63], v[118:119]
    v_cvt_pk_bf16_f32 v100, v60, v61
    v_cvt_pk_bf16_f32 v101, v62, v63
    v_cvt_pk_bf16_f32 v106, v60, v61
    v_cvt_pk_bf16_f32 v107, v62, v63
    ds_read_b128 v[112:115], v6
    ds_read_b128 v[116:119], v6 offset:1024
    v_mfma_f32_16x16x16_bf16 v[72:75], v[32:33], v[16:17], 0
    v_mov_b32 v108, 0x3f803f80
    v_mov_b32 v109, 0x3f803f80
    v_mov_b32 v110, 0x3f803f80
    v_mfma_f32_16x16x16_bf16 v[88:91], v[24:25], v[16:17], 0
    v_mov_b32 v111, 0x3f803f80
    v_lshrrev_b32_e64 v120, 1, v3
    v_mfma_f32_16x16x16_bf16 v[76:79], v[36:37], v[20:21], 0
    v_lshl_add_u32 v120, v120, 4, v2
    v_lshlrev_b32 v120, 4, v120
    v_mfma_f32_16x16x16_bf16 v[92:95], v[28:29], v[20:21], 0
    v_and_b32 v6, 1, v3
    v_lshl_add_u32 v120, v6, 9, v120
    v_cndmask_b32 v72, v88, v72, s[64:65]
    v_cndmask_b32 v73, v89, v73, s[66:67]
    v_mfma_f32_16x16x16_bf16 v[64:67], v[24:25], v[8:9], 0
    v_cndmask_b32 v74, v90, v74, s[68:69]
    v_cndmask_b32 v75, v91, v75, s[70:71]
    v_exp_f32 v72, v72
    v_mfma_f32_16x16x16_bf16 v[80:83], v[40:41], v[8:9], 0
    v_exp_f32 v73, v73
    v_exp_f32 v74, v74
    v_exp_f32 v75, v75
    v_cvt_pk_bf16_f32 v72, v72, v73
    v_cvt_pk_bf16_f32 v73, v74, v75
    s_waitcnt lgkmcnt(0)
    v_and_b32 v52, v72, v112
    v_and_b32 v54, v72, v114
    v_and_b32 v53, v73, v113
    v_and_b32_e64 v55, v73, v115
    v_cndmask_b32 v76, v92, v76, s[64:65]
    v_cndmask_b32 v77, v93, v77, s[66:67]
    v_mfma_f32_16x16x32_bf16 v[72:75], v[96:99], v[52:55], 0
    v_cndmask_b32 v78, v94, v78, s[68:69]
    v_cndmask_b32 v79, v95, v79, s[70:71]
    v_exp_f32 v76, v76
    v_mfma_f32_16x16x32_bf16 v[88:91], v[108:111], v[52:55], 0
    v_exp_f32 v77, v77
    v_exp_f32 v78, v78
    v_exp_f32 v79, v79
    v_mfma_f32_16x16x16_bf16 v[68:71], v[28:29], v[12:13], 0
    v_cvt_pk_bf16_f32 v76, v76, v77
    v_cvt_pk_bf16_f32 v77, v78, v79
    v_and_b32 v56, v76, v112
    v_mfma_f32_16x16x16_bf16 v[84:87], v[40:41], v[12:13], 0
    v_and_b32 v58, v76, v114
    v_and_b32 v57, v77, v113
    v_and_b32 v59, v77, v115
    v_cndmask_b32 v64, v80, v64, s[64:65]
    v_cndmask_b32 v65, v81, v65, s[66:67]
    v_mfma_f32_16x16x32_bf16 v[76:79], v[102:105], v[56:59], 0
    v_cndmask_b32 v66, v82, v66, s[68:69]
    v_cndmask_b32 v67, v83, v67, s[70:71]
    v_exp_f32 v64, v64
    v_mfma_f32_16x16x32_bf16 v[92:95], v[108:111], v[56:59], 0
    v_exp_f32 v65, v65
    v_exp_f32 v66, v66
    v_exp_f32 v67, v67
    v_cvt_pk_bf16_f32 v64, v64, v65
    v_cvt_pk_bf16_f32 v65, v66, v67
    v_and_b32 v44, v64, v112
    v_and_b32 v46, v64, v116
    v_and_b32 v45, v65, v113
    v_and_b32 v47, v65, v117
    v_cndmask_b32 v68, v84, v68, s[64:65]
    v_cndmask_b32 v69, v85, v69, s[66:67]
    v_mfma_f32_16x16x32_bf16 v[64:67], v[98:101], v[44:47], 0
    v_cndmask_b32 v70, v86, v70, s[68:69]
    v_cndmask_b32 v71, v87, v71, s[70:71]
    v_exp_f32 v68, v68
    v_mfma_f32_16x16x32_bf16 v[80:83], v[108:111], v[44:47], 0
    v_exp_f32 v69, v69
    v_exp_f32 v70, v70
    v_exp_f32 v71, v71
    v_cvt_pk_bf16_f32 v68, v68, v69
    v_cvt_pk_bf16_f32 v69, v70, v71
    v_and_b32 v48, v68, v112
    v_and_b32 v50, v68, v118
    v_and_b32 v49, v69, v113
    v_and_b32_e64 v51, v69, v119
    s_nop 1
    v_mfma_f32_16x16x32_bf16 v[68:71], v[104:107], v[48:51], 0
    v_mfma_f32_16x16x32_bf16 v[84:87], v[108:111], v[48:51], 0
    s_mov_b32 s52, 0x21800000
    s_mov_b32 s53, 0x5d800000
    v_rcp_f32 v88, v88
    v_rcp_f32 v92, v92
    v_rcp_f32 v80, v80
    s_nop 2
    v_rcp_f32_e64 v84, v84
    v_pk_mul_f32 v[72:73], v[72:73], v[88:89] op_sel:[0,0] op_sel_hi:[1,0]
    v_pk_mul_f32 v[74:75], v[74:75], v[88:89] op_sel:[0,0] op_sel_hi:[1,0]
    v_cvt_pk_bf16_f32 v44, v72, v73
    v_cvt_pk_bf16_f32 v45, v74, v75
    v_pk_mul_f32 v[76:77], v[76:77], v[92:93] op_sel:[0,0] op_sel_hi:[1,0]
    v_pk_mul_f32 v[78:79], v[78:79], v[92:93] op_sel:[0,0] op_sel_hi:[1,0]
    v_cvt_pk_bf16_f32 v46, v76, v77
    v_cvt_pk_bf16_f32 v47, v78, v79
    v_pk_mul_f32 v[64:65], v[64:65], v[80:81] op_sel:[0,0] op_sel_hi:[1,0]
    v_pk_mul_f32 v[66:67], v[66:67], v[80:81] op_sel:[0,0] op_sel_hi:[1,0]
    v_cvt_pk_bf16_f32 v48, v64, v65
    v_cvt_pk_bf16_f32 v49, v66, v67
    v_pk_mul_f32 v[68:69], v[68:69], v[84:85] op_sel:[0,0] op_sel_hi:[1,0]
    v_pk_mul_f32 v[70:71], v[70:71], v[84:85] op_sel:[0,0] op_sel_hi:[1,0]
    v_cvt_pk_bf16_f32 v50, v68, v69
    v_cvt_pk_bf16_f32 v51, v70, v71
    v_permlane16_swap_b32 v44, v46
    v_permlane16_swap_b32 v45, v47
    v_permlane16_swap_b32 v48, v50
    v_permlane16_swap_b32 v49, v51
    s_cmp_lg_u32 s42, 0
    s_cbranch_scc0 st_66_s
    buffer_store_dwordx4 v[44:47], v120, s[4:7], s75 offen
    buffer_store_dwordx4 v[48:51], v120, s[4:7], s74 offen
st_66:
    v_min3_f32 v4, v88, v92, v80
    v_max3_f32 v5, v88, v92, v80
    v_pk_mul_f32 v[6:7], v[72:73], 0 op_sel_hi:[1,0]
    v_pk_fma_f32 v[6:7], v[74:75], 0, v[6:7] op_sel_hi:[1,0,1]
    v_pk_fma_f32 v[6:7], v[76:77], 0, v[6:7] op_sel_hi:[1,0,1]
    v_pk_fma_f32 v[6:7], v[78:79], 0, v[6:7] op_sel_hi:[1,0,1]
    v_pk_fma_f32 v[6:7], v[64:65], 0, v[6:7] op_sel_hi:[1,0,1]
    v_pk_fma_f32 v[6:7], v[66:67], 0, v[6:7] op_sel_hi:[1,0,1]
    v_pk_fma_f32 v[6:7], v[68:69], 0, v[6:7] op_sel_hi:[1,0,1]
    v_pk_fma_f32 v[6:7], v[70:71], 0, v[6:7] op_sel_hi:[1,0,1]
    v_min_f32 v4, v4, v84
    v_max_f32 v5, v5, v84
    v_add_f32 v6, v6, v7
    v_add_f32 v6, v6, v4
    v_cmp_le_f32 vcc, s52, v6
    v_cmp_ge_f32 s[48:49], s53, v5
    s_nop 0
    s_and_b64 vcc, vcc, s[48:49]
    s_cmp_eq_u64 vcc, exec
    s_nop 0
    s_cbranch_scc0 ab_65_slow
ab_65_ok:
    v_bfe_u32 v5, v1, 3, 1
    v_bfe_u32 v6, v1, 4, 1
    v_lshl_or_b32 v5, v6, 1, v5
    v_xor_b32 v5, 0, v5
    v_lshlrev_b32 v5, 5, v5
    v_and_b32_e64 v6, 3, v1
    v_lshl_add_u32 v5, v6, 3, v5
    v_bfe_u32 v6, v1, 2, 2
    v_lshl_add_u32 v5, v6, 7, v5
    v_mul_u32_u24 v6, 1024, v3
    v_add_u32 v4, v5, v6
    v_add_u32 v4, 65536, v4
    v_xor_b32 v5, 32, v4
    v_xor_b32 v52, 64, v4
    v_xor_b32 v120, 96, v4
    v_lshrrev_b32 v6, 1, v3
    v_and_b32 v7, 1, v3
    v_lshlrev_b32 v122, 4, v2
    v_lshl_add_u32 v6, v7, 1, v6
    v_lshl_add_u32 v122, v6, 8, v122
    v_lshlrev_b32 v6, 4, v6
    v_lshl_add_u32 v121, v2, 11, v6
    v_lshrrev_b32 v6, 5, v1
    v_lshl_add_u32 v7, v6, 9, v0
    s_mov_b32 s56, s83
    ds_read_b64_tr_b16 v[56:57], v4 offset:0
    ds_read_b64_tr_b16 v[58:59], v4 offset:512
    ds_read_b64_tr_b16 v[60:61], v5 offset:0
    ds_read_b64_tr_b16 v[62:63], v5 offset:512
    ds_read_b64_tr_b16 v[64:65], v52 offset:0
    ds_read_b64_tr_b16 v[66:67], v52 offset:512
    ds_read_b64_tr_b16 v[68:69], v120 offset:0
    ds_read_b64_tr_b16 v[70:71], v120 offset:512
    ds_read_b64_tr_b16 v[72:73], v4 offset:4096
    ds_read_b64_tr_b16 v[74:75], v4 offset:4608
    ds_read_b64_tr_b16 v[76:77], v5 offset:4096
    ds_read_b64_tr_b16 v[78:79], v5 offset:4608
    ds_read_b64_tr_b16 v[80:81], v52 offset:4096
    ds_read_b64_tr_b16 v[82:83], v52 offset:4608
    ds_read_b64_tr_b16 v[84:85], v120 offset:4096
    ds_read_b64_tr_b16 v[86:87], v120 offset:4608
    s_add_u32 s48, s43, 5
    v_mov_b32 v6, s48
    s_cmp_lg_u32 s42, 0
    s_mov_b64 exec, 1
    s_waitcnt vmcnt(0)
    s_cbranch_scc0 sig_68_s
    buffer_store_dword v6, off, s[4:7], s47
sig_68:
    s_mov_b64 exec, -1
    ds_read_b64_tr_b16 a[0:1], v4 offset:8192
    ds_read_b64_tr_b16 a[2:3], v4 offset:8704
    ds_read_b64_tr_b16 a[4:5], v5 offset:8192
    ds_read_b64_tr_b16 a[6:7], v5 offset:8704
    ds_read_b64_tr_b16 a[8:9], v52 offset:8192
    ds_read_b64_tr_b16 a[10:11], v52 offset:8704
    ds_read_b64_tr_b16 a[12:13], v120 offset:8192
    ds_read_b64_tr_b16 a[14:15], v120 offset:8704
    ds_read_b64_tr_b16 a[16:17], v4 offset:12288
    ds_read_b64_tr_b16 a[18:19], v4 offset:12800
    ds_read_b64_tr_b16 a[20:21], v5 offset:12288
    ds_read_b64_tr_b16 a[22:23], v5 offset:12800
    ds_read_b64_tr_b16 a[24:25], v52 offset:12288
    ds_read_b64_tr_b16 a[26:27], v52 offset:12800
    ds_read_b64_tr_b16 a[28:29], v120 offset:12288
    ds_read_b64_tr_b16 a[30:31], v120 offset:12800
    ds_read_b64_tr_b16 a[32:33], v4 offset:16384
    ds_read_b64_tr_b16 a[34:35], v4 offset:16896
    ds_read_b64_tr_b16 a[36:37], v5 offset:16384
    ds_read_b64_tr_b16 a[38:39], v5 offset:16896
    ds_read_b64_tr_b16 a[40:41], v52 offset:16384
    ds_read_b64_tr_b16 a[42:43], v52 offset:16896
    ds_read_b64_tr_b16 a[44:45], v120 offset:16384
    ds_read_b64_tr_b16 a[46:47], v120 offset:16896
    ds_read_b64_tr_b16 a[48:49], v4 offset:20480
    ds_read_b64_tr_b16 a[50:51], v4 offset:20992
    ds_read_b64_tr_b16 a[52:53], v5 offset:20480
    ds_read_b64_tr_b16 a[54:55], v5 offset:20992
    ds_read_b64_tr_b16 a[56:57], v52 offset:20480
    ds_read_b64_tr_b16 a[58:59], v52 offset:20992
    ds_read_b64_tr_b16 a[60:61], v120 offset:20480
    ds_read_b64_tr_b16 a[62:63], v120 offset:20992
    ds_read_b64_tr_b16 a[64:65], v4 offset:24576
    ds_read_b64_tr_b16 a[66:67], v4 offset:25088
    ds_read_b64_tr_b16 a[68:69], v5 offset:24576
    ds_read_b64_tr_b16 a[70:71], v5 offset:25088
    ds_read_b64_tr_b16 a[72:73], v52 offset:24576
    ds_read_b64_tr_b16 a[74:75], v52 offset:25088
    ds_read_b64_tr_b16 a[76:77], v120 offset:24576
    ds_read_b64_tr_b16 a[78:79], v120 offset:25088
    s_mov_b32 exec_hi, 0
    buffer_load_dword v126, v124, s[4:7], 0 offen sc1
    s_mov_b32 exec_hi, -1
    s_waitcnt vmcnt(2)
    v_lshlrev_b32 v104, 16, v26
    v_and_b32 v105, 0xffff0000, v26
    v_lshlrev_b32 v106, 16, v27
    v_and_b32 v107, 0xffff0000, v27
    v_lshlrev_b32 v108, 16, v30
    v_and_b32 v109, 0xffff0000, v30
    v_lshlrev_b32 v110, 16, v31
    v_and_b32 v111, 0xffff0000, v31
    v_lshlrev_b32 v112, 16, v34
    v_and_b32 v113, 0xffff0000, v34
    v_lshlrev_b32 v114, 16, v35
    v_and_b32 v115, 0xffff0000, v35
    v_lshlrev_b32 v116, 16, v38
    v_and_b32 v117, 0xffff0000, v38
    v_lshlrev_b32 v118, 16, v39
    v_and_b32 v119, 0xffff0000, v39
    s_mov_b32 s50, 0xffffffff
    s_mov_b32 s51, 0x0
    s_add_i32 s48, s43, 5
    s_mov_b32 s49, s44
    s_mov_b64 exec, s[50:51]
poll_69:
    buffer_load_dword v127, v124, s[4:7], 0 offen sc1
    s_waitcnt vmcnt(1)
    v_subrev_u32 v126, s48, v126
    v_cmp_gt_u32 vcc, 16, v126
    s_nop 0
    s_cmp_eq_u64 vcc, s[50:51]
    s_nop 1
    s_cbranch_scc1 poll_69_ok
    buffer_load_dword v126, v124, s[4:7], 0 offen sc1
    s_waitcnt vmcnt(1)
    v_subrev_u32 v127, s48, v127
    v_cmp_gt_u32 vcc, 16, v127
    s_nop 0
    s_cmp_eq_u64 vcc, s[50:51]
    s_nop 1
    s_cbranch_scc1 poll_69_ok
    s_add_u32 s49, s49, 1
    s_cmp_lt_u32 s49, 2000000
    s_cbranch_scc1 poll_69
    s_mov_b32 s44, 2000000
poll_69_ok:
    s_mov_b64 exec, -1
    buffer_load_dwordx4 v[8:11], v7, s[4:7], s56 offen offset:0 sc1
    buffer_load_dwordx4 v[12:15], v7, s[4:7], s56 offen offset:2048 sc1
    s_xor_b32 s56, s83, 4096
    buffer_load_dwordx4 v[16:19], v7, s[4:7], s56 offen offset:0 sc1
    buffer_load_dwordx4 v[20:23], v7, s[4:7], s56 offen offset:2048 sc1
    s_xor_b32 s56, s83, 8192
    buffer_load_dwordx4 v[24:27], v7, s[4:7], s56 offen offset:0 sc1
    buffer_load_dwordx4 v[28:31], v7, s[4:7], s56 offen offset:2048 sc1
    ds_read_b64_tr_b16 a[80:81], v4 offset:28672
    ds_read_b64_tr_b16 a[82:83], v4 offset:29184
    ds_read_b64_tr_b16 a[84:85], v5 offset:28672
    ds_read_b64_tr_b16 a[86:87], v5 offset:29184
    ds_read_b64_tr_b16 a[88:89], v52 offset:28672
    ds_read_b64_tr_b16 a[90:91], v52 offset:29184
    ds_read_b64_tr_b16 a[92:93], v120 offset:28672
    ds_read_b64_tr_b16 a[94:95], v120 offset:29184
    ds_read_b64_tr_b16 a[96:97], v4 offset:32768
    ds_read_b64_tr_b16 a[98:99], v4 offset:33280
    ds_read_b64_tr_b16 a[100:101], v5 offset:32768
    ds_read_b64_tr_b16 a[102:103], v5 offset:33280
    ds_read_b64_tr_b16 a[104:105], v52 offset:32768
    ds_read_b64_tr_b16 a[106:107], v52 offset:33280
    ds_read_b64_tr_b16 a[108:109], v120 offset:32768
    ds_read_b64_tr_b16 a[110:111], v120 offset:33280
    ds_read_b64_tr_b16 a[112:113], v4 offset:36864
    ds_read_b64_tr_b16 a[114:115], v4 offset:37376
    ds_read_b64_tr_b16 a[116:117], v5 offset:36864
    ds_read_b64_tr_b16 a[118:119], v5 offset:37376
    ds_read_b64_tr_b16 a[120:121], v52 offset:36864
    ds_read_b64_tr_b16 a[122:123], v52 offset:37376
    ds_read_b64_tr_b16 a[124:125], v120 offset:36864
    ds_read_b64_tr_b16 a[126:127], v120 offset:37376
    s_waitcnt vmcnt(5) lgkmcnt(15)
    v_mfma_f32_16x16x32_bf16 v[104:107], v[56:59], v[8:11], v[104:107]
    s_xor_b32 s56, s83, 12288
    buffer_load_dwordx4 v[32:35], v7, s[4:7], s56 offen offset:0 sc1
    ds_read_b64_tr_b16 v[88:89], v4 offset:40960
    v_mfma_f32_16x16x32_bf16 v[108:111], v[60:63], v[8:11], v[108:111]
    ds_read_b64_tr_b16 v[90:91], v4 offset:41472
    ds_read_b64_tr_b16 v[92:93], v5 offset:40960
    v_mfma_f32_16x16x32_bf16 v[112:115], v[64:67], v[8:11], v[112:115]
    ds_read_b64_tr_b16 v[94:95], v5 offset:41472
    ds_read_b64_tr_b16 v[96:97], v52 offset:40960
    ds_read_b64_tr_b16 v[98:99], v52 offset:41472
    v_mfma_f32_16x16x32_bf16 v[116:119], v[68:71], v[8:11], v[116:119]
    ds_read_b64_tr_b16 v[100:101], v120 offset:40960
    ds_read_b64_tr_b16 v[102:103], v120 offset:41472
    s_waitcnt vmcnt(5) lgkmcnt(15)
    v_mfma_f32_16x16x32_bf16 v[104:107], v[72:75], v[12:15], v[104:107]
    buffer_load_dwordx4 v[36:39], v7, s[4:7], s56 offen offset:2048 sc1
    ds_read_b64_tr_b16 v[56:57], v4 offset:45056
    ds_read_b64_tr_b16 v[58:59], v4 offset:45568
    v_mfma_f32_16x16x32_bf16 v[108:111], v[76:79], v[12:15], v[108:111]
    ds_read_b64_tr_b16 v[60:61], v5 offset:45056
    ds_read_b64_tr_b16 v[62:63], v5 offset:45568
    v_mfma_f32_16x16x32_bf16 v[112:115], v[80:83], v[12:15], v[112:115]
    ds_read_b64_tr_b16 v[64:65], v52 offset:45056
    ds_read_b64_tr_b16 v[66:67], v52 offset:45568
    v_mfma_f32_16x16x32_bf16 v[116:119], v[84:87], v[12:15], v[116:119]
    ds_read_b64_tr_b16 v[68:69], v120 offset:45056
    ds_read_b64_tr_b16 v[70:71], v120 offset:45568
    s_waitcnt vmcnt(5) lgkmcnt(15)
    v_mfma_f32_16x16x32_bf16 v[104:107], a[0:3], v[16:19], v[104:107]
    s_xor_b32 s56, s83, 16384
    buffer_load_dwordx4 v[40:43], v7, s[4:7], s56 offen offset:0 sc1
    ds_read_b64_tr_b16 v[72:73], v4 offset:49152
    v_mfma_f32_16x16x32_bf16 v[108:111], a[4:7], v[16:19], v[108:111]
    ds_read_b64_tr_b16 v[74:75], v4 offset:49664
    ds_read_b64_tr_b16 v[76:77], v5 offset:49152
    v_mfma_f32_16x16x32_bf16 v[112:115], a[8:11], v[16:19], v[112:115]
    ds_read_b64_tr_b16 v[78:79], v5 offset:49664
    ds_read_b64_tr_b16 v[80:81], v52 offset:49152
    ds_read_b64_tr_b16 v[82:83], v52 offset:49664
    v_mfma_f32_16x16x32_bf16 v[116:119], a[12:15], v[16:19], v[116:119]
    ds_read_b64_tr_b16 v[84:85], v120 offset:49152
    ds_read_b64_tr_b16 v[86:87], v120 offset:49664
    s_waitcnt vmcnt(5) lgkmcnt(15)
    v_mfma_f32_16x16x32_bf16 v[104:107], a[16:19], v[20:23], v[104:107]
    buffer_load_dwordx4 v[44:47], v7, s[4:7], s56 offen offset:2048 sc1
    ds_read_b64_tr_b16 a[0:1], v4 offset:53248
    ds_read_b64_tr_b16 a[2:3], v4 offset:53760
    v_mfma_f32_16x16x32_bf16 v[108:111], a[20:23], v[20:23], v[108:111]
    ds_read_b64_tr_b16 a[4:5], v5 offset:53248
    ds_read_b64_tr_b16 a[6:7], v5 offset:53760
    v_mfma_f32_16x16x32_bf16 v[112:115], a[24:27], v[20:23], v[112:115]
    ds_read_b64_tr_b16 a[8:9], v52 offset:53248
    ds_read_b64_tr_b16 a[10:11], v52 offset:53760
    v_mfma_f32_16x16x32_bf16 v[116:119], a[28:31], v[20:23], v[116:119]
    ds_read_b64_tr_b16 a[12:13], v120 offset:53248
    ds_read_b64_tr_b16 a[14:15], v120 offset:53760
    s_waitcnt vmcnt(5) lgkmcnt(15)
    v_mfma_f32_16x16x32_bf16 v[104:107], a[32:35], v[24:27], v[104:107]
    s_xor_b32 s56, s83, 20480
    buffer_load_dwordx4 v[48:51], v7, s[4:7], s56 offen offset:0 sc1
    ds_read_b64_tr_b16 a[16:17], v4 offset:57344
    v_mfma_f32_16x16x32_bf16 v[108:111], a[36:39], v[24:27], v[108:111]
    ds_read_b64_tr_b16 a[18:19], v4 offset:57856
    ds_read_b64_tr_b16 a[20:21], v5 offset:57344
    v_mfma_f32_16x16x32_bf16 v[112:115], a[40:43], v[24:27], v[112:115]
    ds_read_b64_tr_b16 a[22:23], v5 offset:57856
    ds_read_b64_tr_b16 a[24:25], v52 offset:57344
    ds_read_b64_tr_b16 a[26:27], v52 offset:57856
    v_mfma_f32_16x16x32_bf16 v[116:119], a[44:47], v[24:27], v[116:119]
    ds_read_b64_tr_b16 a[28:29], v120 offset:57344
    ds_read_b64_tr_b16 a[30:31], v120 offset:57856
    s_waitcnt vmcnt(5) lgkmcnt(15)
    v_mfma_f32_16x16x32_bf16 v[104:107], a[48:51], v[28:31], v[104:107]
    buffer_load_dwordx4 v[8:11], v7, s[4:7], s56 offen offset:2048 sc1
    ds_read_b64_tr_b16 a[32:33], v4 offset:61440
    ds_read_b64_tr_b16 a[34:35], v4 offset:61952
    v_mfma_f32_16x16x32_bf16 v[108:111], a[52:55], v[28:31], v[108:111]
    ds_read_b64_tr_b16 a[36:37], v5 offset:61440
    ds_read_b64_tr_b16 a[38:39], v5 offset:61952
    v_mfma_f32_16x16x32_bf16 v[112:115], a[56:59], v[28:31], v[112:115]
    ds_read_b64_tr_b16 a[40:41], v52 offset:61440
    ds_read_b64_tr_b16 a[42:43], v52 offset:61952
    v_mfma_f32_16x16x32_bf16 v[116:119], a[60:63], v[28:31], v[116:119]
    ds_read_b64_tr_b16 a[44:45], v120 offset:61440
    ds_read_b64_tr_b16 a[46:47], v120 offset:61952
    s_waitcnt vmcnt(5) lgkmcnt(15)
    v_mfma_f32_16x16x32_bf16 v[104:107], a[64:67], v[32:35], v[104:107]
    s_xor_b32 s56, s83, 24576
    v_mfma_f32_16x16x32_bf16 v[108:111], a[68:71], v[32:35], v[108:111]
    v_mfma_f32_16x16x32_bf16 v[112:115], a[72:75], v[32:35], v[112:115]
    buffer_load_dwordx4 v[12:15], v7, s[4:7], s56 offen offset:0 sc1
    v_mfma_f32_16x16x32_bf16 v[116:119], a[76:79], v[32:35], v[116:119]
    s_waitcnt vmcnt(5) lgkmcnt(15)
    v_mfma_f32_16x16x32_bf16 v[104:107], a[80:83], v[36:39], v[104:107]
    buffer_load_dwordx4 v[16:19], v7, s[4:7], s56 offen offset:2048 sc1
    v_mfma_f32_16x16x32_bf16 v[108:111], a[84:87], v[36:39], v[108:111]
    v_mfma_f32_16x16x32_bf16 v[112:115], a[88:91], v[36:39], v[112:115]
    v_mfma_f32_16x16x32_bf16 v[116:119], a[92:95], v[36:39], v[116:119]
    s_waitcnt vmcnt(5) lgkmcnt(15)
    v_mfma_f32_16x16x32_bf16 v[104:107], a[96:99], v[40:43], v[104:107]
    s_xor_b32 s56, s83, 28672
    v_mfma_f32_16x16x32_bf16 v[108:111], a[100:103], v[40:43], v[108:111]
    v_mfma_f32_16x16x32_bf16 v[112:115], a[104:107], v[40:43], v[112:115]
    buffer_load_dwordx4 v[20:23], v7, s[4:7], s56 offen offset:0 sc1
    v_mfma_f32_16x16x32_bf16 v[116:119], a[108:111], v[40:43], v[116:119]
    s_waitcnt vmcnt(5) lgkmcnt(15)
    v_mfma_f32_16x16x32_bf16 v[104:107], a[112:115], v[44:47], v[104:107]
    buffer_load_dwordx4 v[24:27], v7, s[4:7], s56 offen offset:2048 sc1
    v_mfma_f32_16x16x32_bf16 v[108:111], a[116:119], v[44:47], v[108:111]
    v_mfma_f32_16x16x32_bf16 v[112:115], a[120:123], v[44:47], v[112:115]
    v_mfma_f32_16x16x32_bf16 v[116:119], a[124:127], v[44:47], v[116:119]
    s_waitcnt vmcnt(5) lgkmcnt(15)
    v_mfma_f32_16x16x32_bf16 v[104:107], v[88:91], v[48:51], v[104:107]
    v_mfma_f32_16x16x32_bf16 v[108:111], v[92:95], v[48:51], v[108:111]
    v_mfma_f32_16x16x32_bf16 v[112:115], v[96:99], v[48:51], v[112:115]
    v_mfma_f32_16x16x32_bf16 v[116:119], v[100:103], v[48:51], v[116:119]
    s_waitcnt vmcnt(4) lgkmcnt(15)
    v_mfma_f32_16x16x32_bf16 v[104:107], v[56:59], v[8:11], v[104:107]
    v_mfma_f32_16x16x32_bf16 v[108:111], v[60:63], v[8:11], v[108:111]
    v_mfma_f32_16x16x32_bf16 v[112:115], v[64:67], v[8:11], v[112:115]
    v_mfma_f32_16x16x32_bf16 v[116:119], v[68:71], v[8:11], v[116:119]
    s_waitcnt vmcnt(3) lgkmcnt(15)
    v_mfma_f32_16x16x32_bf16 v[104:107], v[72:75], v[12:15], v[104:107]
    v_mfma_f32_16x16x32_bf16 v[108:111], v[76:79], v[12:15], v[108:111]
    v_mfma_f32_16x16x32_bf16 v[112:115], v[80:83], v[12:15], v[112:115]
    v_mfma_f32_16x16x32_bf16 v[116:119], v[84:87], v[12:15], v[116:119]
    s_waitcnt vmcnt(2) lgkmcnt(15)
    v_mfma_f32_16x16x32_bf16 v[104:107], a[0:3], v[16:19], v[104:107]
    v_mfma_f32_16x16x32_bf16 v[108:111], a[4:7], v[16:19], v[108:111]
    s_waitcnt vmcnt(1) lgkmcnt(8)
    v_mfma_f32_16x16x32_bf16 v[104:107], a[16:19], v[20:23], v[104:107]
    v_mfma_f32_16x16x32_bf16 v[108:111], a[20:23], v[20:23], v[108:111]
    s_waitcnt vmcnt(0) lgkmcnt(0)
    v_mfma_f32_16x16x32_bf16 v[104:107], a[32:35], v[24:27], v[104:107]
    v_mfma_f32_16x16x32_bf16 v[108:111], a[36:39], v[24:27], v[108:111]
    v_mfma_f32_16x16x32_bf16 v[112:115], a[8:11], v[16:19], v[112:115]
    v_mfma_f32_16x16x32_bf16 v[116:119], a[12:15], v[16:19], v[116:119]
    s_nop 4
    v_cvt_pk_bf16_f32 v40, v104, v105
    v_cvt_pk_bf16_f32 v41, v106, v107
    v_mfma_f32_16x16x32_bf16 v[112:115], a[24:27], v[20:23], v[112:115]
    v_cvt_pk_bf16_f32 v42, v108, v109
    v_mfma_f32_16x16x32_bf16 v[116:119], a[28:31], v[20:23], v[116:119]
    v_cvt_pk_bf16_f32 v43, v110, v111
    v_permlane16_swap_b32 v40, v42
    v_mfma_f32_16x16x32_bf16 v[112:115], a[40:43], v[24:27], v[112:115]
    v_permlane16_swap_b32 v41, v43
    v_mfma_f32_16x16x32_bf16 v[116:119], a[44:47], v[24:27], v[116:119]
    buffer_store_dwordx4 v[40:43], v121, s[12:15], s84 offen offset:0
    s_nop 4
    v_cvt_pk_bf16_f32 v60, v112, v113
    v_cvt_pk_bf16_f32 v61, v114, v115
    v_cvt_pk_bf16_f32 v62, v116, v117
    v_cvt_pk_bf16_f32 v63, v118, v119
    s_nop 0
    v_permlane16_swap_b32 v60, v62
    v_permlane16_swap_b32 v61, v63
    buffer_store_dwordx4 v[60:63], v121, s[12:15], s84 offen offset:64
    s_endpgm
L_fin:
L_exit:
    s_endpgm
z_10:
    v_mov_b32 v20, 158224
    v_mov_b32 v21, 158224
    v_mov_b32 v22, 158224
    s_nop 0
    s_branch z_10_b
z_13:
    v_mov_b32 v20, 158224
    v_mov_b32 v21, 158224
    v_mov_b32 v22, 158224
    s_nop 0
    s_branch z_13_b
z_16:
    v_mov_b32 v20, 158224
    v_mov_b32 v21, 158224
    v_mov_b32 v22, 158224
    s_nop 0
    s_branch z_16_b
z_17:
    v_mov_b32 v20, 158224
    v_mov_b32 v21, 158224
    v_mov_b32 v22, 158224
    s_nop 0
    s_branch z_17_b
z_18:
    v_mov_b32 v20, 158224
    v_mov_b32 v21, 158224
    v_mov_b32 v22, 158224
    s_nop 0
    s_branch z_18_b
z_21:
    v_mov_b32 v20, 158224
    v_mov_b32 v21, 158224
    v_mov_b32 v22, 158224
    s_nop 0
    s_branch z_21_b
z_22:
    v_mov_b32 v20, 158224
    v_mov_b32 v21, 158224
    v_mov_b32 v22, 158224
    s_nop 0
    s_branch z_22_b
L_pfend:
sig_4_s:
    buffer_store_dword v6, off, s[4:7], s47 sc1
    s_branch sig_4
st_23_s:
    s_nop 7
    buffer_store_dwordx4 v[104:107], v120, s[4:7], s75 offen sc1
    s_nop 0
    s_branch st_23
st_24_s:
    s_nop 7
    buffer_store_dwordx4 v[100:103], v120, s[4:7], s74 offen sc1
    s_nop 0
    s_branch st_24
aa_5_s1:
    s_lshl_b32 s55, s40, 1
    s_add_u32 s55, s55, 1
    s_sub_i32 s50, s55, 8
    s_max_i32 s51, s50, 0
    v_mov_b32 v44, 0x3f803f80
    v_mov_b32 v45, 0x3f803f80
    v_mov_b32 v46, 0x3f803f80
    v_mov_b32 v47, 0x3f803f80
    v_mov_b32 v48, 0x3f803f80
    v_mov_b32 v49, 0x3f803f80
    v_mov_b32 v50, 0x3f803f80
    v_mov_b32 v51, 0x3f803f80
    v_lshlrev_b32 v6, 1, v2
    v_bfe_u32 v7, v1, 4, 1
    v_add_u32 v6, v6, v7
    v_lshrrev_b32 v7, 5, v1
    v_lshlrev_b32 v7, 3, v7
    v_sub_u32 v40, v6, v7
    v_mov_b32 v4, 0xff800000
    s_mov_b32 s56, s51
aa_5_s1_m:
    s_lshl_b32 s49, s40, 12
    s_sub_u32 s48, s73, s49
    s_lshl_b32 s49, s56, 11
    s_add_u32 s48, s48, s49
    buffer_load_dwordx4 v[12:15], v0, s[4:7], s48 offen sc1
    s_mov_b64 exec, s[94:95]
    buffer_load_dwordx4 v[44:47], v0, s[4:7], s48 offen offset:1024 sc1
    buffer_load_dwordx4 v[48:51], v0, s[4:7], s48 offen offset:1280 sc1
    s_mov_b64 exec, -1
    s_waitcnt vmcnt(0)
    v_mfma_f32_32x32x16_bf16 v[68:83], v[12:15], v[16:19], 0
    v_mov_b32 v7, 0xff800000
    s_cmp_lg_u32 s56, s55
    s_nop 8
    s_cbranch_scc1 aa_5_s1_mm_a
    v_cmp_le_i32 s[48:49], 0, v40
    s_nop 1
    v_cndmask_b32 v68, v7, v68, s[48:49]
    v_cmp_le_i32 s[48:49], 2, v40
    s_nop 1
    v_cndmask_b32 v69, v7, v69, s[48:49]
    v_cmp_le_i32 s[48:49], 4, v40
    s_nop 1
    v_cndmask_b32 v70, v7, v70, s[48:49]
    v_cmp_le_i32 s[48:49], 6, v40
    s_nop 1
    v_cndmask_b32 v71, v7, v71, s[48:49]
    v_cmp_le_i32 s[48:49], 16, v40
    s_nop 1
    v_cndmask_b32 v72, v7, v72, s[48:49]
    v_cmp_le_i32 s[48:49], 18, v40
    s_nop 1
    v_cndmask_b32 v73, v7, v73, s[48:49]
    v_cmp_le_i32 s[48:49], 20, v40
    s_nop 1
    v_cndmask_b32 v74, v7, v74, s[48:49]
    v_cmp_le_i32 s[48:49], 22, v40
    s_nop 1
    v_cndmask_b32 v75, v7, v75, s[48:49]
    v_cmp_le_i32 s[48:49], 1, v40
    s_nop 1
    v_cndmask_b32 v76, v7, v76, s[48:49]
    v_cmp_le_i32 s[48:49], 3, v40
    s_nop 1
    v_cndmask_b32 v77, v7, v77, s[48:49]
    v_cmp_le_i32 s[48:49], 5, v40
    s_nop 1
    v_cndmask_b32 v78, v7, v78, s[48:49]
    v_cmp_le_i32 s[48:49], 7, v40
    s_nop 1
    v_cndmask_b32 v79, v7, v79, s[48:49]
    v_cmp_le_i32 s[48:49], 17, v40
    s_nop 1
    v_cndmask_b32 v80, v7, v80, s[48:49]
    v_cmp_le_i32 s[48:49], 19, v40
    s_nop 1
    v_cndmask_b32 v81, v7, v81, s[48:49]
    v_cmp_le_i32 s[48:49], 21, v40
    s_nop 1
    v_cndmask_b32 v82, v7, v82, s[48:49]
    v_cmp_le_i32 s[48:49], 23, v40
    s_nop 1
    v_cndmask_b32 v83, v7, v83, s[48:49]
aa_5_s1_mm_a:
    s_cmp_lg_u32 s56, s50
    s_cbranch_scc1 aa_5_s1_mm_b
    v_cmp_le_i32 s[48:49], 0, v40
    s_nop 1
    v_cndmask_b32 v68, v68, v7, s[48:49]
    v_cmp_le_i32 s[48:49], 2, v40
    s_nop 1
    v_cndmask_b32 v69, v69, v7, s[48:49]
    v_cmp_le_i32 s[48:49], 4, v40
    s_nop 1
    v_cndmask_b32 v70, v70, v7, s[48:49]
    v_cmp_le_i32 s[48:49], 6, v40
    s_nop 1
    v_cndmask_b32 v71, v71, v7, s[48:49]
    v_cmp_le_i32 s[48:49], 16, v40
    s_nop 1
    v_cndmask_b32 v72, v72, v7, s[48:49]
    v_cmp_le_i32 s[48:49], 18, v40
    s_nop 1
    v_cndmask_b32 v73, v73, v7, s[48:49]
    v_cmp_le_i32 s[48:49], 20, v40
    s_nop 1
    v_cndmask_b32 v74, v74, v7, s[48:49]
    v_cmp_le_i32 s[48:49], 22, v40
    s_nop 1
    v_cndmask_b32 v75, v75, v7, s[48:49]
    v_cmp_le_i32 s[48:49], 1, v40
    s_nop 1
    v_cndmask_b32 v76, v76, v7, s[48:49]
    v_cmp_le_i32 s[48:49], 3, v40
    s_nop 1
    v_cndmask_b32 v77, v77, v7, s[48:49]
    v_cmp_le_i32 s[48:49], 5, v40
    s_nop 1
    v_cndmask_b32 v78, v78, v7, s[48:49]
    v_cmp_le_i32 s[48:49], 7, v40
    s_nop 1
    v_cndmask_b32 v79, v79, v7, s[48:49]
    v_cmp_le_i32 s[48:49], 17, v40
    s_nop 1
    v_cndmask_b32 v80, v80, v7, s[48:49]
    v_cmp_le_i32 s[48:49], 19, v40
    s_nop 1
    v_cndmask_b32 v81, v81, v7, s[48:49]
    v_cmp_le_i32 s[48:49], 21, v40
    s_nop 1
    v_cndmask_b32 v82, v82, v7, s[48:49]
    v_cmp_le_i32 s[48:49], 23, v40
    s_nop 1
    v_cndmask_b32 v83, v83, v7, s[48:49]
aa_5_s1_mm_b:
    v_max3_f32 v4, v4, v68, v69
    v_max3_f32 v4, v4, v70, v71
    v_max3_f32 v4, v4, v72, v73
    v_max3_f32 v4, v4, v74, v75
    v_max3_f32 v4, v4, v76, v77
    v_max3_f32 v4, v4, v78, v79
    v_max3_f32 v4, v4, v80, v81
    v_max3_f32 v4, v4, v82, v83
    s_add_u32 s56, s56, 1
    s_cmp_le_u32 s56, s55
    s_cbranch_scc1 aa_5_s1_m
    v_mov_b32 v7, v4
    s_nop 1
    v_permlane32_swap_b32 v4, v7
    v_max_f32 v4, v4, v7
    v_mov_b32 v24, 0
    v_mov_b32 v25, 0
    v_mov_b32 v26, 0
    v_mov_b32 v27, 0
    v_mov_b32 v28, 0
    v_mov_b32 v29, 0
    v_mov_b32 v30, 0
    v_mov_b32 v31, 0
    v_mov_b32 v32, 0
    v_mov_b32 v33, 0
    v_mov_b32 v34, 0
    v_mov_b32 v35, 0
    v_mov_b32 v36, 0
    v_mov_b32 v37, 0
    v_mov_b32 v38, 0
    v_mov_b32 v39, 0
    s_mov_b32 s56, s51
aa_5_s1_p:
    s_lshl_b32 s49, s40, 12
    s_sub_u32 s48, s73, s49
    s_lshl_b32 s49, s56, 11
    s_add_u32 s48, s48, s49
    buffer_load_dwordx4 v[12:15], v0, s[4:7], s48 offen sc1
    s_mov_b64 exec, s[94:95]
    buffer_load_dwordx4 v[44:47], v0, s[4:7], s48 offen offset:1024 sc1
    buffer_load_dwordx4 v[48:51], v0, s[4:7], s48 offen offset:1280 sc1
    s_mov_b64 exec, -1
    s_waitcnt vmcnt(0)
    v_mfma_f32_32x32x16_bf16 v[68:83], v[12:15], v[16:19], 0
    v_mov_b32 v7, 0xff800000
    s_cmp_lg_u32 s56, s55
    s_nop 8
    s_cbranch_scc1 aa_5_s1_pm_a
    v_cmp_le_i32 s[48:49], 0, v40
    s_nop 1
    v_cndmask_b32 v68, v7, v68, s[48:49]
    v_cmp_le_i32 s[48:49], 2, v40
    s_nop 1
    v_cndmask_b32 v69, v7, v69, s[48:49]
    v_cmp_le_i32 s[48:49], 4, v40
    s_nop 1
    v_cndmask_b32 v70, v7, v70, s[48:49]
    v_cmp_le_i32 s[48:49], 6, v40
    s_nop 1
    v_cndmask_b32 v71, v7, v71, s[48:49]
    v_cmp_le_i32 s[48:49], 16, v40
    s_nop 1
    v_cndmask_b32 v72, v7, v72, s[48:49]
    v_cmp_le_i32 s[48:49], 18, v40
    s_nop 1
    v_cndmask_b32 v73, v7, v73, s[48:49]
    v_cmp_le_i32 s[48:49], 20, v40
    s_nop 1
    v_cndmask_b32 v74, v7, v74, s[48:49]
    v_cmp_le_i32 s[48:49], 22, v40
    s_nop 1
    v_cndmask_b32 v75, v7, v75, s[48:49]
    v_cmp_le_i32 s[48:49], 1, v40
    s_nop 1
    v_cndmask_b32 v76, v7, v76, s[48:49]
    v_cmp_le_i32 s[48:49], 3, v40
    s_nop 1
    v_cndmask_b32 v77, v7, v77, s[48:49]
    v_cmp_le_i32 s[48:49], 5, v40
    s_nop 1
    v_cndmask_b32 v78, v7, v78, s[48:49]
    v_cmp_le_i32 s[48:49], 7, v40
    s_nop 1
    v_cndmask_b32 v79, v7, v79, s[48:49]
    v_cmp_le_i32 s[48:49], 17, v40
    s_nop 1
    v_cndmask_b32 v80, v7, v80, s[48:49]
    v_cmp_le_i32 s[48:49], 19, v40
    s_nop 1
    v_cndmask_b32 v81, v7, v81, s[48:49]
    v_cmp_le_i32 s[48:49], 21, v40
    s_nop 1
    v_cndmask_b32 v82, v7, v82, s[48:49]
    v_cmp_le_i32 s[48:49], 23, v40
    s_nop 1
    v_cndmask_b32 v83, v7, v83, s[48:49]
aa_5_s1_pm_a:
    s_cmp_lg_u32 s56, s50
    s_cbranch_scc1 aa_5_s1_pm_b
    v_cmp_le_i32 s[48:49], 0, v40
    s_nop 1
    v_cndmask_b32 v68, v68, v7, s[48:49]
    v_cmp_le_i32 s[48:49], 2, v40
    s_nop 1
    v_cndmask_b32 v69, v69, v7, s[48:49]
    v_cmp_le_i32 s[48:49], 4, v40
    s_nop 1
    v_cndmask_b32 v70, v70, v7, s[48:49]
    v_cmp_le_i32 s[48:49], 6, v40
    s_nop 1
    v_cndmask_b32 v71, v71, v7, s[48:49]
    v_cmp_le_i32 s[48:49], 16, v40
    s_nop 1
    v_cndmask_b32 v72, v72, v7, s[48:49]
    v_cmp_le_i32 s[48:49], 18, v40
    s_nop 1
    v_cndmask_b32 v73, v73, v7, s[48:49]
    v_cmp_le_i32 s[48:49], 20, v40
    s_nop 1
    v_cndmask_b32 v74, v74, v7, s[48:49]
    v_cmp_le_i32 s[48:49], 22, v40
    s_nop 1
    v_cndmask_b32 v75, v75, v7, s[48:49]
    v_cmp_le_i32 s[48:49], 1, v40
    s_nop 1
    v_cndmask_b32 v76, v76, v7, s[48:49]
    v_cmp_le_i32 s[48:49], 3, v40
    s_nop 1
    v_cndmask_b32 v77, v77, v7, s[48:49]
    v_cmp_le_i32 s[48:49], 5, v40
    s_nop 1
    v_cndmask_b32 v78, v78, v7, s[48:49]
    v_cmp_le_i32 s[48:49], 7, v40
    s_nop 1
    v_cndmask_b32 v79, v79, v7, s[48:49]
    v_cmp_le_i32 s[48:49], 17, v40
    s_nop 1
    v_cndmask_b32 v80, v80, v7, s[48:49]
    v_cmp_le_i32 s[48:49], 19, v40
    s_nop 1
    v_cndmask_b32 v81, v81, v7, s[48:49]
    v_cmp_le_i32 s[48:49], 21, v40
    s_nop 1
    v_cndmask_b32 v82, v82, v7, s[48:49]
    v_cmp_le_i32 s[48:49], 23, v40
    s_nop 1
    v_cndmask_b32 v83, v83, v7, s[48:49]
aa_5_s1_pm_b:
    v_sub_f32 v68, v68, v4
    v_sub_f32 v69, v69, v4
    v_sub_f32 v70, v70, v4
    v_sub_f32 v71, v71, v4
    v_sub_f32 v72, v72, v4
    v_sub_f32 v73, v73, v4
    v_sub_f32 v74, v74, v4
    v_sub_f32 v75, v75, v4
    v_sub_f32 v76, v76, v4
    v_sub_f32 v77, v77, v4
    v_sub_f32 v78, v78, v4
    v_sub_f32 v79, v79, v4
    v_sub_f32 v80, v80, v4
    v_sub_f32 v81, v81, v4
    v_sub_f32 v82, v82, v4
    v_sub_f32 v83, v83, v4
    v_exp_f32 v68, v68
    v_exp_f32 v69, v69
    v_exp_f32 v70, v70
    v_exp_f32 v71, v71
    v_exp_f32 v72, v72
    v_exp_f32 v73, v73
    v_exp_f32 v74, v74
    v_exp_f32 v75, v75
    v_exp_f32 v76, v76
    v_exp_f32 v77, v77
    v_exp_f32 v78, v78
    v_exp_f32 v79, v79
    v_exp_f32 v80, v80
    v_exp_f32 v81, v81
    v_exp_f32 v82, v82
    v_exp_f32_e64 v83, v83
    v_cvt_pk_bf16_f32 v100, v68, v69
    v_cvt_pk_bf16_f32 v101, v70, v71
    v_cvt_pk_bf16_f32 v102, v72, v73
    v_cvt_pk_bf16_f32 v103, v74, v75
    v_cvt_pk_bf16_f32 v104, v76, v77
    v_cvt_pk_bf16_f32 v105, v78, v79
    v_cvt_pk_bf16_f32 v106, v80, v81
    v_cvt_pk_bf16_f32 v107, v82, v83
    v_mfma_f32_32x32x16_bf16 v[24:39], v[44:47], v[100:103], v[24:39]
    s_nop 0
    v_mfma_f32_32x32x16_bf16 v[24:39], v[48:51], v[104:107], v[24:39]
    s_add_u32 s56, s56, 1
    s_cmp_le_u32 s56, s55
    s_nop 8
    s_cbranch_scc1 aa_5_s1_p
    v_rcp_f32_e64 v32, v32
    s_nop 0
    v_pk_mul_f32 v[24:25], v[24:25], v[32:33] op_sel:[0,0] op_sel_hi:[1,0]
    v_pk_mul_f32 v[26:27], v[26:27], v[32:33] op_sel:[0,0] op_sel_hi:[1,0]
    v_pk_mul_f32 v[28:29], v[28:29], v[32:33] op_sel:[0,0] op_sel_hi:[1,0]
    v_pk_mul_f32 v[30:31], v[30:31], v[32:33] op_sel:[0,0] op_sel_hi:[1,0]
    v_cvt_pk_bf16_f32 v104, v24, v25
    v_cvt_pk_bf16_f32 v105, v26, v27
    v_cvt_pk_bf16_f32 v106, v28, v29
    v_cvt_pk_bf16_f32 v107, v30, v31
    s_nop 0
    v_permlane32_swap_b32 v104, v106
    v_permlane32_swap_b32 v105, v107
    s_cmp_lg_u32 s42, 0
    s_cbranch_scc0 st_70_s
    buffer_store_dwordx4 v[104:107], v120, s[4:7], s75 offen
st_70:
    s_nop 7
    s_branch aa_5_ok1
aa_5_s0:
    s_lshl_b32 s55, s40, 1
    s_sub_i32 s50, s55, 8
    s_max_i32 s51, s50, 0
    v_mov_b32 v44, 0x3f803f80
    v_mov_b32 v45, 0x3f803f80
    v_mov_b32 v46, 0x3f803f80
    v_mov_b32 v47, 0x3f803f80
    v_mov_b32 v48, 0x3f803f80
    v_mov_b32 v49, 0x3f803f80
    v_mov_b32 v50, 0x3f803f80
    v_mov_b32 v51, 0x3f803f80
    v_lshlrev_b32 v6, 1, v2
    v_bfe_u32 v7, v1, 4, 1
    v_add_u32 v6, v6, v7
    v_lshrrev_b32 v7, 5, v1
    v_lshlrev_b32 v7, 3, v7
    v_sub_u32 v40, v6, v7
    v_mov_b32 v4, 0xff800000
    s_mov_b32 s56, s51
aa_5_s0_m:
    s_lshl_b32 s49, s40, 12
    s_sub_u32 s48, s73, s49
    s_lshl_b32 s49, s56, 11
    s_add_u32 s48, s48, s49
    buffer_load_dwordx4 v[12:15], v0, s[4:7], s48 offen sc1
    s_mov_b64 exec, s[94:95]
    buffer_load_dwordx4 v[44:47], v0, s[4:7], s48 offen offset:1024 sc1
    buffer_load_dwordx4 v[48:51], v0, s[4:7], s48 offen offset:1280 sc1
    s_mov_b64 exec, -1
    s_waitcnt vmcnt(0)
    v_mfma_f32_32x32x16_bf16 v[68:83], v[12:15], v[8:11], 0
    v_mov_b32 v7, 0xff800000
    s_cmp_lg_u32 s56, s55
    s_nop 8
    s_cbranch_scc1 aa_5_s0_mm_a
    v_cmp_le_i32 s[48:49], 0, v40
    s_nop 1
    v_cndmask_b32 v68, v7, v68, s[48:49]
    v_cmp_le_i32 s[48:49], 2, v40
    s_nop 1
    v_cndmask_b32 v69, v7, v69, s[48:49]
    v_cmp_le_i32 s[48:49], 4, v40
    s_nop 1
    v_cndmask_b32 v70, v7, v70, s[48:49]
    v_cmp_le_i32 s[48:49], 6, v40
    s_nop 1
    v_cndmask_b32 v71, v7, v71, s[48:49]
    v_cmp_le_i32 s[48:49], 16, v40
    s_nop 1
    v_cndmask_b32 v72, v7, v72, s[48:49]
    v_cmp_le_i32 s[48:49], 18, v40
    s_nop 1
    v_cndmask_b32 v73, v7, v73, s[48:49]
    v_cmp_le_i32 s[48:49], 20, v40
    s_nop 1
    v_cndmask_b32 v74, v7, v74, s[48:49]
    v_cmp_le_i32 s[48:49], 22, v40
    s_nop 1
    v_cndmask_b32 v75, v7, v75, s[48:49]
    v_cmp_le_i32 s[48:49], 1, v40
    s_nop 1
    v_cndmask_b32 v76, v7, v76, s[48:49]
    v_cmp_le_i32 s[48:49], 3, v40
    s_nop 1
    v_cndmask_b32 v77, v7, v77, s[48:49]
    v_cmp_le_i32 s[48:49], 5, v40
    s_nop 1
    v_cndmask_b32 v78, v7, v78, s[48:49]
    v_cmp_le_i32 s[48:49], 7, v40
    s_nop 1
    v_cndmask_b32 v79, v7, v79, s[48:49]
    v_cmp_le_i32 s[48:49], 17, v40
    s_nop 1
    v_cndmask_b32 v80, v7, v80, s[48:49]
    v_cmp_le_i32 s[48:49], 19, v40
    s_nop 1
    v_cndmask_b32 v81, v7, v81, s[48:49]
    v_cmp_le_i32 s[48:49], 21, v40
    s_nop 1
    v_cndmask_b32 v82, v7, v82, s[48:49]
    v_cmp_le_i32 s[48:49], 23, v40
    s_nop 1
    v_cndmask_b32 v83, v7, v83, s[48:49]
aa_5_s0_mm_a:
    s_cmp_lg_u32 s56, s50
    s_cbranch_scc1 aa_5_s0_mm_b
    v_cmp_le_i32 s[48:49], 0, v40
    s_nop 1
    v_cndmask_b32 v68, v68, v7, s[48:49]
    v_cmp_le_i32 s[48:49], 2, v40
    s_nop 1
    v_cndmask_b32 v69, v69, v7, s[48:49]
    v_cmp_le_i32 s[48:49], 4, v40
    s_nop 1
    v_cndmask_b32 v70, v70, v7, s[48:49]
    v_cmp_le_i32 s[48:49], 6, v40
    s_nop 1
    v_cndmask_b32 v71, v71, v7, s[48:49]
    v_cmp_le_i32 s[48:49], 16, v40
    s_nop 1
    v_cndmask_b32 v72, v72, v7, s[48:49]
    v_cmp_le_i32 s[48:49], 18, v40
    s_nop 1
    v_cndmask_b32 v73, v73, v7, s[48:49]
    v_cmp_le_i32 s[48:49], 20, v40
    s_nop 1
    v_cndmask_b32 v74, v74, v7, s[48:49]
    v_cmp_le_i32 s[48:49], 22, v40
    s_nop 1
    v_cndmask_b32 v75, v75, v7, s[48:49]
    v_cmp_le_i32 s[48:49], 1, v40
    s_nop 1
    v_cndmask_b32 v76, v76, v7, s[48:49]
    v_cmp_le_i32 s[48:49], 3, v40
    s_nop 1
    v_cndmask_b32 v77, v77, v7, s[48:49]
    v_cmp_le_i32 s[48:49], 5, v40
    s_nop 1
    v_cndmask_b32 v78, v78, v7, s[48:49]
    v_cmp_le_i32 s[48:49], 7, v40
    s_nop 1
    v_cndmask_b32 v79, v79, v7, s[48:49]
    v_cmp_le_i32 s[48:49], 17, v40
    s_nop 1
    v_cndmask_b32 v80, v80, v7, s[48:49]
    v_cmp_le_i32 s[48:49], 19, v40
    s_nop 1
    v_cndmask_b32 v81, v81, v7, s[48:49]
    v_cmp_le_i32 s[48:49], 21, v40
    s_nop 1
    v_cndmask_b32 v82, v82, v7, s[48:49]
    v_cmp_le_i32 s[48:49], 23, v40
    s_nop 1
    v_cndmask_b32 v83, v83, v7, s[48:49]
aa_5_s0_mm_b:
    v_max3_f32 v4, v4, v68, v69
    v_max3_f32 v4, v4, v70, v71
    v_max3_f32 v4, v4, v72, v73
    v_max3_f32 v4, v4, v74, v75
    v_max3_f32 v4, v4, v76, v77
    v_max3_f32 v4, v4, v78, v79
    v_max3_f32 v4, v4, v80, v81
    v_max3_f32 v4, v4, v82, v83
    s_add_u32 s56, s56, 1
    s_cmp_le_u32 s56, s55
    s_cbranch_scc1 aa_5_s0_m
    v_mov_b32 v7, v4
    s_nop 1
    v_permlane32_swap_b32 v4, v7
    v_max_f32 v4, v4, v7
    v_mov_b32 v52, 0
    v_mov_b32 v53, 0
    v_mov_b32 v54, 0
    v_mov_b32 v55, 0
    v_mov_b32 v56, 0
    v_mov_b32 v57, 0
    v_mov_b32 v58, 0
    v_mov_b32 v59, 0
    v_mov_b32 v60, 0
    v_mov_b32 v61, 0
    v_mov_b32 v62, 0
    v_mov_b32 v63, 0
    v_mov_b32 v64, 0
    v_mov_b32 v65, 0
    v_mov_b32 v66, 0
    v_mov_b32 v67, 0
    s_mov_b32 s56, s51
aa_5_s0_p:
    s_lshl_b32 s49, s40, 12
    s_sub_u32 s48, s73, s49
    s_lshl_b32 s49, s56, 11
    s_add_u32 s48, s48, s49
    buffer_load_dwordx4 v[12:15], v0, s[4:7], s48 offen sc1
    s_mov_b64 exec, s[94:95]
    buffer_load_dwordx4 v[44:47], v0, s[4:7], s48 offen offset:1024 sc1
    buffer_load_dwordx4 v[48:51], v0, s[4:7], s48 offen offset:1280 sc1
    s_mov_b64 exec, -1
    s_waitcnt vmcnt(0)
    v_mfma_f32_32x32x16_bf16 v[68:83], v[12:15], v[8:11], 0
    v_mov_b32 v7, 0xff800000
    s_cmp_lg_u32 s56, s55
    s_nop 8
    s_cbranch_scc1 aa_5_s0_pm_a
    v_cmp_le_i32 s[48:49], 0, v40
    s_nop 1
    v_cndmask_b32 v68, v7, v68, s[48:49]
    v_cmp_le_i32 s[48:49], 2, v40
    s_nop 1
    v_cndmask_b32 v69, v7, v69, s[48:49]
    v_cmp_le_i32 s[48:49], 4, v40
    s_nop 1
    v_cndmask_b32 v70, v7, v70, s[48:49]
    v_cmp_le_i32 s[48:49], 6, v40
    s_nop 1
    v_cndmask_b32 v71, v7, v71, s[48:49]
    v_cmp_le_i32 s[48:49], 16, v40
    s_nop 1
    v_cndmask_b32 v72, v7, v72, s[48:49]
    v_cmp_le_i32 s[48:49], 18, v40
    s_nop 1
    v_cndmask_b32 v73, v7, v73, s[48:49]
    v_cmp_le_i32 s[48:49], 20, v40
    s_nop 1
    v_cndmask_b32 v74, v7, v74, s[48:49]
    v_cmp_le_i32 s[48:49], 22, v40
    s_nop 1
    v_cndmask_b32 v75, v7, v75, s[48:49]
    v_cmp_le_i32 s[48:49], 1, v40
    s_nop 1
    v_cndmask_b32 v76, v7, v76, s[48:49]
    v_cmp_le_i32 s[48:49], 3, v40
    s_nop 1
    v_cndmask_b32 v77, v7, v77, s[48:49]
    v_cmp_le_i32 s[48:49], 5, v40
    s_nop 1
    v_cndmask_b32 v78, v7, v78, s[48:49]
    v_cmp_le_i32 s[48:49], 7, v40
    s_nop 1
    v_cndmask_b32 v79, v7, v79, s[48:49]
    v_cmp_le_i32 s[48:49], 17, v40
    s_nop 1
    v_cndmask_b32 v80, v7, v80, s[48:49]
    v_cmp_le_i32 s[48:49], 19, v40
    s_nop 1
    v_cndmask_b32 v81, v7, v81, s[48:49]
    v_cmp_le_i32 s[48:49], 21, v40
    s_nop 1
    v_cndmask_b32 v82, v7, v82, s[48:49]
    v_cmp_le_i32 s[48:49], 23, v40
    s_nop 1
    v_cndmask_b32 v83, v7, v83, s[48:49]
aa_5_s0_pm_a:
    s_cmp_lg_u32 s56, s50
    s_cbranch_scc1 aa_5_s0_pm_b
    v_cmp_le_i32 s[48:49], 0, v40
    s_nop 1
    v_cndmask_b32 v68, v68, v7, s[48:49]
    v_cmp_le_i32 s[48:49], 2, v40
    s_nop 1
    v_cndmask_b32 v69, v69, v7, s[48:49]
    v_cmp_le_i32 s[48:49], 4, v40
    s_nop 1
    v_cndmask_b32 v70, v70, v7, s[48:49]
    v_cmp_le_i32 s[48:49], 6, v40
    s_nop 1
    v_cndmask_b32 v71, v71, v7, s[48:49]
    v_cmp_le_i32 s[48:49], 16, v40
    s_nop 1
    v_cndmask_b32 v72, v72, v7, s[48:49]
    v_cmp_le_i32 s[48:49], 18, v40
    s_nop 1
    v_cndmask_b32 v73, v73, v7, s[48:49]
    v_cmp_le_i32 s[48:49], 20, v40
    s_nop 1
    v_cndmask_b32 v74, v74, v7, s[48:49]
    v_cmp_le_i32 s[48:49], 22, v40
    s_nop 1
    v_cndmask_b32 v75, v75, v7, s[48:49]
    v_cmp_le_i32 s[48:49], 1, v40
    s_nop 1
    v_cndmask_b32 v76, v76, v7, s[48:49]
    v_cmp_le_i32 s[48:49], 3, v40
    s_nop 1
    v_cndmask_b32 v77, v77, v7, s[48:49]
    v_cmp_le_i32 s[48:49], 5, v40
    s_nop 1
    v_cndmask_b32 v78, v78, v7, s[48:49]
    v_cmp_le_i32 s[48:49], 7, v40
    s_nop 1
    v_cndmask_b32 v79, v79, v7, s[48:49]
    v_cmp_le_i32 s[48:49], 17, v40
    s_nop 1
    v_cndmask_b32 v80, v80, v7, s[48:49]
    v_cmp_le_i32 s[48:49], 19, v40
    s_nop 1
    v_cndmask_b32 v81, v81, v7, s[48:49]
    v_cmp_le_i32 s[48:49], 21, v40
    s_nop 1
    v_cndmask_b32 v82, v82, v7, s[48:49]
    v_cmp_le_i32 s[48:49], 23, v40
    s_nop 1
    v_cndmask_b32 v83, v83, v7, s[48:49]
aa_5_s0_pm_b:
    v_sub_f32 v68, v68, v4
    v_sub_f32 v69, v69, v4
    v_sub_f32 v70, v70, v4
    v_sub_f32 v71, v71, v4
    v_sub_f32 v72, v72, v4
    v_sub_f32 v73, v73, v4
    v_sub_f32 v74, v74, v4
    v_sub_f32 v75, v75, v4
    v_sub_f32 v76, v76, v4
    v_sub_f32 v77, v77, v4
    v_sub_f32 v78, v78, v4
    v_sub_f32 v79, v79, v4
    v_sub_f32 v80, v80, v4
    v_sub_f32 v81, v81, v4
    v_sub_f32 v82, v82, v4
    v_sub_f32 v83, v83, v4
    v_exp_f32 v68, v68
    v_exp_f32 v69, v69
    v_exp_f32 v70, v70
    v_exp_f32 v71, v71
    v_exp_f32 v72, v72
    v_exp_f32 v73, v73
    v_exp_f32 v74, v74
    v_exp_f32 v75, v75
    v_exp_f32 v76, v76
    v_exp_f32 v77, v77
    v_exp_f32 v78, v78
    v_exp_f32 v79, v79
    v_exp_f32 v80, v80
    v_exp_f32 v81, v81
    v_exp_f32 v82, v82
    v_exp_f32 v83, v83
    v_cvt_pk_bf16_f32 v100, v68, v69
    v_cvt_pk_bf16_f32 v101, v70, v71
    v_cvt_pk_bf16_f32 v102, v72, v73
    v_cvt_pk_bf16_f32 v103, v74, v75
    v_cvt_pk_bf16_f32 v104, v76, v77
    v_cvt_pk_bf16_f32 v105, v78, v79
    v_cvt_pk_bf16_f32 v106, v80, v81
    v_cvt_pk_bf16_f32 v107, v82, v83
    v_mfma_f32_32x32x16_bf16 v[52:67], v[44:47], v[100:103], v[52:67]
    s_nop 0
    v_mfma_f32_32x32x16_bf16 v[52:67], v[48:51], v[104:107], v[52:67]
    s_add_u32 s56, s56, 1
    s_cmp_le_u32 s56, s55
    s_nop 8
    s_cbranch_scc1 aa_5_s0_p
    v_rcp_f32_e64 v60, v60
    s_nop 0
    v_pk_mul_f32 v[52:53], v[52:53], v[60:61] op_sel:[0,0] op_sel_hi:[1,0]
    v_pk_mul_f32 v[54:55], v[54:55], v[60:61] op_sel:[0,0] op_sel_hi:[1,0]
    v_pk_mul_f32 v[56:57], v[56:57], v[60:61] op_sel:[0,0] op_sel_hi:[1,0]
    v_pk_mul_f32 v[58:59], v[58:59], v[60:61] op_sel:[0,0] op_sel_hi:[1,0]
    v_cvt_pk_bf16_f32 v100, v52, v53
    v_cvt_pk_bf16_f32 v101, v54, v55
    v_cvt_pk_bf16_f32 v102, v56, v57
    v_cvt_pk_bf16_f32 v103, v58, v59
    s_nop 0
    v_permlane32_swap_b32 v100, v102
    v_permlane32_swap_b32 v101, v103
    s_cmp_lg_u32 s42, 0
    s_cbranch_scc0 st_71_s
    buffer_store_dwordx4 v[100:103], v120, s[4:7], s74 offen
st_71:
    s_nop 7
    s_branch aa_5_ok0
sig_26_s:
    buffer_store_dword v6, off, s[4:7], s47 sc1
    s_branch sig_26
st_28_s:
    s_nop 7
    buffer_store_dwordx4 v[40:43], v122, s[12:15], s85 offen offset:0 sc1
    s_nop 0
    s_branch st_28
st_29_s:
    s_nop 7
    buffer_store_dwordx4 v[60:63], v122, s[12:15], s85 offen offset:1024 sc1
    s_nop 0
    s_branch st_29
sig_30_s:
    buffer_store_dword v6, off, s[4:7], s47 sc1
    s_branch sig_30
st_31_s:
    s_nop 7
    s_mov_b64 exec, 0xffff
    buffer_store_dwordx2 v[112:113], v114, s[4:7], s86 offen sc1
    s_mov_b64 exec, -1
    s_branch st_31
st_32_s:
    s_nop 7
    s_mov_b32 exec_lo, 0xff00ff00
    s_mov_b32 exec_hi, 0xff00ff00
    buffer_store_dwordx4 v[40:43], v122, s[4:7], s87 offen sc1
    buffer_store_dwordx4 v[60:63], v122, s[4:7], s87 offen offset:1024 sc1
    s_mov_b64 exec, 0xff00
    buffer_store_dwordx2 v[112:113], v114, s[4:7], s88 offen sc1
    s_mov_b64 exec, -1
    s_branch st_32
sig_34_s:
    buffer_store_dword v6, off, s[4:7], s47 sc1
    s_branch sig_34
sq_35_c:
    s_nop 7
    s_mov_b32 s50, s60
    s_mov_b32 s51, 0
    s_add_i32 s48, s43, 4
    s_mov_b32 s49, s44
    s_mov_b64 exec, s[50:51]
    buffer_load_dword v126, v124, s[4:7], 0 offen sc1
    s_nop 7
    s_nop 7
poll_72:
    buffer_load_dword v127, v124, s[4:7], 0 offen sc1
    s_waitcnt vmcnt(1)
    v_subrev_u32 v126, s48, v126
    v_cmp_gt_u32 vcc, 16, v126
    s_nop 0
    s_cmp_eq_u64 vcc, s[50:51]
    s_nop 1
    s_cbranch_scc1 poll_72_ok
    buffer_load_dword v126, v124, s[4:7], 0 offen sc1
    s_waitcnt vmcnt(1)
    v_subrev_u32 v127, s48, v127
    v_cmp_gt_u32 vcc, 16, v127
    s_nop 0
    s_cmp_eq_u64 vcc, s[50:51]
    s_nop 1
    s_cbranch_scc1 poll_72_ok
    s_add_u32 s49, s49, 1
    s_cmp_lt_u32 s49, 2000000
    s_cbranch_scc1 poll_72
    s_mov_b32 s44, 2000000
poll_72_ok:
    s_mov_b64 exec, -1
    s_branch sq_35
st_39_s:
    s_nop 7
    buffer_store_dwordx4 v[44:47], v120, s[4:7], s75 offen sc1
    buffer_store_dwordx4 v[48:51], v120, s[4:7], s74 offen sc1
    s_nop 0
    s_branch st_39
ab_38_slow:
    s_nop 7
    v_mfma_f32_16x16x16_bf16 v[72:75], v[32:33], v[16:17], 0
    v_mfma_f32_16x16x16_bf16 v[88:91], v[24:25], v[16:17], 0
    v_mfma_f32_16x16x16_bf16 v[76:79], v[36:37], v[20:21], 0
    v_mfma_f32_16x16x16_bf16 v[92:95], v[28:29], v[20:21], 0
    s_nop 5
    v_cndmask_b32 v72, v88, v72, s[64:65]
    v_cndmask_b32 v73, v89, v73, s[66:67]
    v_mfma_f32_16x16x16_bf16 v[64:67], v[24:25], v[8:9], 0
    v_cndmask_b32 v74, v90, v74, s[68:69]
    v_cndmask_b32 v75, v91, v75, s[70:71]
    v_or_b32 v6, v112, v114
    v_mfma_f32_16x16x16_bf16 v[80:83], v[40:41], v[8:9], 0
    v_and_b32 v6, 0x8000, v6
    v_cmp_ne_u32 s[48:49], 0, v6
    v_mov_b32 v7, 0xff800000
    s_nop 0
    v_cndmask_b32 v72, v7, v72, s[48:49]
    v_or_b32 v6, v112, v114
    v_and_b32 v6, 0x80000000, v6
    v_cmp_ne_u32 s[48:49], 0, v6
    v_mov_b32 v7, 0xff800000
    s_nop 0
    v_cndmask_b32 v73, v7, v73, s[48:49]
    v_or_b32 v6, v113, v115
    v_and_b32 v6, 0x8000, v6
    v_cmp_ne_u32 s[48:49], 0, v6
    v_mov_b32 v7, 0xff800000
    s_nop 0
    v_cndmask_b32 v74, v7, v74, s[48:49]
    v_or_b32 v6, v113, v115
    v_and_b32 v6, 0x80000000, v6
    v_cmp_ne_u32 s[48:49], 0, v6
    v_mov_b32 v7, 0xff800000
    s_nop 0
    v_cndmask_b32 v75, v7, v75, s[48:49]
    v_max_f32 v6, v72, v73
    v_max3_f32 v6, v6, v74, v75
    v_mov_b32 v7, v6
    s_nop 1
    v_permlane32_swap_b32 v6, v7
    v_max_f32 v6, v6, v7
    v_mov_b32 v7, v6
    s_nop 1
    v_permlane16_swap_b32 v6, v7
    v_max_f32 v6, v6, v7
    v_sub_f32 v72, v72, v6
    v_sub_f32 v73, v73, v6
    v_sub_f32 v74, v74, v6
    v_sub_f32 v75, v75, v6
    v_exp_f32 v72, v72
    v_exp_f32 v73, v73
    v_exp_f32 v74, v74
    v_exp_f32 v75, v75
    v_cvt_pk_bf16_f32 v72, v72, v73
    v_cvt_pk_bf16_f32 v73, v74, v75
    v_and_b32 v52, v72, v112
    v_and_b32 v54, v72, v114
    v_and_b32 v53, v73, v113
    v_and_b32 v55, v73, v115
    v_cndmask_b32 v76, v92, v76, s[64:65]
    v_cndmask_b32 v77, v93, v77, s[66:67]
    v_mfma_f32_16x16x32_bf16 v[72:75], v[96:99], v[52:55], 0
    v_cndmask_b32 v78, v94, v78, s[68:69]
    v_cndmask_b32 v79, v95, v79, s[70:71]
    v_or_b32_e64 v6, v112, v114
    v_mfma_f32_16x16x32_bf16 v[88:91], v[108:111], v[52:55], 0
    v_and_b32 v6, 0x8000, v6
    v_cmp_ne_u32 s[48:49], 0, v6
    v_mov_b32 v7, 0xff800000
    v_mfma_f32_16x16x16_bf16 v[68:71], v[28:29], v[12:13], 0
    v_cndmask_b32 v76, v7, v76, s[48:49]
    v_or_b32_e64 v6, v112, v114
    v_and_b32 v6, 0x80000000, v6
    v_mfma_f32_16x16x16_bf16 v[84:87], v[40:41], v[12:13], 0
    v_cmp_ne_u32 s[48:49], 0, v6
    v_mov_b32 v7, 0xff800000
    s_nop 0
    v_cndmask_b32 v77, v7, v77, s[48:49]
    v_or_b32 v6, v113, v115
    v_and_b32 v6, 0x8000, v6
    v_cmp_ne_u32 s[48:49], 0, v6
    v_mov_b32 v7, 0xff800000
    s_nop 0
    v_cndmask_b32 v78, v7, v78, s[48:49]
    v_or_b32 v6, v113, v115
    v_and_b32 v6, 0x80000000, v6
    v_cmp_ne_u32 s[48:49], 0, v6
    v_mov_b32 v7, 0xff800000
    s_nop 0
    v_cndmask_b32 v79, v7, v79, s[48:49]
    v_max_f32 v6, v76, v77
    v_max3_f32 v6, v6, v78, v79
    v_mov_b32 v7, v6
    s_nop 1
    v_permlane32_swap_b32 v6, v7
    v_max_f32 v6, v6, v7
    v_mov_b32 v7, v6
    s_nop 1
    v_permlane16_swap_b32 v6, v7
    v_max_f32 v6, v6, v7
    v_sub_f32 v76, v76, v6
    v_sub_f32 v77, v77, v6
    v_sub_f32 v78, v78, v6
    v_sub_f32 v79, v79, v6
    v_exp_f32 v76, v76
    v_exp_f32 v77, v77
    v_exp_f32 v78, v78
    v_exp_f32 v79, v79
    v_cvt_pk_bf16_f32 v76, v76, v77
    v_cvt_pk_bf16_f32 v77, v78, v79
    v_and_b32 v56, v76, v112
    v_and_b32 v58, v76, v114
    v_and_b32 v57, v77, v113
    v_and_b32 v59, v77, v115
    v_cndmask_b32 v64, v80, v64, s[64:65]
    v_cndmask_b32 v65, v81, v65, s[66:67]
    v_mfma_f32_16x16x32_bf16 v[76:79], v[102:105], v[56:59], 0
    v_cndmask_b32 v66, v82, v66, s[68:69]
    v_cndmask_b32 v67, v83, v67, s[70:71]
    v_or_b32_e64 v6, v112, v116
    v_mfma_f32_16x16x32_bf16 v[92:95], v[108:111], v[56:59], 0
    v_and_b32 v6, 0x8000, v6
    v_cmp_ne_u32 s[48:49], 0, v6
    v_mov_b32 v7, 0xff800000
    s_nop 0
    v_cndmask_b32 v64, v7, v64, s[48:49]
    v_or_b32 v6, v112, v116
    v_and_b32 v6, 0x80000000, v6
    v_cmp_ne_u32 s[48:49], 0, v6
    v_mov_b32 v7, 0xff800000
    s_nop 0
    v_cndmask_b32 v65, v7, v65, s[48:49]
    v_or_b32 v6, v113, v117
    v_and_b32 v6, 0x8000, v6
    v_cmp_ne_u32 s[48:49], 0, v6
    v_mov_b32 v7, 0xff800000
    s_nop 0
    v_cndmask_b32 v66, v7, v66, s[48:49]
    v_or_b32 v6, v113, v117
    v_and_b32 v6, 0x80000000, v6
    v_cmp_ne_u32 s[48:49], 0, v6
    v_mov_b32 v7, 0xff800000
    s_nop 0
    v_cndmask_b32 v67, v7, v67, s[48:49]
    v_max_f32 v6, v64, v65
    v_max3_f32 v6, v6, v66, v67
    v_mov_b32 v7, v6
    s_nop 1
    v_permlane32_swap_b32 v6, v7
    v_max_f32 v6, v6, v7
    v_mov_b32 v7, v6
    s_nop 1
    v_permlane16_swap_b32 v6, v7
    v_max_f32 v6, v6, v7
    v_sub_f32 v64, v64, v6
    v_sub_f32 v65, v65, v6
    v_sub_f32 v66, v66, v6
    v_sub_f32 v67, v67, v6
    v_exp_f32 v64, v64
    v_exp_f32 v65, v65
    v_exp_f32 v66, v66
    v_exp_f32 v67, v67
    v_cvt_pk_bf16_f32 v64, v64, v65
    v_cvt_pk_bf16_f32 v65, v66, v67
    v_and_b32 v44, v64, v112
    v_and_b32 v46, v64, v116
    v_and_b32 v45, v65, v113
    v_and_b32 v47, v65, v117
    v_cndmask_b32 v68, v84, v68, s[64:65]
    v_cndmask_b32 v69, v85, v69, s[66:67]
    v_mfma_f32_16x16x32_bf16 v[64:67], v[98:101], v[44:47], 0
    v_cndmask_b32 v70, v86, v70, s[68:69]
    v_cndmask_b32 v71, v87, v71, s[70:71]
    v_or_b32_e64 v6, v112, v118
    v_mfma_f32_16x16x32_bf16 v[80:83], v[108:111], v[44:47], 0
    v_and_b32 v6, 0x8000, v6
    v_cmp_ne_u32 s[48:49], 0, v6
    v_mov_b32 v7, 0xff800000
    s_nop 0
    v_cndmask_b32 v68, v7, v68, s[48:49]
    v_or_b32 v6, v112, v118
    v_and_b32 v6, 0x80000000, v6
    v_cmp_ne_u32 s[48:49], 0, v6
    v_mov_b32 v7, 0xff800000
    s_nop 0
    v_cndmask_b32 v69, v7, v69, s[48:49]
    v_or_b32 v6, v113, v119
    v_and_b32 v6, 0x8000, v6
    v_cmp_ne_u32 s[48:49], 0, v6
    v_mov_b32 v7, 0xff800000
    s_nop 0
    v_cndmask_b32 v70, v7, v70, s[48:49]
    v_or_b32 v6, v113, v119
    v_and_b32 v6, 0x80000000, v6
    v_cmp_ne_u32 s[48:49], 0, v6
    v_mov_b32 v7, 0xff800000
    s_nop 0
    v_cndmask_b32 v71, v7, v71, s[48:49]
    v_max_f32 v6, v68, v69
    v_max3_f32 v6, v6, v70, v71
    v_mov_b32 v7, v6
    s_nop 1
    v_permlane32_swap_b32 v6, v7
    v_max_f32 v6, v6, v7
    v_mov_b32 v7, v6
    s_nop 1
    v_permlane16_swap_b32 v6, v7
    v_max_f32 v6, v6, v7
    v_sub_f32 v68, v68, v6
    v_sub_f32 v69, v69, v6
    v_sub_f32 v70, v70, v6
    v_sub_f32 v71, v71, v6
    v_exp_f32 v68, v68
    v_exp_f32 v69, v69
    v_exp_f32 v70, v70
    v_exp_f32 v71, v71
    v_cvt_pk_bf16_f32 v68, v68, v69
    v_cvt_pk_bf16_f32 v69, v70, v71
    v_and_b32 v48, v68, v112
    v_and_b32 v50, v68, v118
    v_and_b32 v49, v69, v113
    v_and_b32_e64 v51, v69, v119
    s_nop 1
    v_mfma_f32_16x16x32_bf16 v[68:71], v[104:107], v[48:51], 0
    v_mfma_f32_16x16x32_bf16 v[84:87], v[108:111], v[48:51], 0
    s_waitcnt vmcnt(0)
    v_rcp_f32 v88, v88
    v_rcp_f32 v92, v92
    v_rcp_f32 v80, v80
    s_nop 3
    v_rcp_f32 v84, v84
    v_pk_mul_f32 v[72:73], v[72:73], v[88:89] op_sel:[0,0] op_sel_hi:[1,0]
    v_pk_mul_f32 v[74:75], v[74:75], v[88:89] op_sel:[0,0] op_sel_hi:[1,0]
    v_cvt_pk_bf16_f32 v44, v72, v73
    v_cvt_pk_bf16_f32 v45, v74, v75
    v_pk_mul_f32 v[76:77], v[76:77], v[92:93] op_sel:[0,0] op_sel_hi:[1,0]
    v_pk_mul_f32 v[78:79], v[78:79], v[92:93] op_sel:[0,0] op_sel_hi:[1,0]
    v_cvt_pk_bf16_f32 v46, v76, v77
    v_cvt_pk_bf16_f32 v47, v78, v79
    v_pk_mul_f32 v[64:65], v[64:65], v[80:81] op_sel:[0,0] op_sel_hi:[1,0]
    v_pk_mul_f32 v[66:67], v[66:67], v[80:81] op_sel:[0,0] op_sel_hi:[1,0]
    v_cvt_pk_bf16_f32 v48, v64, v65
    v_cvt_pk_bf16_f32 v49, v66, v67
    v_pk_mul_f32 v[68:69], v[68:69], v[84:85] op_sel:[0,0] op_sel_hi:[1,0]
    v_pk_mul_f32 v[70:71], v[70:71], v[84:85] op_sel:[0,0] op_sel_hi:[1,0]
    v_cvt_pk_bf16_f32 v50, v68, v69
    v_cvt_pk_bf16_f32 v51, v70, v71
    v_permlane16_swap_b32 v44, v46
    v_permlane16_swap_b32 v45, v47
    v_permlane16_swap_b32 v48, v50
    v_permlane16_swap_b32 v49, v51
    s_cmp_lg_u32 s42, 0
    s_cbranch_scc0 st_73_s
    buffer_store_dwordx4 v[44:47], v120, s[4:7], s75 offen
    buffer_store_dwordx4 v[48:51], v120, s[4:7], s74 offen
st_73:
    s_nop 7
    s_branch ab_38_ok
sig_41_s:
    buffer_store_dword v6, off, s[4:7], s47 sc1
    s_branch sig_41
st_44_s:
    s_nop 7
    buffer_store_dwordx4 v[40:43], v122, s[12:15], s76 offen offset:0 sc1
    s_nop 0
    s_branch st_44
st_45_s:
    s_nop 7
    buffer_store_dwordx4 v[60:63], v122, s[12:15], s76 offen offset:1024 sc1
    s_nop 0
    s_branch st_45
sig_46_s:
    buffer_store_dword v6, off, s[4:7], s47 sc1
    s_branch sig_46
st_47_s:
    s_nop 7
    s_mov_b64 exec, 0xffff
    buffer_store_dwordx2 v[112:113], v114, s[4:7], s86 offen sc1
    s_mov_b64 exec, -1
    s_branch st_47
sig_49_s:
    buffer_store_dword v6, off, s[4:7], s47 sc1
    s_branch sig_49
sq_50_c:
    s_nop 7
    s_mov_b32 s50, s60
    s_mov_b32 s51, 0
    s_add_i32 s48, s43, 0
    s_mov_b32 s49, s44
    s_mov_b64 exec, s[50:51]
    buffer_load_dword v126, v124, s[4:7], 0 offen sc1
    s_nop 7
    s_nop 7
poll_74:
    buffer_load_dword v127, v124, s[4:7], 0 offen sc1
    s_waitcnt vmcnt(1)
    v_subrev_u32 v126, s48, v126
    v_cmp_gt_u32 vcc, 16, v126
    s_nop 0
    s_cmp_eq_u64 vcc, s[50:51]
    s_nop 1
    s_cbranch_scc1 poll_74_ok
    buffer_load_dword v126, v124, s[4:7], 0 offen sc1
    s_waitcnt vmcnt(1)
    v_subrev_u32 v127, s48, v127
    v_cmp_gt_u32 vcc, 16, v127
    s_nop 0
    s_cmp_eq_u64 vcc, s[50:51]
    s_nop 1
    s_cbranch_scc1 poll_74_ok
    s_add_u32 s49, s49, 1
    s_cmp_lt_u32 s49, 2000000
    s_cbranch_scc1 poll_74
    s_mov_b32 s44, 2000000
poll_74_ok:
    s_mov_b64 exec, -1
    s_branch sq_50
sig_51_s:
    buffer_store_dword v6, off, s[4:7], s47 sc1
    s_branch sig_51
sig_53_s:
    buffer_store_dword v6, off, s[4:7], s47 sc1
    s_branch sig_53
st_55_s:
    s_nop 7
    buffer_store_dwordx4 v[40:43], v122, s[12:15], s85 offen offset:0 sc1
    s_nop 0
    s_branch st_55
st_56_s:
    s_nop 7
    buffer_store_dwordx4 v[60:63], v122, s[12:15], s85 offen offset:1024 sc1
    s_nop 0
    s_branch st_56
sig_57_s:
    buffer_store_dword v6, off, s[4:7], s47 sc1
    s_branch sig_57
st_58_s:
    s_nop 7
    s_mov_b64 exec, 0xffff
    buffer_store_dwordx2 v[112:113], v114, s[4:7], s86 offen sc1
    s_mov_b64 exec, -1
    s_branch st_58
st_59_s:
    s_nop 7
    s_mov_b32 exec_lo, 0xff00ff00
    s_mov_b32 exec_hi, 0xff00ff00
    buffer_store_dwordx4 v[40:43], v122, s[4:7], s87 offen sc1
    buffer_store_dwordx4 v[60:63], v122, s[4:7], s87 offen offset:1024 sc1
    s_mov_b64 exec, 0xff00
    buffer_store_dwordx2 v[112:113], v114, s[4:7], s88 offen sc1
    s_mov_b64 exec, -1
    s_branch st_59
sig_61_s:
    buffer_store_dword v6, off, s[4:7], s47 sc1
    s_branch sig_61
sq_62_c:
    s_nop 7
    s_mov_b32 s50, s60
    s_mov_b32 s51, 0
    s_add_i32 s48, s43, 4
    s_mov_b32 s49, s44
    s_mov_b64 exec, s[50:51]
    buffer_load_dword v126, v124, s[4:7], 0 offen sc1
    s_nop 7
    s_nop 7
poll_75:
    buffer_load_dword v127, v124, s[4:7], 0 offen sc1
    s_waitcnt vmcnt(1)
    v_subrev_u32 v126, s48, v126
    v_cmp_gt_u32 vcc, 16, v126
    s_nop 0
    s_cmp_eq_u64 vcc, s[50:51]
    s_nop 1
    s_cbranch_scc1 poll_75_ok
    buffer_load_dword v126, v124, s[4:7], 0 offen sc1
    s_waitcnt vmcnt(1)
    v_subrev_u32 v127, s48, v127
    v_cmp_gt_u32 vcc, 16, v127
    s_nop 0
    s_cmp_eq_u64 vcc, s[50:51]
    s_nop 1
    s_cbranch_scc1 poll_75_ok
    s_add_u32 s49, s49, 1
    s_cmp_lt_u32 s49, 2000000
    s_cbranch_scc1 poll_75
    s_mov_b32 s44, 2000000
poll_75_ok:
    s_mov_b64 exec, -1
    s_branch sq_62
st_66_s:
    s_nop 7
    buffer_store_dwordx4 v[44:47], v120, s[4:7], s75 offen sc1
    buffer_store_dwordx4 v[48:51], v120, s[4:7], s74 offen sc1
    s_nop 0
    s_branch st_66
ab_65_slow:
    s_nop 7
    v_mfma_f32_16x16x16_bf16 v[72:75], v[32:33], v[16:17], 0
    v_mfma_f32_16x16x16_bf16 v[88:91], v[24:25], v[16:17], 0
    v_mfma_f32_16x16x16_bf16 v[76:79], v[36:37], v[20:21], 0
    v_mfma_f32_16x16x16_bf16 v[92:95], v[28:29], v[20:21], 0
    s_nop 5
    v_cndmask_b32 v72, v88, v72, s[64:65]
    v_cndmask_b32 v73, v89, v73, s[66:67]
    v_mfma_f32_16x16x16_bf16 v[64:67], v[24:25], v[8:9], 0
    v_cndmask_b32 v74, v90, v74, s[68:69]
    v_cndmask_b32 v75, v91, v75, s[70:71]
    v_or_b32 v6, v112, v114
    v_mfma_f32_16x16x16_bf16 v[80:83], v[40:41], v[8:9], 0
    v_and_b32 v6, 0x8000, v6
    v_cmp_ne_u32 s[48:49], 0, v6
    v_mov_b32 v7, 0xff800000
    s_nop 0
    v_cndmask_b32 v72, v7, v72, s[48:49]
    v_or_b32 v6, v112, v114
    v_and_b32 v6, 0x80000000, v6
    v_cmp_ne_u32 s[48:49], 0, v6
    v_mov_b32 v7, 0xff800000
    s_nop 0
    v_cndmask_b32 v73, v7, v73, s[48:49]
    v_or_b32 v6, v113, v115
    v_and_b32 v6, 0x8000, v6
    v_cmp_ne_u32 s[48:49], 0, v6
    v_mov_b32 v7, 0xff800000
    s_nop 0
    v_cndmask_b32 v74, v7, v74, s[48:49]
    v_or_b32 v6, v113, v115
    v_and_b32 v6, 0x80000000, v6
    v_cmp_ne_u32 s[48:49], 0, v6
    v_mov_b32 v7, 0xff800000
    s_nop 0
    v_cndmask_b32 v75, v7, v75, s[48:49]
    v_max_f32 v6, v72, v73
    v_max3_f32 v6, v6, v74, v75
    v_mov_b32 v7, v6
    s_nop 1
    v_permlane32_swap_b32 v6, v7
    v_max_f32 v6, v6, v7
    v_mov_b32 v7, v6
    s_nop 1
    v_permlane16_swap_b32 v6, v7
    v_max_f32 v6, v6, v7
    v_sub_f32 v72, v72, v6
    v_sub_f32 v73, v73, v6
    v_sub_f32 v74, v74, v6
    v_sub_f32 v75, v75, v6
    v_exp_f32 v72, v72
    v_exp_f32 v73, v73
    v_exp_f32 v74, v74
    v_exp_f32 v75, v75
    v_cvt_pk_bf16_f32 v72, v72, v73
    v_cvt_pk_bf16_f32 v73, v74, v75
    v_and_b32 v52, v72, v112
    v_and_b32 v54, v72, v114
    v_and_b32 v53, v73, v113
    v_and_b32 v55, v73, v115
    v_cndmask_b32 v76, v92, v76, s[64:65]
    v_cndmask_b32 v77, v93, v77, s[66:67]
    v_mfma_f32_16x16x32_bf16 v[72:75], v[96:99], v[52:55], 0
    v_cndmask_b32 v78, v94, v78, s[68:69]
    v_cndmask_b32 v79, v95, v79, s[70:71]
    v_or_b32_e64 v6, v112, v114
    v_mfma_f32_16x16x32_bf16 v[88:91], v[108:111], v[52:55], 0
    v_and_b32 v6, 0x8000, v6
    v_cmp_ne_u32 s[48:49], 0, v6
    v_mov_b32 v7, 0xff800000
    v_mfma_f32_16x16x16_bf16 v[68:71], v[28:29], v[12:13], 0
    v_cndmask_b32 v76, v7, v76, s[48:49]
    v_or_b32_e64 v6, v112, v114
    v_and_b32 v6, 0x80000000, v6
    v_mfma_f32_16x16x16_bf16 v[84:87], v[40:41], v[12:13], 0
    v_cmp_ne_u32 s[48:49], 0, v6
    v_mov_b32 v7, 0xff800000
    s_nop 0
    v_cndmask_b32 v77, v7, v77, s[48:49]
    v_or_b32 v6, v113, v115
    v_and_b32 v6, 0x8000, v6
    v_cmp_ne_u32 s[48:49], 0, v6
    v_mov_b32 v7, 0xff800000
    s_nop 0
    v_cndmask_b32 v78, v7, v78, s[48:49]
    v_or_b32 v6, v113, v115
    v_and_b32 v6, 0x80000000, v6
    v_cmp_ne_u32 s[48:49], 0, v6
    v_mov_b32 v7, 0xff800000
    s_nop 0
    v_cndmask_b32 v79, v7, v79, s[48:49]
    v_max_f32 v6, v76, v77
    v_max3_f32 v6, v6, v78, v79
    v_mov_b32 v7, v6
    s_nop 1
    v_permlane32_swap_b32 v6, v7
    v_max_f32 v6, v6, v7
    v_mov_b32 v7, v6
    s_nop 1
    v_permlane16_swap_b32 v6, v7
    v_max_f32 v6, v6, v7
    v_sub_f32 v76, v76, v6
    v_sub_f32 v77, v77, v6
    v_sub_f32 v78, v78, v6
    v_sub_f32 v79, v79, v6
    v_exp_f32 v76, v76
    v_exp_f32 v77, v77
    v_exp_f32 v78, v78
    v_exp_f32 v79, v79
    v_cvt_pk_bf16_f32 v76, v76, v77
    v_cvt_pk_bf16_f32 v77, v78, v79
    v_and_b32 v56, v76, v112
    v_and_b32 v58, v76, v114
    v_and_b32 v57, v77, v113
    v_and_b32 v59, v77, v115
    v_cndmask_b32 v64, v80, v64, s[64:65]
    v_cndmask_b32 v65, v81, v65, s[66:67]
    v_mfma_f32_16x16x32_bf16 v[76:79], v[102:105], v[56:59], 0
    v_cndmask_b32 v66, v82, v66, s[68:69]
    v_cndmask_b32 v67, v83, v67, s[70:71]
    v_or_b32_e64 v6, v112, v116
    v_mfma_f32_16x16x32_bf16 v[92:95], v[108:111], v[56:59], 0
    v_and_b32 v6, 0x8000, v6
    v_cmp_ne_u32 s[48:49], 0, v6
    v_mov_b32 v7, 0xff800000
    s_nop 0
    v_cndmask_b32 v64, v7, v64, s[48:49]
    v_or_b32 v6, v112, v116
    v_and_b32 v6, 0x80000000, v6
    v_cmp_ne_u32 s[48:49], 0, v6
    v_mov_b32 v7, 0xff800000
    s_nop 0
    v_cndmask_b32 v65, v7, v65, s[48:49]
    v_or_b32 v6, v113, v117
    v_and_b32 v6, 0x8000, v6
    v_cmp_ne_u32 s[48:49], 0, v6
    v_mov_b32 v7, 0xff800000
    s_nop 0
    v_cndmask_b32 v66, v7, v66, s[48:49]
    v_or_b32 v6, v113, v117
    v_and_b32 v6, 0x80000000, v6
    v_cmp_ne_u32 s[48:49], 0, v6
    v_mov_b32 v7, 0xff800000
    s_nop 0
    v_cndmask_b32 v67, v7, v67, s[48:49]
    v_max_f32 v6, v64, v65
    v_max3_f32 v6, v6, v66, v67
    v_mov_b32 v7, v6
    s_nop 1
    v_permlane32_swap_b32 v6, v7
    v_max_f32 v6, v6, v7
    v_mov_b32 v7, v6
    s_nop 1
    v_permlane16_swap_b32 v6, v7
    v_max_f32 v6, v6, v7
    v_sub_f32 v64, v64, v6
    v_sub_f32 v65, v65, v6
    v_sub_f32 v66, v66, v6
    v_sub_f32 v67, v67, v6
    v_exp_f32 v64, v64
    v_exp_f32 v65, v65
    v_exp_f32 v66, v66
    v_exp_f32 v67, v67
    v_cvt_pk_bf16_f32 v64, v64, v65
    v_cvt_pk_bf16_f32 v65, v66, v67
    v_and_b32 v44, v64, v112
    v_and_b32 v46, v64, v116
    v_and_b32 v45, v65, v113
    v_and_b32 v47, v65, v117
    v_cndmask_b32 v68, v84, v68, s[64:65]
    v_cndmask_b32 v69, v85, v69, s[66:67]
    v_mfma_f32_16x16x32_bf16 v[64:67], v[98:101], v[44:47], 0
    v_cndmask_b32 v70, v86, v70, s[68:69]
    v_cndmask_b32 v71, v87, v71, s[70:71]
    v_or_b32_e64 v6, v112, v118
    v_mfma_f32_16x16x32_bf16 v[80:83], v[108:111], v[44:47], 0
    v_and_b32 v6, 0x8000, v6
    v_cmp_ne_u32 s[48:49], 0, v6
    v_mov_b32 v7, 0xff800000
    s_nop 0
    v_cndmask_b32 v68, v7, v68, s[48:49]
    v_or_b32 v6, v112, v118
    v_and_b32 v6, 0x80000000, v6
    v_cmp_ne_u32 s[48:49], 0, v6
    v_mov_b32 v7, 0xff800000
    s_nop 0
    v_cndmask_b32 v69, v7, v69, s[48:49]
    v_or_b32 v6, v113, v119
    v_and_b32 v6, 0x8000, v6
    v_cmp_ne_u32 s[48:49], 0, v6
    v_mov_b32 v7, 0xff800000
    s_nop 0
    v_cndmask_b32 v70, v7, v70, s[48:49]
    v_or_b32 v6, v113, v119
    v_and_b32 v6, 0x80000000, v6
    v_cmp_ne_u32 s[48:49], 0, v6
    v_mov_b32 v7, 0xff800000
    s_nop 0
    v_cndmask_b32 v71, v7, v71, s[48:49]
    v_max_f32 v6, v68, v69
    v_max3_f32 v6, v6, v70, v71
    v_mov_b32 v7, v6
    s_nop 1
    v_permlane32_swap_b32 v6, v7
    v_max_f32 v6, v6, v7
    v_mov_b32 v7, v6
    s_nop 1
    v_permlane16_swap_b32 v6, v7
    v_max_f32 v6, v6, v7
    v_sub_f32 v68, v68, v6
    v_sub_f32 v69, v69, v6
    v_sub_f32 v70, v70, v6
    v_sub_f32 v71, v71, v6
    v_exp_f32 v68, v68
    v_exp_f32 v69, v69
    v_exp_f32 v70, v70
    v_exp_f32 v71, v71
    v_cvt_pk_bf16_f32 v68, v68, v69
    v_cvt_pk_bf16_f32 v69, v70, v71
    v_and_b32 v48, v68, v112
    v_and_b32 v50, v68, v118
    v_and_b32 v49, v69, v113
    v_and_b32_e64 v51, v69, v119
    s_nop 1
    v_mfma_f32_16x16x32_bf16 v[68:71], v[104:107], v[48:51], 0
    v_mfma_f32_16x16x32_bf16 v[84:87], v[108:111], v[48:51], 0
    s_waitcnt vmcnt(0)
    v_rcp_f32 v88, v88
    v_rcp_f32 v92, v92
    v_rcp_f32 v80, v80
    s_nop 3
    v_rcp_f32 v84, v84
    v_pk_mul_f32 v[72:73], v[72:73], v[88:89] op_sel:[0,0] op_sel_hi:[1,0]
    v_pk_mul_f32 v[74:75], v[74:75], v[88:89] op_sel:[0,0] op_sel_hi:[1,0]
    v_cvt_pk_bf16_f32 v44, v72, v73
    v_cvt_pk_bf16_f32 v45, v74, v75
    v_pk_mul_f32 v[76:77], v[76:77], v[92:93] op_sel:[0,0] op_sel_hi:[1,0]
    v_pk_mul_f32 v[78:79], v[78:79], v[92:93] op_sel:[0,0] op_sel_hi:[1,0]
    v_cvt_pk_bf16_f32 v46, v76, v77
    v_cvt_pk_bf16_f32 v47, v78, v79
    v_pk_mul_f32 v[64:65], v[64:65], v[80:81] op_sel:[0,0] op_sel_hi:[1,0]
    v_pk_mul_f32 v[66:67], v[66:67], v[80:81] op_sel:[0,0] op_sel_hi:[1,0]
    v_cvt_pk_bf16_f32 v48, v64, v65
    v_cvt_pk_bf16_f32 v49, v66, v67
    v_pk_mul_f32 v[68:69], v[68:69], v[84:85] op_sel:[0,0] op_sel_hi:[1,0]
    v_pk_mul_f32 v[70:71], v[70:71], v[84:85] op_sel:[0,0] op_sel_hi:[1,0]
    v_cvt_pk_bf16_f32 v50, v68, v69
    v_cvt_pk_bf16_f32 v51, v70, v71
    v_permlane16_swap_b32 v44, v46
    v_permlane16_swap_b32 v45, v47
    v_permlane16_swap_b32 v48, v50
    v_permlane16_swap_b32 v49, v51
    s_cmp_lg_u32 s42, 0
    s_cbranch_scc0 st_76_s
    buffer_store_dwordx4 v[44:47], v120, s[4:7], s75 offen
    buffer_store_dwordx4 v[48:51], v120, s[4:7], s74 offen
st_76:
    s_nop 7
    s_branch ab_65_ok
sig_68_s:
    buffer_store_dword v6, off, s[4:7], s47 sc1
    s_branch sig_68
st_70_s:
    s_nop 7
    buffer_store_dwordx4 v[104:107], v120, s[4:7], s75 offen sc1
    s_nop 0
    s_branch st_70
st_71_s:
    s_nop 7
    buffer_store_dwordx4 v[100:103], v120, s[4:7], s74 offen sc1
    s_nop 0
    s_branch st_71
st_73_s:
    s_nop 7
    buffer_store_dwordx4 v[44:47], v120, s[4:7], s75 offen sc1
    buffer_store_dwordx4 v[48:51], v120, s[4:7], s74 offen sc1
    s_nop 0
    s_branch st_73
st_76_s:
    s_nop 7
    buffer_store_dwordx4 v[44:47], v120, s[4:7], s75 offen sc1
    buffer_store_dwordx4 v[48:51], v120, s[4:7], s74 offen sc1
    s_nop 0
    s_branch st_76
    s_endpgm

.section .rodata,"a"
.p2align 6
.amdhsa_kernel interleave_layers__sliding_block__sliding_local_dilated__prompt_kernel
  .amdhsa_next_free_vgpr 512
  .amdhsa_next_free_sgpr 102
  .amdhsa_accum_offset 256
  .amdhsa_group_segment_fixed_size 0
  .amdhsa_kernarg_size 72
  .amdhsa_user_sgpr_count 2
  .amdhsa_user_sgpr_kernarg_segment_ptr 1
  .amdhsa_system_sgpr_workgroup_id_x 1
  .amdhsa_float_denorm_mode_32 3
.end_amdhsa_kernel
```
